```python
import torch

def _softmax(x, axis=-1):
    return torch.softmax(x, dim=axis)
def _gelu(x):
    return torch.nn.functional.gelu(x, approximate="tanh")
def _silu(x):
    return torch.nn.functional.silu(x)
def _sigmoid(x):
    return torch.sigmoid(x)
def _layernorm(x, axis=-1, eps=1e-5):
    m = x.mean(dim=axis, keepdim=True)
    v = x.var(dim=axis, keepdim=True, unbiased=False)
    return (x - m) / torch.sqrt(v + eps)
def _scatter_add(tgt, idx, src, axis=0):
    return tgt.clone().index_add_(axis, idx, src)
def _segment_sum(src, seg, n):
    out = torch.zeros((n,) + src.shape[1:], dtype=src.dtype)
    return out.index_add_(0, seg, src)
def _pad(x, pw):
    flat = tuple(v for pair in reversed(pw) for v in pair)
    return torch.nn.functional.pad(x, flat)

kernel_name = 'sequential_preLN__spectral_gfnet__dense_activation_silu__prompt'

def setup_inputs():

    _w = (lambda a: (lambda t: t.to(torch.bfloat16) if t.is_floating_point() else t)(torch.as_tensor(a)))
    def _A_setup():
        B, S, D = 1, 2048, 512
        Df = D // 2 + 1
        return {
            "x": _w((lambda *s: torch.randn(*s, dtype=torch.bfloat16) * 0.05)(B, S, D)),
            "w_r": _w((lambda *s: torch.randn(*s, dtype=torch.bfloat16) * 0.4)(S, Df) * 0.02),
            "w_i": _w((lambda *s: torch.randn(*s, dtype=torch.bfloat16) * 0.4)(S, Df) * 0.02),
        }
    _A_in = _A_setup()

    def _B_setup():
        B, S, D, F = 1, 2048, 512, 1792
        return {
            "x": _w((lambda *s: torch.randn(*s, dtype=torch.bfloat16) * 0.05)(B, S, D)),
            "w1": _w((lambda *s: torch.randn(*s, dtype=torch.bfloat16) * 0.8)(D, F) * (D ** -0.5)),
            "w2": _w((lambda *s: torch.randn(*s, dtype=torch.bfloat16) * 0.1)(F, D) * (F ** -0.5)),
        }
    _B_in = _B_setup()

    return {
        "A_x": _A_in["x"],
        "A_w_r": _A_in["w_r"],
        "A_w_i": _A_in["w_i"],
        "B_x": _B_in["x"],
        "B_w1": _B_in["w1"],
        "B_w2": _B_in["w2"],
    }

def reference(A_x, A_w_r, A_w_i, B_x, B_w1, B_w2):
    def _A_ref(x, w_r, w_i):
        B, S, D = x.shape
        X = (lambda x, axes=(-2,-1): torch.fft.rfft2(x.float(), dim=axes))(x, axes=(-2, -1))
        W = w_r + 1j * w_i
        X = X * W
        y = (lambda x, s, axes=(-2,-1): torch.fft.irfft2(x, s=s, dim=axes).to(torch.bfloat16))(X, (S, D), axes=(-2, -1))
        return y

    def _B_ref(x, w1, w2):
        h = torch.einsum("bsd,df->bsf", x, w1)
        h = _silu(h)
        out = torch.einsum("bsf,fd->bsd", h, w2)
        return out

    x = A_x
    h = x + _A_ref(_layernorm(x, axis=-1), A_w_r, A_w_i)
    h2 = h + _B_ref(_layernorm(h, axis=-1), B_w1, B_w2)
    return h2
```

```asm
; @launch kernel=k1_kernel grid=(512,1,1) block=(256,1,1) lds=36864
; @launch kernel=km_kernel grid=(256,1,1) block=(256,1,1) lds=163840
.amdgcn_target "amdgcn-amd-amdhsa--gfx950"
.text
.globl k1_kernel
.p2align 8
.type k1_kernel,@function
k1_kernel:
    s_cmp_ge_u32 s2, 256
    s_cbranch_scc1 k1_side
    s_load_dwordx2 s[24:25], s[0:1], 0
    s_load_dwordx2 s[6:7], s[0:1], 64
    v_lshrrev_b32 v2, 6, v0
    v_and_b32 v1, 63, v0
    v_readfirstlane_b32 s3, v2
    s_getpc_b64 s[20:21]
    s_add_u32 s20, s20, tab1@rel32@lo+4
    s_addc_u32 s21, s21, tab1@rel32@hi+12
    s_and_b32 s21, s21, 0xffff
    s_mov_b32 s22, 0x3000
    s_mov_b32 s23, 0x20000
    v_lshlrev_b32 v2, 4, v1
    s_mul_i32 s4, s3, 3072
    s_add_u32 s5, s4, 24576
    s_mov_b32 m0, s5
    s_nop 0
    buffer_load_dwordx4 v2, s[20:23], s4 offen offset:0 lds
    buffer_load_dwordx4 v2, s[20:23], s4 offen offset:1024 lds
    buffer_load_dwordx4 v2, s[20:23], s4 offen offset:2048 lds
    s_and_b32 s32, s2, 7
    s_lshr_b32 s48, s2, 3
    s_and_b32 s39, s48, 7
    s_and_b32 s34, s32, 1
    s_lshr_b32 s35, s32, 1
    s_lshl_b32 s35, s35, 2
    s_lshr_b32 s49, s48, 3
    s_add_u32 s35, s35, s49
    s_lshl_b32 s33, s35, 1
    s_add_u32 s33, s33, s34
    s_lshl_b32 s34, s34, 3
    s_add_u32 s34, s34, s39
    s_and_b32 s37, s33, 7
    s_lshr_b32 s36, s33, 3
    s_lshl_b32 s38, s36, 3
    s_add_u32 s38, s38, s39
    s_lshl_b32 s32, s32, 5
    s_add_u32 s32, s32, s48
    s_lshl_b32 s50, s37, 2
    s_add_u32 s50, s50, s3
    s_lshl_b32 s50, s50, 5
    s_add_u32 s50, s50, s38
    s_lshl_b32 s50, s50, 10
    s_add_u32 s51, s50, 1048576
    s_waitcnt lgkmcnt(0)
    s_mov_b32 s12, s24
    s_and_b32 s13, s25, 0xffff
    s_mov_b32 s14, 0x200000
    s_mov_b32 s15, 0x20000
    buffer_load_dwordx4 v[8:11], v2, s[12:15], s50 offen
    buffer_load_dwordx4 v[12:15], v2, s[12:15], s51 offen
    s_mov_b32 s8, s6
    s_and_b32 s9, s7, 0xffff
    s_mov_b32 s10, 0x1600000
    s_mov_b32 s11, 0x20000
    v_lshrrev_b32 v3, 4, v1
    v_and_b32 v4, 15, v1
    v_lshlrev_b32 v5, 4, v0
    v_mov_b32 v120, -1
    v_mov_b32 v121, -1
    v_mov_b32 v122, -1
    v_mov_b32 v123, -1
    s_lshl_b32 s6, s2, 13
    s_add_u32 s6, s6, 4194304
    s_add_u32 s7, s6, 4096
    buffer_store_dwordx4 v[120:123], v5, s[8:11], s6 offen
    buffer_store_dwordx4 v[120:123], v5, s[8:11], s7 offen
    s_lshr_b32 s41, s38, 4
    s_lshl_b32 s41, s41, 3
    s_add_u32 s41, s41, s37
    s_lshl_b32 s41, s41, 4
    s_and_b32 s42, s38, 15
    s_add_u32 s41, s41, s42
    s_lshl_b32 s41, s41, 13
    s_lshl_b32 s24, s3, 11
    s_add_u32 s41, s41, s24
    s_add_u32 s25, s24, 16384
    v_lshlrev_b32 v134, 5, v1
    v_add_u32 v134, s25, v134
    v_add_u32 v135, s25, v2
    s_lshl_b32 s29, s3, 12
    v_add_u32 v128, s29, v2
    v_lshlrev_b32 v130, 2, v4
    v_lshl_add_u32 v130, v3, 9, v130
    v_add_u32 v130, s29, v130
    v_add_u32 v131, 2048, v130
    v_lshlrev_b32 v129, 3, v4
    v_lshl_add_u32 v129, v3, 8, v129
    v_add_u32 v129, s29, v129
    v_lshlrev_b32 v132, 2, v0
    v_sub_u32 v133, 512, v0
    v_cmp_eq_u32 s[28:29], 0, v0
    v_mov_b32 v6, 256
    s_nop 0
    v_cndmask_b32 v133, v133, v6, s[28:29]
    v_lshlrev_b32 v133, 2, v133
    s_waitcnt vmcnt(4)
    s_barrier
    ds_read_b128 v[16:19], v2 offset:24576
    ds_read_b128 v[20:23], v2 offset:25600
    ds_read_b128 v[24:27], v2 offset:26624
    ds_read_b128 v[28:31], v2 offset:27648
    ds_read_b128 v[32:35], v2 offset:28672
    ds_read_b128 v[36:39], v2 offset:29696
    ds_read_b128 v[40:43], v2 offset:30720
    ds_read_b128 v[44:47], v2 offset:31744
    ds_read_b128 v[48:51], v2 offset:32768
    ds_read_b128 v[52:55], v2 offset:33792
    ds_read_b128 v[56:59], v2 offset:34816
    ds_read_b128 v[60:63], v2 offset:35840
    s_waitcnt vmcnt(3)
    v_lshlrev_b32 v64, 16, v8
    v_and_b32 v65, 0xffff0000, v8
    v_lshlrev_b32 v66, 16, v9
    v_and_b32 v67, 0xffff0000, v9
    v_lshlrev_b32 v68, 16, v10
    v_and_b32 v69, 0xffff0000, v10
    v_lshlrev_b32 v70, 16, v11
    v_and_b32 v71, 0xffff0000, v11
    s_waitcnt vmcnt(2)
    v_lshlrev_b32 v72, 16, v12
    v_and_b32 v73, 0xffff0000, v12
    v_lshlrev_b32 v74, 16, v13
    v_and_b32 v75, 0xffff0000, v13
    v_lshlrev_b32 v76, 16, v14
    v_and_b32 v77, 0xffff0000, v14
    v_lshlrev_b32 v78, 16, v15
    v_and_b32 v79, 0xffff0000, v15
    v_add_f32 v80, v64, v65
    v_add_f32 v81, v72, v73
    v_add_f32 v80, v80, v66
    v_add_f32 v81, v81, v74
    v_add_f32 v80, v80, v67
    v_add_f32 v81, v81, v75
    v_add_f32 v80, v80, v68
    v_add_f32 v81, v81, v76
    v_add_f32 v80, v80, v69
    v_add_f32 v81, v81, v77
    v_add_f32 v80, v80, v70
    v_add_f32 v81, v81, v78
    v_add_f32 v80, v80, v71
    v_add_f32 v81, v81, v79
    s_nop 1
    v_permlane32_swap_b32 v80, v81
    v_add_f32 v80, v80, v81
    v_mov_b32 v82, v80
    s_nop 1
    v_permlane16_swap_b32 v80, v82
    v_add_f32 v80, v80, v82
    s_nop 1
    v_add_f32_dpp v80, v80, v80 quad_perm:[1,0,3,2] row_mask:0xf bank_mask:0xf
    s_nop 1
    v_add_f32_dpp v80, v80, v80 quad_perm:[2,3,0,1] row_mask:0xf bank_mask:0xf
    s_nop 1
    v_add_f32_dpp v80, v80, v80 row_half_mirror row_mask:0xf bank_mask:0xf
    s_nop 1
    v_add_f32_dpp v80, v80, v80 row_mirror row_mask:0xf bank_mask:0xf
    v_mul_f32 v83, 0x3b000000, v80
    v_mov_b32 v85, v83
    v_mov_b32 v84, v83
    s_nop 1
    v_permlane32_swap_b32 v83, v84
    v_sub_f32 v86, v64, v83
    v_sub_f32 v94, v72, v84
    v_sub_f32 v87, v65, v83
    v_sub_f32 v95, v73, v84
    v_sub_f32 v88, v66, v83
    v_sub_f32 v96, v74, v84
    v_sub_f32 v89, v67, v83
    v_sub_f32 v97, v75, v84
    v_sub_f32 v90, v68, v83
    v_sub_f32 v98, v76, v84
    v_sub_f32 v91, v69, v83
    v_sub_f32 v99, v77, v84
    v_sub_f32 v92, v70, v83
    v_sub_f32 v100, v78, v84
    v_sub_f32 v93, v71, v83
    v_sub_f32 v101, v79, v84
    v_mul_f32 v80, v86, v86
    v_mul_f32 v81, v94, v94
    v_fmac_f32 v80, v87, v87
    v_fmac_f32 v81, v95, v95
    v_fmac_f32 v80, v88, v88
    v_fmac_f32 v81, v96, v96
    v_fmac_f32 v80, v89, v89
    v_fmac_f32 v81, v97, v97
    v_fmac_f32 v80, v90, v90
    v_fmac_f32 v81, v98, v98
    v_fmac_f32 v80, v91, v91
    v_fmac_f32 v81, v99, v99
    v_fmac_f32 v80, v92, v92
    v_fmac_f32 v81, v100, v100
    v_fmac_f32 v80, v93, v93
    v_fmac_f32 v81, v101, v101
    v_cvt_pk_bf16_f32 v85, v85, v85
    v_lshlrev_b32 v85, 16, v85
    v_mov_b32 v83, v85
    v_mov_b32 v84, v83
    s_nop 1
    v_permlane32_swap_b32 v83, v84
    v_permlane32_swap_b32 v80, v81
    v_add_f32 v80, v80, v81
    v_mov_b32 v82, v80
    s_nop 1
    v_permlane16_swap_b32 v80, v82
    v_add_f32 v80, v80, v82
    s_nop 1
    v_add_f32_dpp v80, v80, v80 quad_perm:[1,0,3,2] row_mask:0xf bank_mask:0xf
    s_nop 1
    v_add_f32_dpp v80, v80, v80 quad_perm:[2,3,0,1] row_mask:0xf bank_mask:0xf
    s_nop 1
    v_add_f32_dpp v80, v80, v80 row_half_mirror row_mask:0xf bank_mask:0xf
    s_nop 1
    v_add_f32_dpp v80, v80, v80 row_mirror row_mask:0xf bank_mask:0xf
    v_sub_f32 v86, v64, v83
    v_sub_f32 v94, v72, v84
    v_sub_f32 v87, v65, v83
    v_sub_f32 v95, v73, v84
    v_sub_f32 v88, v66, v83
    v_sub_f32 v96, v74, v84
    v_sub_f32 v89, v67, v83
    v_sub_f32 v97, v75, v84
    v_sub_f32 v90, v68, v83
    v_sub_f32 v98, v76, v84
    v_sub_f32 v91, v69, v83
    v_sub_f32 v99, v77, v84
    v_sub_f32 v92, v70, v83
    v_sub_f32 v100, v78, v84
    v_sub_f32 v93, v71, v83
    v_sub_f32 v101, v79, v84
    v_mul_f32 v80, 0x3b000000, v80
    v_cvt_pk_bf16_f32 v80, v80, v80
    v_lshlrev_b32 v80, 16, v80
    v_add_f32 v80, 0x3727c5ac, v80
    v_cvt_pk_bf16_f32 v80, v80, v80
    v_lshlrev_b32 v80, 16, v80
    v_sqrt_f32 v80, v80
    s_nop 0
    v_cvt_pk_bf16_f32 v80, v80, v80
    v_lshlrev_b32 v80, 16, v80
    v_rcp_f32 v80, v80
    v_cvt_pk_bf16_f32 v86, v86, v87
    v_cvt_pk_bf16_f32 v88, v88, v89
    v_cvt_pk_bf16_f32 v90, v90, v91
    v_cvt_pk_bf16_f32 v92, v92, v93
    v_cvt_pk_bf16_f32 v94, v94, v95
    v_cvt_pk_bf16_f32 v96, v96, v97
    v_cvt_pk_bf16_f32 v98, v98, v99
    v_cvt_pk_bf16_f32 v100, v100, v101
    v_mov_b32 v81, v80
    s_nop 1
    v_permlane32_swap_b32 v80, v81
    v_and_b32 v87, 0xffff0000, v86
    v_lshlrev_b32 v86, 16, v86
    v_and_b32 v89, 0xffff0000, v88
    v_lshlrev_b32 v88, 16, v88
    v_and_b32 v91, 0xffff0000, v90
    v_lshlrev_b32 v90, 16, v90
    v_and_b32 v93, 0xffff0000, v92
    v_lshlrev_b32 v92, 16, v92
    v_and_b32 v95, 0xffff0000, v94
    v_lshlrev_b32 v94, 16, v94
    v_and_b32 v97, 0xffff0000, v96
    v_lshlrev_b32 v96, 16, v96
    v_and_b32 v99, 0xffff0000, v98
    v_lshlrev_b32 v98, 16, v98
    v_and_b32 v101, 0xffff0000, v100
    v_lshlrev_b32 v100, 16, v100
    v_mul_f32 v86, v86, v80
    v_mul_f32 v94, v94, v81
    v_mul_f32 v87, v87, v80
    v_mul_f32 v95, v95, v81
    v_mul_f32 v88, v88, v80
    v_mul_f32 v96, v96, v81
    v_mul_f32 v89, v89, v80
    v_mul_f32 v97, v97, v81
    v_mul_f32 v90, v90, v80
    v_mul_f32 v98, v98, v81
    v_mul_f32 v91, v91, v80
    v_mul_f32 v99, v99, v81
    v_mul_f32 v92, v92, v80
    v_mul_f32 v100, v100, v81
    v_mul_f32 v93, v93, v80
    v_mul_f32 v101, v101, v81
    v_cvt_pk_bf16_f32 v8, v86, v87
    v_cvt_pk_bf16_f32 v12, v94, v95
    v_cvt_pk_bf16_f32 v9, v88, v89
    v_cvt_pk_bf16_f32 v13, v96, v97
    v_cvt_pk_bf16_f32 v10, v90, v91
    v_cvt_pk_bf16_f32 v14, v98, v99
    v_cvt_pk_bf16_f32 v11, v92, v93
    v_cvt_pk_bf16_f32 v15, v100, v101
    ds_write_b128 v128, v[8:11]
    ds_write_b128 v128, v[12:15] offset:1024
    s_waitcnt lgkmcnt(0)
    ds_read_b64_tr_b16 v[64:65], v129
    ds_read_b64_tr_b16 v[66:67], v129 offset:128
    ds_read_b64_tr_b16 v[68:69], v129 offset:1024
    ds_read_b64_tr_b16 v[70:71], v129 offset:1152
    s_waitcnt lgkmcnt(2)
    v_mfma_f32_16x16x32_bf16 v[104:107], v[64:67], v[16:19], 0
    v_mfma_f32_16x16x32_bf16 v[108:111], v[64:67], v[20:23], 0
    v_mfma_f32_16x16x32_bf16 v[112:115], v[64:67], v[28:31], 0
    v_mfma_f32_16x16x32_bf16 v[116:119], v[64:67], v[32:35], 0
    s_waitcnt lgkmcnt(0)
    v_mfma_f32_16x16x32_bf16 v[104:107], v[68:71], v[24:27], v[104:107]
    v_mfma_f32_16x16x32_bf16 v[108:111], v[68:71], v[16:19], v[108:111]
    v_mfma_f32_16x16x32_bf16 v[112:115], v[68:71], v[36:39], v[112:115]
    v_mfma_f32_16x16x32_bf16 v[116:119], v[68:71], v[28:31], v[116:119]
    s_nop 4
    v_mul_f32 v80, v104, v40
    v_mul_f32 v84, v108, v40
    v_fma_f32 v80, -v108, v44, v80
    v_fma_f32 v84, v104, v44, v84
    v_mul_f32 v81, v105, v41
    v_mul_f32 v85, v109, v41
    v_fma_f32 v81, -v109, v45, v81
    v_fma_f32 v85, v105, v45, v85
    v_mul_f32 v82, v106, v42
    v_mul_f32 v86, v110, v42
    v_fma_f32 v82, -v110, v46, v82
    v_fma_f32 v86, v106, v46, v86
    v_mul_f32 v83, v107, v43
    v_mul_f32 v87, v111, v43
    v_fma_f32 v83, -v111, v47, v83
    v_fma_f32 v87, v107, v47, v87
    v_cvt_pk_bf16_f32 v120, v80, v81
    v_cvt_pk_bf16_f32 v121, v82, v83
    v_cvt_pk_bf16_f32 v122, v84, v85
    v_cvt_pk_bf16_f32 v123, v86, v87
    v_mul_f32 v88, v112, v48
    v_mul_f32 v92, v116, v48
    v_fma_f32 v88, -v116, v52, v88
    v_fma_f32 v92, v112, v52, v92
    v_mul_f32 v89, v113, v49
    v_mul_f32 v93, v117, v49
    v_fma_f32 v89, -v117, v53, v89
    v_fma_f32 v93, v113, v53, v93
    v_mul_f32 v90, v114, v50
    v_mul_f32 v94, v118, v50
    v_fma_f32 v90, -v118, v54, v90
    v_fma_f32 v94, v114, v54, v94
    v_mul_f32 v91, v115, v51
    v_mul_f32 v95, v119, v51
    v_fma_f32 v91, -v119, v55, v91
    v_fma_f32 v95, v115, v55, v95
    v_cvt_pk_bf16_f32 v124, v88, v89
    v_cvt_pk_bf16_f32 v125, v90, v91
    v_cvt_pk_bf16_f32 v126, v92, v93
    v_cvt_pk_bf16_f32 v127, v94, v95
    v_mfma_f32_16x16x32_bf16 v[104:107], v[56:59], v[120:123], 0
    v_mfma_f32_16x16x32_bf16 v[108:111], v[60:63], v[120:123], 0
    v_mfma_f32_16x16x32_bf16 v[112:115], v[56:59], v[124:127], 0
    v_mfma_f32_16x16x32_bf16 v[116:119], v[60:63], v[124:127], 0
    s_nop 6
    ds_write2_b32 v130, v104, v112 offset0:0 offset1:16
    ds_write2_b32 v131, v108, v116 offset0:0 offset1:16
    ds_write2_b32 v130, v105, v113 offset0:32 offset1:48
    ds_write2_b32 v131, v109, v117 offset0:32 offset1:48
    ds_write2_b32 v130, v106, v114 offset0:64 offset1:80
    ds_write2_b32 v131, v110, v118 offset0:64 offset1:80
    ds_write2_b32 v130, v107, v115 offset0:96 offset1:112
    ds_write2_b32 v131, v111, v119 offset0:96 offset1:112
    s_waitcnt lgkmcnt(0)
    s_barrier
    ds_read2st64_b32 v[16:17], v132 offset0:0 offset1:8
    ds_read2st64_b32 v[24:25], v133 offset0:0 offset1:8
    ds_read2st64_b32 v[18:19], v132 offset0:16 offset1:24
    ds_read2st64_b32 v[26:27], v133 offset0:16 offset1:24
    ds_read2st64_b32 v[20:21], v132 offset0:32 offset1:40
    ds_read2st64_b32 v[28:29], v133 offset0:32 offset1:40
    ds_read2st64_b32 v[22:23], v132 offset0:48 offset1:56
    ds_read2st64_b32 v[30:31], v133 offset0:48 offset1:56
    s_waitcnt lgkmcnt(6)
    v_cndmask_b32 v84, v24, v16, s[28:29]
    v_cndmask_b32 v85, v17, v24, s[28:29]
    v_cndmask_b32 v86, v25, -v24, s[28:29]
    v_cndmask_b32 v87, v25, v17, s[28:29]
    v_add_f32 v80, v16, v84
    v_sub_f32 v81, v85, v86
    v_add_f32 v82, v17, v87
    v_cndmask_b32 v84, v16, -v25, s[28:29]
    v_cndmask_b32 v85, v24, v25, s[28:29]
    v_sub_f32 v83, v84, v85
    v_cvt_pk_bf16_f32 v8, v80, v81
    v_cvt_pk_bf16_f32 v12, -v82, v83
    s_waitcnt lgkmcnt(4)
    v_cndmask_b32 v92, v26, v18, s[28:29]
    v_cndmask_b32 v93, v19, v26, s[28:29]
    v_cndmask_b32 v94, v27, -v26, s[28:29]
    v_cndmask_b32 v95, v27, v19, s[28:29]
    v_add_f32 v88, v18, v92
    v_sub_f32 v89, v93, v94
    v_add_f32 v90, v19, v95
    v_cndmask_b32 v92, v18, -v27, s[28:29]
    v_cndmask_b32 v93, v26, v27, s[28:29]
    v_sub_f32 v91, v92, v93
    v_cvt_pk_bf16_f32 v9, v88, v89
    v_cvt_pk_bf16_f32 v13, -v90, v91
    s_waitcnt lgkmcnt(2)
    v_cndmask_b32 v84, v28, v20, s[28:29]
    v_cndmask_b32 v85, v21, v28, s[28:29]
    v_cndmask_b32 v86, v29, -v28, s[28:29]
    v_cndmask_b32 v87, v29, v21, s[28:29]
    v_add_f32 v80, v20, v84
    v_sub_f32 v81, v85, v86
    v_add_f32 v82, v21, v87
    v_cndmask_b32 v84, v20, -v29, s[28:29]
    v_cndmask_b32 v85, v28, v29, s[28:29]
    v_sub_f32 v83, v84, v85
    v_cvt_pk_bf16_f32 v10, v80, v81
    v_cvt_pk_bf16_f32 v14, -v82, v83
    s_waitcnt lgkmcnt(0)
    v_cndmask_b32 v92, v30, v22, s[28:29]
    v_cndmask_b32 v93, v23, v30, s[28:29]
    v_cndmask_b32 v94, v31, -v30, s[28:29]
    v_cndmask_b32 v95, v31, v23, s[28:29]
    v_add_f32 v88, v22, v92
    v_sub_f32 v89, v93, v94
    v_add_f32 v90, v23, v95
    v_cndmask_b32 v92, v22, -v31, s[28:29]
    v_cndmask_b32 v93, v30, v31, s[28:29]
    v_sub_f32 v91, v92, v93
    v_cvt_pk_bf16_f32 v11, v88, v89
    v_cvt_pk_bf16_f32 v15, -v90, v91
    ds_write_b128 v134, v[8:11]
    ds_write_b128 v134, v[12:15] offset:16
    s_waitcnt lgkmcnt(0)
    ds_read_b128 v[8:11], v135
    ds_read_b128 v[12:15], v135 offset:1024
    s_waitcnt lgkmcnt(1)
    buffer_store_dwordx4 v[8:11], v2, s[8:11], s41 offen
    s_waitcnt lgkmcnt(0)
    buffer_store_dwordx4 v[12:15], v2, s[8:11], s41 offen offset:1024
    s_endpgm
k1_side:
    s_cmp_ge_u32 s2, 512
    s_cbranch_scc1 k1_end
    s_load_dwordx4 s[24:27], s[0:1], 8
    s_load_dwordx4 s[28:31], s[0:1], 32
    s_load_dwordx2 s[6:7], s[0:1], 64
    s_sub_u32 s40, s2, 256
    v_lshrrev_b32 v2, 6, v0
    v_and_b32 v1, 63, v0
    v_readfirstlane_b32 s3, v2
    v_lshlrev_b32 v2, 4, v1
    v_lshlrev_b32 v3, 3, v1
    v_lshrrev_b32 v4, 4, v1
    v_and_b32 v5, 15, v1
    v_lshlrev_b32 v6, 4, v0
    s_getpc_b64 s[72:73]
    s_add_u32 s72, s72, tabm@rel32@lo+4
    s_addc_u32 s73, s73, tabm@rel32@hi+12
    s_and_b32 s73, s73, 0xffff
    s_mov_b32 s74, 0xb000
    s_mov_b32 s75, 0x20000
    s_getpc_b64 s[12:13]
    s_add_u32 s12, s12, km_kernel@rel32@lo+4
    s_addc_u32 s13, s13, km_kernel@rel32@hi+12
    s_and_b32 s13, s13, 0xffff
    s_mov_b32 s14, 0x0
    s_mov_b32 s15, 0x20000
    s_mov_b32 s14, km_end-km_kernel
    s_lshr_b32 s16, s40, 3
    s_lshl_b32 s16, s16, 2
    s_add_u32 s16, s16, s3
    s_lshl_b32 s16, s16, 10
    s_sub_u32 s17, 130048, s16
    v_lshlrev_b32 v7, 7, v1
    s_mov_b64 exec, 0xff
    buffer_load_dword v68, v7, s[72:75], s16 offen
    buffer_load_dword v69, v7, s[12:15], s17 offen
    s_mov_b64 exec, -1
    s_and_b32 s53, s40, 3
    s_andn2_b32 s52, s40, 3
    s_add_u32 s52, s52, s3
    s_and_b32 s54, s52, 15
    s_bfe_u32 s55, s52, 65542
    s_lshl_b32 s55, s55, 4
    s_add_u32 s54, s54, s55
    s_lshl_b32 s54, s54, 1
    s_lshr_b32 s55, s52, 7
    s_add_u32 s54, s54, s55
    s_bfe_u32 s55, s52, 131076
    s_lshl_b32 s55, s55, 8
    s_add_u32 s54, s54, s55
    v_bfe_u32 v9, v1, 3, 2
    v_lshrrev_b32 v7, 5, v1
    v_lshl_add_u32 v9, v7, 4, v9
    v_mul_u32_u24 v9, 32896, v9
    v_and_b32 v14, 7, v1
    v_lshl_add_u32 v9, v14, 4, v9
    v_mul_u32_u24 v12, 1184, v14
    v_lshrrev_b32 v7, 3, v1
    v_lshl_add_u32 v12, v7, 2, v12
    s_lshl_b32 s55, s3, 5
    v_add_u32 v12, s55, v12
    v_lshrrev_b32 v10, 3, v0
    v_mul_u32_u24 v11, 144, v10
    v_lshl_add_u32 v11, v14, 4, v11
    v_lshrrev_b32 v7, 6, v0
    v_lshl_add_u32 v11, v7, 5, v11
    v_lshlrev_b32 v10, 13, v10
    v_lshl_add_u32 v10, v14, 4, v10
    v_lshlrev_b32 v14, 2, v14
    s_cmp_eq_u32 s53, 0
    s_cselect_b32 s41, 0, 9600
    s_add_u32 s41, s41, s55
    v_add_u32 v13, s41, v14
    v_and_b32 v15, 3, v1
    v_bfe_u32 v7, v1, 2, 1
    v_lshl_add_u32 v15, v7, 4, v15
    v_lshlrev_b32 v15, 6, v15
    v_add_u32 v15, s54, v15
    v_sub_u32 v7, 2048, v15
    v_and_b32 v7, 2047, v7
    v_and_b32 v8, 8, v1
    v_cmp_ne_u32 vcc, 0, v8
    s_nop 1
    v_cndmask_b32 v15, v15, v7, vcc
    v_mul_u32_u24 v15, 514, v15
    v_bfe_u32 v7, v1, 4, 1
    v_lshl_add_u32 v15, v7, 9, v15
    s_mul_i32 s54, s54, 514
    s_lshl_b32 s55, s53, 7
    s_add_u32 s54, s54, s55
    v_mul_u32_u24 v16, 3584, v4
    v_lshl_add_u32 v16, v5, 4, v16
    v_lshlrev_b32 v18, 10, v4
    v_lshl_add_u32 v18, v5, 4, v18
    v_lshlrev_b32 v17, 14, v4
    v_lshl_add_u32 v17, v5, 4, v17
    s_mul_i32 s55, s3, 4608
    s_add_u32 s55, s55, 10240
    v_mul_u32_u24 v19, 272, v4
    v_lshl_add_u32 v19, v5, 4, v19
    v_add_u32 v19, s55, v19
    v_lshrrev_b32 v7, 2, v5
    v_mul_u32_u24 v7, 272, v7
    v_add_u32 v7, s55, v7
    v_and_b32 v8, 3, v5
    v_lshl_add_u32 v20, v4, 5, v7
    v_lshl_add_u32 v20, v8, 3, v20
    v_lshl_add_u32 v21, v4, 3, v7
    v_lshl_add_u32 v21, v8, 5, v21
    s_waitcnt lgkmcnt(0)
    s_mov_b32 s56, s24
    s_and_b32 s57, s25, 0xffff
    s_mov_b32 s58, 0x101000
    s_mov_b32 s59, 0x20000
    s_mov_b32 s60, s26
    s_and_b32 s61, s27, 0xffff
    s_mov_b32 s62, 0x101000
    s_mov_b32 s63, 0x20000
    s_mov_b32 s64, s28
    s_and_b32 s65, s29, 0xffff
    s_mov_b32 s66, 0x1c0000
    s_mov_b32 s67, 0x20000
    s_mov_b32 s68, s30
    s_and_b32 s69, s31, 0xffff
    s_mov_b32 s70, 0x1c0000
    s_mov_b32 s71, 0x20000
    s_mov_b32 s8, s6
    s_and_b32 s9, s7, 0xffff
    s_mov_b32 s10, 0x1600000
    s_mov_b32 s11, 0x20000
    buffer_load_dwordx4 v[24:27], v9, s[56:59], s54 offen
    buffer_load_dwordx4 v[28:31], v9, s[60:63], s54 offen
    buffer_load_ushort v40, v15, s[56:59], 0 offen
    buffer_load_ushort v41, v15, s[60:63], 0 offen
    s_lshl_b32 s26, s40, 2
    s_add_u32 s26, s26, s3
    s_mul_i32 s27, s26, 4682
    s_lshr_b32 s27, s27, 16
    s_mul_i32 s28, s27, 14
    s_sub_u32 s28, s26, s28
    s_mul_i32 s29, s27, 28672
    s_lshl_b32 s30, s28, 8
    s_add_u32 s29, s29, s30
    s_lshl_b32 s30, s28, 17
    s_lshl_b32 s31, s27, 8
    s_add_u32 s30, s30, s31
    s_add_u32 s30, s30, 10485760
    s_add_u32 s24, s29, 14336
    buffer_load_dwordx4 v[48:51], v16, s[64:67], s29 offen
    buffer_load_dwordx4 v[52:55], v16, s[64:67], s24 offen
    s_and_b32 s27, s26, 3
    s_lshr_b32 s28, s26, 4
    s_bfe_u32 s29, s26, 131074
    s_lshl_b32 s16, s28, 15
    s_lshl_b32 s17, s29, 12
    s_add_u32 s16, s16, s17
    s_lshl_b32 s17, s27, 8
    s_add_u32 s16, s16, s17
    s_mul_i32 s31, s27, 458752
    s_lshl_b32 s28, s28, 12
    s_add_u32 s31, s31, s28
    s_lshl_b32 s29, s29, 8
    s_add_u32 s31, s31, s29
    s_add_u32 s31, s31, 12320768
    s_add_u32 s24, s16, 16384
    buffer_load_dwordx4 v[56:59], v18, s[68:71], s16 offen
    buffer_load_dwordx4 v[60:63], v18, s[68:71], s24 offen
    s_cmp_ge_u32 s26, 896
    s_cselect_b32 s26, 268435456, 0
    s_add_u32 s30, s30, s26
    s_add_u32 s31, s31, s26
    s_lshl_b32 s52, s52, 5
    s_add_u32 s52, s52, 21495808
    s_lshl_b32 s29, s53, 28
    s_add_u32 s52, s52, s29
    s_lshr_b32 s24, s40, 2
    s_lshl_b32 s24, s24, 7
    s_lshl_b32 s53, s53, 19
    s_add_u32 s53, s53, s24
    s_add_u32 s53, s53, 2097152
    s_add_u32 s54, s53, 262144
    s_mov_b32 s24, 0x05040100
    s_mov_b32 s25, 0x07060302
    s_waitcnt vmcnt(6)
    v_perm_b32 v32, v28, v24, s24
    v_perm_b32 v33, v28, v24, s25
    v_perm_b32 v34, v29, v25, s24
    v_perm_b32 v35, v29, v25, s25
    v_perm_b32 v36, v30, v26, s24
    v_perm_b32 v37, v30, v26, s25
    v_perm_b32 v38, v31, v27, s24
    v_perm_b32 v39, v31, v27, s25
    ds_write_b32 v12, v32 offset:0
    ds_write_b32 v12, v33 offset:144
    ds_write_b32 v12, v34 offset:288
    ds_write_b32 v12, v35 offset:432
    ds_write_b32 v12, v36 offset:576
    ds_write_b32 v12, v37 offset:720
    ds_write_b32 v12, v38 offset:864
    ds_write_b32 v12, v39 offset:1008
    s_waitcnt vmcnt(5)
    v_lshlrev_b32 v40, 16, v40
    s_waitcnt vmcnt(4)
    v_lshlrev_b32 v41, 16, v41
    v_add_f32_dpp v42, v40, v40 row_ror:8 row_mask:0xf bank_mask:0xf
    s_nop 0
    v_subrev_f32_dpp v43, v41, v41 row_ror:8 row_mask:0xf bank_mask:0xf
    v_mov_b32 v44, v42
    v_mov_b32 v45, v43
    s_nop 0
    v_permlane16_swap_b32 v42, v44
    v_permlane16_swap_b32 v43, v45
    v_add_f32 v40, v42, v44
    v_add_f32 v41, v43, v45
    v_sub_f32 v42, v42, v44
    v_sub_f32 v43, v43, v45
    v_mul_f32 v40, 0x3e800000, v40
    v_mul_f32 v41, 0x3e800000, v41
    v_mul_f32 v42, 0x3e800000, v42
    v_mul_f32 v43, 0x3e800000, v43
    v_cvt_pk_bf16_f32 v40, v40, v41
    v_cvt_pk_bf16_f32 v41, v42, v43
    s_mov_b64 exec, 0xff
    ds_write_b32 v13, v40
    buffer_store_dword v41, v14, s[8:11], s52 offen
    s_mov_b64 exec, -1
    s_waitcnt lgkmcnt(0)
    s_barrier
    ds_read_b128 v[24:27], v11
    ds_read_b128 v[28:31], v11 offset:4736
    s_waitcnt vmcnt(4)
    ds_write_b128 v19, v[48:51]
    s_waitcnt vmcnt(3)
    ds_write_b128 v19, v[52:55] offset:1088
    s_waitcnt vmcnt(2)
    ds_write_b128 v19, v[56:59] offset:2304
    s_waitcnt vmcnt(1)
    ds_write_b128 v19, v[60:63] offset:3392
    s_waitcnt lgkmcnt(5)
    buffer_store_dwordx4 v[24:27], v10, s[8:11], s53 offen
    s_waitcnt lgkmcnt(4)
    buffer_store_dwordx4 v[28:31], v10, s[8:11], s54 offen
    s_waitcnt lgkmcnt(0)
    ds_read_b64_tr_b16 v[48:49], v20 offset:0
    ds_read_b64_tr_b16 v[50:51], v20 offset:1088
    ds_read_b64_tr_b16 v[52:53], v20 offset:128
    ds_read_b64_tr_b16 v[54:55], v20 offset:1216
    ds_read_b64_tr_b16 v[56:57], v21 offset:2304
    ds_read_b64_tr_b16 v[58:59], v21 offset:3392
    ds_read_b64_tr_b16 v[60:61], v21 offset:2432
    ds_read_b64_tr_b16 v[62:63], v21 offset:3520
    s_add_u32 s24, s30, 65536
    s_add_u32 s25, s31, 229376
    s_waitcnt lgkmcnt(6)
    buffer_store_dwordx4 v[48:51], v17, s[8:11], s30 offen
    s_waitcnt lgkmcnt(4)
    buffer_store_dwordx4 v[52:55], v17, s[8:11], s24 offen
    s_waitcnt lgkmcnt(2)
    buffer_store_dwordx4 v[56:59], v18, s[8:11], s31 offen
    s_waitcnt lgkmcnt(0)
    buffer_store_dwordx4 v[60:63], v18, s[8:11], s25 offen
k1_end:
    s_endpgm
.globl km_kernel
.p2align 8
.type km_kernel,@function
km_kernel:
    s_cmp_ge_u32 s2, 256
    s_cbranch_scc1 km_end
    s_mov_b32 s101, 0
    s_load_dwordx2 s[24:25], s[0:1], 0
    s_load_dwordx2 s[30:31], s[0:1], 48
    s_load_dwordx2 s[6:7], s[0:1], 64
    v_lshrrev_b32 v2, 6, v0
    v_and_b32 v1, 63, v0
    v_readfirstlane_b32 s3, v2
    s_getpc_b64 s[20:21]
    s_add_u32 s20, s20, tabm@rel32@lo+4
    s_addc_u32 s21, s21, tabm@rel32@hi+12
    s_and_b32 s21, s21, 0xffff
    s_mov_b32 s22, 0xb000
    s_mov_b32 s23, 0x20000
    v_lshlrev_b32 v2, 4, v1
    s_mul_i32 s4, s3, 6144
    s_add_u32 s4, s4, 20480
    s_add_u32 s5, s4, 2048
    buffer_load_dwordx4 v[148:151], v2, s[20:23], s4 offen offset:0
    buffer_load_dwordx4 v[156:159], v2, s[20:23], s4 offen offset:1024
    s_mul_i32 s60, s3, 5120
    s_add_u32 s61, s60, 143360
    s_mov_b32 m0, s61
    s_nop 0
    buffer_load_dwordx4 v2, s[20:23], s60 offen offset:0 lds
    buffer_load_dwordx4 v2, s[20:23], s60 offen offset:1024 lds
    buffer_load_dwordx4 v2, s[20:23], s60 offen offset:2048 lds
    buffer_load_dwordx4 v2, s[20:23], s60 offen offset:3072 lds
    s_add_u32 s60, s60, 4096
    s_add_u32 m0, m0, 4096
    s_nop 0
    buffer_load_dwordx4 v2, s[20:23], s60 offen lds
    buffer_load_dwordx4 v[180:183], v2, s[20:23], s5 offen offset:0
    buffer_load_dwordx4 v[184:187], v2, s[20:23], s5 offen offset:1024
    buffer_load_dwordx4 v[188:191], v2, s[20:23], s5 offen offset:2048
    buffer_load_dwordx4 v[192:195], v2, s[20:23], s5 offen offset:3072
    v_lshlrev_b32 v3, 3, v1
    v_lshrrev_b32 v4, 4, v1
    v_and_b32 v5, 15, v1
    v_lshlrev_b32 v6, 4, v0
    v_lshlrev_b32 v227, 5, v1
    v_lshlrev_b32 v222, 13, v1
    s_and_b32 s32, s2, 7
    s_lshr_b32 s48, s2, 3
    s_and_b32 s39, s48, 7
    s_and_b32 s34, s32, 1
    s_lshr_b32 s35, s32, 1
    s_lshl_b32 s35, s35, 2
    s_lshr_b32 s49, s48, 3
    s_add_u32 s35, s35, s49
    s_lshl_b32 s33, s35, 1
    s_add_u32 s33, s33, s34
    s_lshl_b32 s34, s34, 3
    s_add_u32 s34, s34, s39
    s_and_b32 s37, s33, 7
    s_lshr_b32 s36, s33, 3
    s_lshl_b32 s38, s36, 3
    s_add_u32 s38, s38, s39
    s_lshl_b32 s32, s32, 5
    s_add_u32 s32, s32, s48
    s_lshl_b32 s50, s37, 2
    s_add_u32 s50, s50, s3
    s_lshl_b32 s50, s50, 5
    s_add_u32 s50, s50, s38
    s_lshl_b32 s50, s50, 10
    s_add_u32 s51, s50, 1048576
    s_lshl_b32 s56, s32, 5
    s_lshl_b32 s57, s3, 19
    s_add_u32 s56, s56, s57
    s_add_u32 s57, s56, 16
    s_lshl_b32 s58, s3, 11
    s_add_u32 s58, s58, 131072
    s_lshr_b32 s59, s3, 1
    s_lshl_b32 s59, s59, 10
    s_add_u32 s59, s59, 131072
    v_add_u32 v235, s59, v2
    s_waitcnt lgkmcnt(0)
    s_mov_b32 s8, s6
    s_and_b32 s9, s7, 0xffff
    s_mov_b32 s10, 0x1600000
    s_mov_b32 s11, 0x20000
    s_mov_b32 s16, s30
    s_and_b32 s17, s31, 0xffff
    s_mov_b32 s18, 0x200000
    s_mov_b32 s19, 0x20000
    s_mov_b32 m0, s58
    s_nop 0
    buffer_load_dwordx4 v222, s[8:11], s56 offen lds
    s_add_u32 m0, m0, 1024
    s_nop 0
    buffer_load_dwordx4 v222, s[8:11], s57 offen lds
    s_lshl_b32 s7, s32, 13
    s_lshl_b32 s29, s3, 11
    s_add_u32 s28, s7, s29
    s_add_u32 s28, s28, 2097152
    s_add_u32 s29, s29, 21495808
    buffer_load_dwordx4 v[28:31], v227, s[8:11], s28 offen
    buffer_load_dwordx4 v[32:35], v227, s[8:11], s28 offen offset:16
    s_mov_b32 s12, s24
    s_and_b32 s13, s25, 0xffff
    s_mov_b32 s14, 0x200000
    s_mov_b32 s15, 0x20000
    s_add_u32 s6, s7, 4194304
    s_add_u32 s7, s6, 4096
    s_lshr_b32 s40, s38, 4
    s_lshl_b32 s40, s40, 3
    s_add_u32 s40, s40, s37
    s_lshl_b32 s40, s40, 9
    s_and_b32 s41, s38, 15
    s_lshl_b32 s41, s41, 4
    s_add_u32 s40, s40, s41
    s_add_u32 s40, s40, 4194304
    s_lshl_b32 s52, s3, 6
    s_add_u32 s52, s52, 114688
    v_mul_u32_u24 v223, 1088, v4
    v_lshl_add_u32 v223, v5, 2, v223
    v_add_u32 v223, s52, v223
    v_add_u32 v224, 4352, v223
    v_mul_u32_u24 v225, 272, v5
    v_lshl_add_u32 v225, v4, 4, v225
    v_add_u32 v225, 114688, v225
    v_lshlrev_b32 v226, 6, v5
    v_lshl_add_u32 v226, v4, 4, v226
    v_add_u32 v220, 143360, v2
    s_cmp_lg_u32 s2, 0
    s_cbranch_scc1 km_noab
    buffer_load_dwordx4 v[84:87], v227, s[8:11], s29 offen offset:0
    buffer_load_dwordx4 v[88:91], v227, s[8:11], s29 offen offset:16
km_noab:
    s_lshl_b32 s44, s35, 4
    s_add_u32 s44, s44, s34
    s_lshl_b32 s44, s44, 13
    s_add_u32 s45, s44, 8388608
    s_add_u32 s46, s45, 4096
    s_add_u32 s44, s44, 6291456
    s_lshl_b32 s27, s35, 3
    s_lshl_b32 s28, s3, 1
    s_add_u32 s27, s27, s28
    s_mul_i32 s27, s27, 57344
    s_mul_i32 s28, s34, 7
    s_lshr_b32 s28, s28, 1
    s_lshl_b32 s28, s28, 10
    s_add_u32 s27, s27, s28
    s_add_u32 s27, s27, 14155776
    s_and_b32 s55, s34, 1
    s_mul_i32 s28, s55, 2560
    s_sub_u32 s28, 3072, s28
    s_add_u32 s47, s27, s28
    s_add_u32 s48, s47, 57344
    s_lshl_b32 s28, s55, 10
    s_add_u32 s42, s27, s28
    s_add_u32 s5, s42, 57344
    v_mov_b32 v236, -1
    v_mov_b32 v237, -1
    v_mov_b32 v238, -1
    v_mov_b32 v239, -1
    buffer_store_dwordx4 v[236:239], v6, s[8:11], s45 offen sc1
    buffer_store_dwordx4 v[236:239], v6, s[8:11], s46 offen sc1
    s_mul_i32 s62, s3, 28672
    s_mul_i32 s63, s34, 114688
    s_add_u32 s63, s63, 10485760
    s_lshl_b32 s61, s49, 1
    s_and_b32 s26, s3, 1
    s_lshl_b32 s26, s26, 5
    s_lshr_b32 s27, s3, 1
    s_add_u32 s26, s26, s27
    v_lshlrev_b32 v36, 1, v5
    v_add_u32 v36, s26, v36
    v_cvt_f32_u32 v36, v36
    v_mul_f32 v36, 0x3a000000, v36
    v_lshlrev_b32 v37, 2, v4
    v_cvt_f32_u32 v37, v37
    v_mul_f32 v37, v36, v37
    v_fmamk_f32 v52, v36, 0x0, v37
    v_fmamk_f32 v53, v36, 0x3f800000, v37
    v_fmamk_f32 v54, v36, 0x40000000, v37
    v_fmamk_f32 v55, v36, 0x40400000, v37
    v_fmamk_f32 v56, v36, 0x41800000, v37
    v_fmamk_f32 v57, v36, 0x41880000, v37
    v_fmamk_f32 v58, v36, 0x41900000, v37
    v_fmamk_f32 v59, v36, 0x41980000, v37
    v_cos_f32 v164, v52
    v_sin_f32 v168, v52
    v_cos_f32 v165, v53
    v_sin_f32 v169, v53
    v_cos_f32 v166, v54
    v_sin_f32 v170, v54
    v_cos_f32 v167, v55
    v_sin_f32 v171, v55
    v_cos_f32 v172, v56
    v_sin_f32 v176, v56
    v_cos_f32 v173, v57
    v_sin_f32 v177, v57
    v_cos_f32 v174, v58
    v_sin_f32 v178, v58
    v_cos_f32 v175, v59
    v_sin_f32 v179, v59
    s_waitcnt vmcnt(16)
    v_alignbit_b32 v152, v148, v148, 16
    v_xor_b32 v152, 0x8000, v152
    v_alignbit_b32 v153, v149, v149, 16
    v_xor_b32 v153, 0x8000, v153
    v_alignbit_b32 v154, v150, v150, 16
    v_xor_b32 v154, 0x8000, v154
    v_alignbit_b32 v155, v151, v151, 16
    v_xor_b32 v155, 0x8000, v155
    s_waitcnt vmcnt(15)
    v_alignbit_b32 v160, v156, v156, 16
    v_xor_b32 v160, 0x8000, v160
    v_alignbit_b32 v161, v157, v157, 16
    v_xor_b32 v161, 0x8000, v161
    v_alignbit_b32 v162, v158, v158, 16
    v_xor_b32 v162, 0x8000, v162
    v_alignbit_b32 v163, v159, v159, 16
    v_xor_b32 v163, 0x8000, v163
    s_waitcnt vmcnt(4)
    s_barrier
    ds_read_b128 v[12:15], v235 offset:0
    ds_read_b128 v[20:23], v235 offset:4096
    ds_read_b128 v[16:19], v235 offset:2048
    ds_read_b128 v[24:27], v235 offset:6144
    ds_read_b128 v[196:199], v220 offset:0
    ds_read_b128 v[200:203], v220 offset:1024
    ds_read_b128 v[204:207], v220 offset:2048
    ds_read_b128 v[208:211], v220 offset:3072
    ds_read_b128 v[212:215], v220 offset:4096
    ds_read_b128 v[216:219], v220 offset:5120
    s_waitcnt lgkmcnt(9)
    v_mfma_f32_16x16x32_bf16 v[36:39], v[12:15], v[148:151], 0
    v_mfma_f32_16x16x32_bf16 v[40:43], v[12:15], v[152:155], 0
    s_waitcnt lgkmcnt(8)
    v_mfma_f32_16x16x32_bf16 v[44:47], v[20:23], v[148:151], 0
    v_mfma_f32_16x16x32_bf16 v[48:51], v[20:23], v[152:155], 0
    s_waitcnt lgkmcnt(7)
    v_mfma_f32_16x16x32_bf16 v[36:39], v[16:19], v[156:159], v[36:39]
    v_mfma_f32_16x16x32_bf16 v[40:43], v[16:19], v[160:163], v[40:43]
    s_waitcnt lgkmcnt(6)
    v_mfma_f32_16x16x32_bf16 v[44:47], v[24:27], v[156:159], v[44:47]
    v_mfma_f32_16x16x32_bf16 v[48:51], v[24:27], v[160:163], v[48:51]
    s_nop 3
    v_mul_f32 v52, v36, v164
    v_mul_f32 v56, v40, v164
    v_fma_f32 v52, v40, v168, v52
    v_fma_f32 v56, -v36, v168, v56
    v_mul_f32 v53, v37, v165
    v_mul_f32 v57, v41, v165
    v_fma_f32 v53, v41, v169, v53
    v_fma_f32 v57, -v37, v169, v57
    v_mul_f32 v54, v38, v166
    v_mul_f32 v58, v42, v166
    v_fma_f32 v54, v42, v170, v54
    v_fma_f32 v58, -v38, v170, v58
    v_mul_f32 v55, v39, v167
    v_mul_f32 v59, v43, v167
    v_fma_f32 v55, v43, v171, v55
    v_fma_f32 v59, -v39, v171, v59
    v_mul_f32 v60, v44, v172
    v_mul_f32 v64, v48, v172
    v_fma_f32 v60, v48, v176, v60
    v_fma_f32 v64, -v44, v176, v64
    v_mul_f32 v61, v45, v173
    v_mul_f32 v65, v49, v173
    v_fma_f32 v61, v49, v177, v61
    v_fma_f32 v65, -v45, v177, v65
    v_mul_f32 v62, v46, v174
    v_mul_f32 v66, v50, v174
    v_fma_f32 v62, v50, v178, v62
    v_fma_f32 v66, -v46, v178, v66
    v_mul_f32 v63, v47, v175
    v_mul_f32 v67, v51, v175
    v_fma_f32 v63, v51, v179, v63
    v_fma_f32 v67, -v47, v179, v67
    v_cvt_pk_bf16_f32 v76, v52, v53
    v_cvt_pk_bf16_f32 v77, v54, v55
    s_lshl_b32 s30, s61, 12
    s_add_u32 s30, s30, s62
    s_mov_b32 m0, s30
    s_lshl_b32 s31, s55, 14
    s_add_u32 s31, s31, s30
    s_cmp_ge_u32 s31, 114688
    s_cselect_b32 s4, 114688, 0
    s_sub_u32 s31, s31, s4
    s_add_u32 s31, s31, s63
    s_add_u32 s61, s61, 1
    s_cmp_eq_u32 s61, 7
    s_cselect_b32 s61, 0, s61
    buffer_load_dwordx4 v2, s[8:11], s31 offen offset:0 lds
    buffer_load_dwordx4 v2, s[8:11], s31 offen offset:1024 lds
    buffer_load_dwordx4 v2, s[8:11], s31 offen offset:2048 lds
    buffer_load_dwordx4 v2, s[8:11], s31 offen offset:3072 lds
    v_cvt_pk_bf16_f32 v78, v60, v61
    v_cvt_pk_bf16_f32 v79, v62, v63
    v_cvt_pk_bf16_f32 v80, v56, v57
    v_cvt_pk_bf16_f32 v81, v58, v59
    v_cvt_pk_bf16_f32 v82, v64, v65
    v_cvt_pk_bf16_f32 v83, v66, v67
    s_waitcnt lgkmcnt(5)
    v_mfma_f32_16x16x32_bf16 v[36:39], v[196:199], v[76:79], 0
    s_waitcnt lgkmcnt(4)
    v_mfma_f32_16x16x32_bf16 v[40:43], v[200:203], v[76:79], 0
    s_waitcnt lgkmcnt(2)
    v_mfma_f32_16x16x32_bf16 v[44:47], v[208:211], v[76:79], 0
    s_waitcnt lgkmcnt(1)
    v_mfma_f32_16x16x32_bf16 v[48:51], v[212:215], v[76:79], 0
    v_mfma_f32_16x16x32_bf16 v[36:39], v[204:207], v[80:83], v[36:39]
    v_mfma_f32_16x16x32_bf16 v[40:43], v[196:199], v[80:83], v[40:43]
    s_waitcnt lgkmcnt(0)
    v_mfma_f32_16x16x32_bf16 v[44:47], v[216:219], v[80:83], v[44:47]
    v_mfma_f32_16x16x32_bf16 v[48:51], v[208:211], v[80:83], v[48:51]
    ds_read_b128 a[224:227], v220 offset:6144
    ds_read_b128 a[228:231], v220 offset:7168
    ds_read_b128 a[232:235], v220 offset:8192
    ds_read_b128 a[236:239], v220 offset:9216
    ds_read_b128 a[240:243], v220 offset:10240
    ds_read_b128 a[244:247], v220 offset:11264
    ds_read_b128 a[248:251], v220 offset:12288
    ds_read_b128 a[252:255], v220 offset:13312
    ds_read_b128 v[116:119], v220 offset:14336
    ds_read_b128 v[120:123], v220 offset:15360
    ds_read_b128 v[124:127], v220 offset:16384
    ds_read_b128 v[128:131], v220 offset:17408
    ds_read_b128 v[132:135], v220 offset:18432
    ds_read_b128 v[136:139], v220 offset:19456
    buffer_load_dwordx4 v[140:143], v226, s[12:15], s50 offen
    buffer_load_dwordx4 v[144:147], v226, s[12:15], s51 offen
    s_waitcnt vmcnt(9)
    v_lshlrev_b32 v12, 16, v28
    v_and_b32 v13, 0xffff0000, v28
    v_lshlrev_b32 v14, 16, v29
    v_and_b32 v15, 0xffff0000, v29
    v_lshlrev_b32 v16, 16, v30
    v_and_b32 v17, 0xffff0000, v30
    v_lshlrev_b32 v18, 16, v31
    v_and_b32 v19, 0xffff0000, v31
    s_waitcnt vmcnt(8)
    v_lshlrev_b32 v20, 16, v32
    v_and_b32 v21, 0xffff0000, v32
    v_lshlrev_b32 v22, 16, v33
    v_and_b32 v23, 0xffff0000, v33
    v_lshlrev_b32 v24, 16, v34
    v_and_b32 v25, 0xffff0000, v34
    v_lshlrev_b32 v26, 16, v35
    v_and_b32 v27, 0xffff0000, v35
    s_cmp_eq_u32 s2, 0
    s_cbranch_scc1 km_special
    v_mul_f32 v52, v36, v12
    v_mul_f32 v56, v40, v12
    v_fma_f32 v52, -v40, v13, v52
    v_fma_f32 v56, v36, v13, v56
    v_mul_f32 v53, v37, v14
    v_mul_f32 v57, v41, v14
    v_fma_f32 v53, -v41, v15, v53
    v_fma_f32 v57, v37, v15, v57
    v_mul_f32 v54, v38, v16
    v_mul_f32 v58, v42, v16
    v_fma_f32 v54, -v42, v17, v54
    v_fma_f32 v58, v38, v17, v58
    v_mul_f32 v55, v39, v18
    v_mul_f32 v59, v43, v18
    v_fma_f32 v55, -v43, v19, v55
    v_fma_f32 v59, v39, v19, v59
    v_mul_f32 v60, v44, v20
    v_mul_f32 v64, v48, v20
    v_fma_f32 v60, -v48, v21, v60
    v_fma_f32 v64, v44, v21, v64
    v_mul_f32 v61, v45, v22
    v_mul_f32 v65, v49, v22
    v_fma_f32 v61, -v49, v23, v61
    v_fma_f32 v65, v45, v23, v65
    v_mul_f32 v62, v46, v24
    v_mul_f32 v66, v50, v24
    v_fma_f32 v62, -v50, v25, v62
    v_fma_f32 v66, v46, v25, v66
    v_mul_f32 v63, v47, v26
    v_mul_f32 v67, v51, v26
    v_fma_f32 v63, -v51, v27, v63
    v_fma_f32 v67, v47, v27, v67
km_filtered:
    v_cvt_pk_bf16_f32 v76, v52, v53
    v_cvt_pk_bf16_f32 v77, v54, v55
    v_cvt_pk_bf16_f32 v78, v60, v61
    v_cvt_pk_bf16_f32 v79, v62, v63
    v_cvt_pk_bf16_f32 v80, v56, v57
    v_cvt_pk_bf16_f32 v81, v58, v59
    v_cvt_pk_bf16_f32 v82, v64, v65
    v_cvt_pk_bf16_f32 v83, v66, v67
    v_mfma_f32_16x16x32_bf16 v[36:39], v[196:199], v[76:79], 0
    v_mfma_f32_16x16x32_bf16 v[40:43], v[204:207], v[76:79], 0
    v_mfma_f32_16x16x32_bf16 v[44:47], v[208:211], v[76:79], 0
    v_mfma_f32_16x16x32_bf16 v[48:51], v[216:219], v[76:79], 0
    v_mfma_f32_16x16x32_bf16 v[36:39], v[200:203], v[80:83], v[36:39]
    v_mfma_f32_16x16x32_bf16 v[40:43], v[196:199], v[80:83], v[40:43]
    s_lshl_b32 s30, s61, 12
    s_add_u32 s30, s30, s62
    s_mov_b32 m0, s30
    s_lshl_b32 s31, s55, 14
    s_add_u32 s31, s31, s30
    s_cmp_ge_u32 s31, 114688
    s_cselect_b32 s4, 114688, 0
    s_sub_u32 s31, s31, s4
    s_add_u32 s31, s31, s63
    s_add_u32 s61, s61, 1
    s_cmp_eq_u32 s61, 7
    s_cselect_b32 s61, 0, s61
    buffer_load_dwordx4 v2, s[8:11], s31 offen offset:0 lds
    buffer_load_dwordx4 v2, s[8:11], s31 offen offset:1024 lds
    buffer_load_dwordx4 v2, s[8:11], s31 offen offset:2048 lds
    buffer_load_dwordx4 v2, s[8:11], s31 offen offset:3072 lds
    v_mfma_f32_16x16x32_bf16 v[44:47], v[212:215], v[80:83], v[44:47]
    v_mfma_f32_16x16x32_bf16 v[48:51], v[208:211], v[80:83], v[48:51]
    v_mul_f32 v52, v36, v164
    v_mul_f32 v56, v40, v164
    v_fma_f32 v52, -v40, v168, v52
    v_fma_f32 v56, v36, v168, v56
    v_mul_f32 v53, v37, v165
    v_mul_f32 v57, v41, v165
    v_fma_f32 v53, -v41, v169, v53
    v_fma_f32 v57, v37, v169, v57
    v_mul_f32 v54, v38, v166
    v_mul_f32 v58, v42, v166
    v_fma_f32 v54, -v42, v170, v54
    v_fma_f32 v58, v38, v170, v58
    s_lshl_b32 s30, s61, 12
    s_add_u32 s30, s30, s62
    s_mov_b32 m0, s30
    s_lshl_b32 s31, s55, 14
    s_add_u32 s31, s31, s30
    s_cmp_ge_u32 s31, 114688
    s_cselect_b32 s4, 114688, 0
    s_sub_u32 s31, s31, s4
    s_add_u32 s31, s31, s63
    s_add_u32 s61, s61, 1
    s_cmp_eq_u32 s61, 7
    s_cselect_b32 s61, 0, s61
    buffer_load_dwordx4 v2, s[8:11], s31 offen offset:0 lds
    buffer_load_dwordx4 v2, s[8:11], s31 offen offset:1024 lds
    buffer_load_dwordx4 v2, s[8:11], s31 offen offset:2048 lds
    buffer_load_dwordx4 v2, s[8:11], s31 offen offset:3072 lds
    v_mul_f32 v55, v39, v167
    v_mul_f32 v59, v43, v167
    v_fma_f32 v55, -v43, v171, v55
    v_fma_f32 v59, v39, v171, v59
    v_mul_f32 v60, v44, v172
    v_mul_f32 v64, v48, v172
    v_fma_f32 v60, -v48, v176, v60
    v_fma_f32 v64, v44, v176, v64
    v_mul_f32 v61, v45, v173
    v_mul_f32 v65, v49, v173
    v_fma_f32 v61, -v49, v177, v61
    v_fma_f32 v65, v45, v177, v65
    v_mul_f32 v62, v46, v174
    v_mul_f32 v66, v50, v174
    v_fma_f32 v62, -v50, v178, v62
    v_fma_f32 v66, v46, v178, v66
    v_mul_f32 v63, v47, v175
    v_mul_f32 v67, v51, v175
    v_fma_f32 v63, -v51, v179, v63
    v_fma_f32 v67, v47, v179, v67
    v_cvt_pk_bf16_f32 v76, v52, v56
    v_cvt_pk_bf16_f32 v77, v53, v57
    v_cvt_pk_bf16_f32 v78, v54, v58
    v_cvt_pk_bf16_f32 v79, v55, v59
    v_cvt_pk_bf16_f32 v80, v60, v64
    v_cvt_pk_bf16_f32 v81, v61, v65
    v_cvt_pk_bf16_f32 v82, v62, v66
    v_cvt_pk_bf16_f32 v83, v63, v67
    ds_write2_b32 v223, v76, v77 offset0:0 offset1:68
    ds_write2_b32 v223, v78, v79 offset0:136 offset1:204
    ds_write2_b32 v224, v80, v81 offset0:0 offset1:68
    ds_write2_b32 v224, v82, v83 offset0:136 offset1:204
    s_waitcnt vmcnt(14)
    s_waitcnt lgkmcnt(0)
    s_barrier
    ds_read_b128 v[84:87], v225 offset:0
    ds_read_b128 v[88:91], v225 offset:64
    ds_read_b128 v[92:95], v225 offset:128
    ds_read_b128 v[96:99], v225 offset:192
    ds_read_b128 v[100:103], v225 offset:4352
    ds_read_b128 v[104:107], v225 offset:4416
    ds_read_b128 v[108:111], v225 offset:4480
    ds_read_b128 v[112:115], v225 offset:4544
    s_lshl_b32 s26, s3, 10
    s_add_u32 s27, s26, s7
    s_add_u32 s26, s26, s6
    s_waitcnt lgkmcnt(7)
    v_mfma_f32_16x16x32_bf16 v[36:39], v[180:183], v[84:87], 0
    s_waitcnt lgkmcnt(5)
    v_mfma_f32_16x16x32_bf16 v[40:43], v[188:191], v[92:95], 0
    s_waitcnt lgkmcnt(3)
    v_mfma_f32_16x16x32_bf16 v[44:47], v[180:183], v[100:103], 0
    s_waitcnt lgkmcnt(1)
    v_mfma_f32_16x16x32_bf16 v[48:51], v[188:191], v[108:111], 0
    v_mfma_f32_16x16x32_bf16 v[36:39], v[184:187], v[88:91], v[36:39]
    v_mfma_f32_16x16x32_bf16 v[40:43], v[192:195], v[96:99], v[40:43]
    v_mfma_f32_16x16x32_bf16 v[44:47], v[184:187], v[104:107], v[44:47]
    s_waitcnt lgkmcnt(0)
    v_mfma_f32_16x16x32_bf16 v[48:51], v[192:195], v[112:115], v[48:51]
    s_nop 4
    v_add_f32 v52, v36, v40
    v_sub_f32 v56, v36, v40
    v_add_f32 v53, v37, v41
    v_sub_f32 v57, v37, v41
    v_add_f32 v54, v38, v42
    v_sub_f32 v58, v38, v42
    v_add_f32 v55, v39, v43
    v_sub_f32 v59, v39, v43
    v_add_f32 v60, v44, v48
    v_sub_f32 v64, v44, v48
    v_add_f32 v61, v45, v49
    v_sub_f32 v65, v45, v49
    v_add_f32 v62, v46, v50
    v_sub_f32 v66, v46, v50
    v_add_f32 v63, v47, v51
    v_sub_f32 v67, v47, v51
    s_cmp_lg_u32 s2, 0
    s_cbranch_scc1 km_noself
    v_add_f32 v36, v52, v57
    v_add_f32 v37, v53, v56
    v_sub_f32 v38, v53, v56
    v_sub_f32 v39, v57, v52
    v_mul_f32 v52, 0.5, v36
    v_mul_f32 v53, 0.5, v37
    v_mul_f32 v57, 0.5, v38
    v_mul_f32 v56, 0.5, v39
    v_add_f32 v36, v54, v59
    v_add_f32 v37, v55, v58
    v_sub_f32 v38, v55, v58
    v_sub_f32 v39, v59, v54
    v_mul_f32 v54, 0.5, v36
    v_mul_f32 v55, 0.5, v37
    v_mul_f32 v59, 0.5, v38
    v_mul_f32 v58, 0.5, v39
    v_add_f32 v36, v60, v65
    v_add_f32 v37, v61, v64
    v_sub_f32 v38, v61, v64
    v_sub_f32 v39, v65, v60
    v_mul_f32 v60, 0.5, v36
    v_mul_f32 v61, 0.5, v37
    v_mul_f32 v65, 0.5, v38
    v_mul_f32 v64, 0.5, v39
    v_add_f32 v36, v62, v67
    v_add_f32 v37, v63, v66
    v_sub_f32 v38, v63, v66
    v_sub_f32 v39, v67, v62
    v_mul_f32 v62, 0.5, v36
    v_mul_f32 v63, 0.5, v37
    v_mul_f32 v67, 0.5, v38
    v_mul_f32 v66, 0.5, v39
km_noself:
    v_cvt_pk_bf16_f32 v76, v52, v53
    v_cvt_pk_bf16_f32 v77, v57, v56
    v_cvt_pk_bf16_f32 v78, v54, v55
    v_cvt_pk_bf16_f32 v79, v59, v58
    v_min_u32 v77, -2, v77
    v_min_u32 v79, -2, v79
    buffer_store_dwordx4 v[76:79], v2, s[8:11], s26 offen sc1
    v_cvt_pk_bf16_f32 v80, v60, v61
    v_cvt_pk_bf16_f32 v81, v65, v64
    v_cvt_pk_bf16_f32 v82, v62, v63
    v_cvt_pk_bf16_f32 v83, v67, v66
    v_min_u32 v81, -2, v81
    v_min_u32 v83, -2, v83
    buffer_store_dwordx4 v[80:83], v2, s[8:11], s27 offen sc1
    buffer_store_dwordx4 v[236:239], v2, s[8:11], s42 offen offset:1024 sc1
    buffer_store_dwordx4 v[236:239], v2, s[8:11], s42 offen offset:2048 sc1
    buffer_store_dwordx4 v[236:239], v2, s[8:11], s5 offen offset:1024 sc1
    buffer_store_dwordx4 v[236:239], v2, s[8:11], s5 offen offset:2048 sc1
    buffer_store_dwordx2 v[236:237], v3, s[8:11], s47 offen sc1
    buffer_store_dwordx2 v[236:237], v3, s[8:11], s48 offen sc1
    v_lshlrev_b32 v221, 13, v0
    v_cmp_eq_u32 vcc, 0, v0
    v_mov_b32 v150, 268435456
    s_nop 0
    v_cndmask_b32 v221, v221, v150, vcc
    v_mov_b32 v152, 0
    s_lshr_b32 s28, s3, 1
    s_lshl_b32 s28, s28, 8
    s_and_b32 s29, s3, 1
    s_lshl_b32 s29, s29, 3
    s_add_u32 s28, s28, s29
    s_add_u32 s28, s28, s40
    v_and_b32 v228, 15, v0
    v_mul_u32_u24 v228, 36, v228
    v_lshrrev_b32 v151, 4, v0
    v_add_lshl_u32 v228, v228, v151, 2
    v_add_u32 v228, 131072, v228
    v_sub_u32 v150, 512, v0
    v_mov_b32 v151, 256
    v_cndmask_b32 v150, v150, v151, vcc
    v_and_b32 v229, 15, v150
    v_mul_u32_u24 v229, 36, v229
    v_lshrrev_b32 v151, 4, v150
    v_add_lshl_u32 v229, v229, v151, 2
    v_add_u32 v229, 131072, v229
    s_mul_i32 s27, s3, 2304
    s_add_u32 s27, s27, 131072
    v_mul_u32_u24 v230, 144, v5
    v_lshl_add_u32 v230, v4, 4, v230
    v_add_u32 v230, s27, v230
    s_add_u32 s56, s39, s49
    s_and_b32 s56, s56, 1
    s_mul_i32 s57, s3, 57344
    s_mul_i32 s58, s39, 229376
    s_add_u32 s57, s57, s58
    s_add_u32 s57, s57, 12320768
    s_mul_i32 s59, s56, 28672
    s_sub_u32 s58, s57, s59
    s_add_u32 s57, s57, s59
    s_lshl_b32 s30, s61, 12
    s_add_u32 s30, s30, s62
    s_mov_b32 m0, s30
    s_lshl_b32 s31, s55, 14
    s_add_u32 s31, s31, s30
    s_cmp_ge_u32 s31, 114688
    s_cselect_b32 s4, 114688, 0
    s_sub_u32 s31, s31, s4
    s_add_u32 s31, s31, s63
    s_add_u32 s61, s61, 1
    s_cmp_eq_u32 s61, 7
    s_cselect_b32 s61, 0, s61
    buffer_load_dwordx4 v2, s[8:11], s31 offen offset:0 lds
    buffer_load_dwordx4 v2, s[8:11], s31 offen offset:1024 lds
    buffer_load_dwordx4 v2, s[8:11], s31 offen offset:2048 lds
    buffer_load_dwordx4 v2, s[8:11], s31 offen offset:3072 lds
    s_lshl_b32 s30, s61, 12
    s_add_u32 s30, s30, s62
    s_mov_b32 m0, s30
    s_lshl_b32 s31, s55, 14
    s_add_u32 s31, s31, s30
    s_cmp_ge_u32 s31, 114688
    s_cselect_b32 s4, 114688, 0
    s_sub_u32 s31, s31, s4
    s_add_u32 s31, s31, s63
    s_add_u32 s61, s61, 1
    s_cmp_eq_u32 s61, 7
    s_cselect_b32 s61, 0, s61
    buffer_load_dwordx4 v2, s[8:11], s31 offen offset:0 lds
    buffer_load_dwordx4 v2, s[8:11], s31 offen offset:1024 lds
    buffer_load_dwordx4 v2, s[8:11], s31 offen offset:2048 lds
    buffer_load_dwordx4 v2, s[8:11], s31 offen offset:3072 lds
    s_lshl_b32 s30, s61, 12
    s_add_u32 s30, s30, s62
    s_mov_b32 m0, s30
    s_lshl_b32 s31, s55, 14
    s_add_u32 s31, s31, s30
    s_cmp_ge_u32 s31, 114688
    s_cselect_b32 s4, 114688, 0
    s_sub_u32 s31, s31, s4
    s_add_u32 s31, s31, s63
    s_add_u32 s61, s61, 1
    s_cmp_eq_u32 s61, 7
    s_cselect_b32 s61, 0, s61
    buffer_load_dwordx4 v2, s[8:11], s31 offen offset:0 lds
    buffer_load_dwordx4 v2, s[8:11], s31 offen offset:1024 lds
    buffer_load_dwordx4 v2, s[8:11], s31 offen offset:2048 lds
    buffer_load_dwordx4 v2, s[8:11], s31 offen offset:3072 lds
    s_lshl_b32 s30, s61, 12
    s_add_u32 s30, s30, s62
    s_mov_b32 m0, s30
    s_lshl_b32 s31, s55, 14
    s_add_u32 s31, s31, s30
    s_cmp_ge_u32 s31, 114688
    s_cselect_b32 s4, 114688, 0
    s_sub_u32 s31, s31, s4
    s_add_u32 s31, s31, s63
    s_add_u32 s61, s61, 1
    s_cmp_eq_u32 s61, 7
    s_cselect_b32 s61, 0, s61
    buffer_load_dwordx4 v2, s[8:11], s31 offen offset:0 lds
    buffer_load_dwordx4 v2, s[8:11], s31 offen offset:1024 lds
    buffer_load_dwordx4 v2, s[8:11], s31 offen offset:2048 lds
    buffer_load_dwordx4 v2, s[8:11], s31 offen offset:3072 lds
    buffer_load_dwordx4 v[12:15], v221, s[8:11], s40 offen sc1
    buffer_load_dwordx4 v[16:19], v221, s[8:11], s40 offen offset:256 sc1
    s_add_u32 s60, s57, 4096
    buffer_load_dwordx4 a[16:19], v2, s[8:11], s60 offen
    buffer_load_dwordx4 a[20:23], v2, s[8:11], s60 offen offset:1024
    buffer_load_dwordx4 a[24:27], v2, s[8:11], s60 offen offset:2048
    buffer_load_dwordx4 a[28:31], v2, s[8:11], s60 offen offset:3072
    s_add_u32 s60, s57, 20480
    buffer_load_dwordx4 a[80:83], v2, s[8:11], s60 offen
    buffer_load_dwordx4 a[84:87], v2, s[8:11], s60 offen offset:1024
    s_waitcnt vmcnt(6)
    v_max3_u32 v150, v13, v15, v17
    v_max_u32 v150, v150, v19
    v_cmp_eq_u32 vcc, -1, v150
    s_nop 0
    s_cbranch_vccnz km_retry0
km_back0:
    buffer_load_dwordx2 v[154:155], v152, s[8:11], s28 offen sc1
    ds_write2st64_b32 v228, v12, v14 offset0:0 offset1:9
    ds_write2st64_b32 v229, v13, v15 offset0:0 offset1:9
    ds_write2st64_b32 v228, v16, v18 offset0:18 offset1:27
    ds_write2st64_b32 v229, v17, v19 offset0:18 offset1:27
    s_waitcnt lgkmcnt(0)
    s_barrier
    ds_read_b128 v[12:15], v230
    ds_read_b128 v[16:19], v230 offset:64
    s_waitcnt lgkmcnt(1)
    v_mfma_f32_16x16x32_bf16 v[36:39], v[12:15], a[224:227], 0
    v_mfma_f32_16x16x32_bf16 v[40:43], v[12:15], a[228:231], 0
    v_mfma_f32_16x16x32_bf16 v[44:47], v[12:15], a[232:235], 0
    v_mfma_f32_16x16x32_bf16 v[48:51], v[12:15], a[236:239], 0
    s_waitcnt lgkmcnt(0)
    v_mfma_f32_16x16x32_bf16 v[36:39], v[16:19], a[240:243], v[36:39]
    v_mfma_f32_16x16x32_bf16 v[40:43], v[16:19], a[244:247], v[40:43]
    v_mfma_f32_16x16x32_bf16 v[44:47], v[16:19], a[248:251], v[44:47]
    v_mfma_f32_16x16x32_bf16 v[48:51], v[16:19], a[252:255], v[48:51]
    v_lshlrev_b32 v84, 16, v140
    v_and_b32 v85, 0xffff0000, v140
    v_lshlrev_b32 v86, 16, v141
    v_and_b32 v87, 0xffff0000, v141
    v_lshlrev_b32 v88, 16, v142
    v_and_b32 v89, 0xffff0000, v142
    v_lshlrev_b32 v90, 16, v143
    v_and_b32 v91, 0xffff0000, v143
    v_lshlrev_b32 v92, 16, v144
    v_and_b32 v93, 0xffff0000, v144
    v_lshlrev_b32 v94, 16, v145
    v_and_b32 v95, 0xffff0000, v145
    v_lshlrev_b32 v96, 16, v146
    v_and_b32 v97, 0xffff0000, v146
    v_lshlrev_b32 v98, 16, v147
    v_and_b32 v99, 0xffff0000, v147
    v_mul_f32 v52, v36, v116
    v_mul_f32 v56, v40, v116
    v_fma_f32 v52, -v40, v120, v52
    v_fma_f32 v56, v36, v120, v56
    v_mul_f32 v53, v37, v117
    v_mul_f32 v57, v41, v117
    v_fma_f32 v53, -v41, v121, v53
    v_fma_f32 v57, v37, v121, v57
    v_mul_f32 v54, v38, v118
    v_mul_f32 v58, v42, v118
    v_fma_f32 v54, -v42, v122, v54
    v_fma_f32 v58, v38, v122, v58
    v_mul_f32 v55, v39, v119
    v_mul_f32 v59, v43, v119
    v_fma_f32 v55, -v43, v123, v55
    v_fma_f32 v59, v39, v123, v59
    v_cvt_pk_bf16_f32 v76, v52, v53
    v_cvt_pk_bf16_f32 v77, v54, v55
    v_cvt_pk_bf16_f32 v78, v56, v57
    v_cvt_pk_bf16_f32 v79, v58, v59
    v_mul_f32 v60, v44, v124
    v_mul_f32 v64, v48, v124
    v_fma_f32 v60, -v48, v128, v60
    v_fma_f32 v64, v44, v128, v64
    v_mul_f32 v61, v45, v125
    v_mul_f32 v65, v49, v125
    v_fma_f32 v61, -v49, v129, v61
    v_fma_f32 v65, v45, v129, v65
    v_mul_f32 v62, v46, v126
    v_mul_f32 v66, v50, v126
    v_fma_f32 v62, -v50, v130, v62
    v_fma_f32 v66, v46, v130, v66
    v_mul_f32 v63, v47, v127
    v_mul_f32 v67, v51, v127
    v_fma_f32 v63, -v51, v131, v63
    v_fma_f32 v67, v47, v131, v67
    v_cvt_pk_bf16_f32 v80, v60, v61
    v_cvt_pk_bf16_f32 v81, v62, v63
    v_cvt_pk_bf16_f32 v82, v64, v65
    v_cvt_pk_bf16_f32 v83, v66, v67
    s_waitcnt vmcnt(0)
    v_cmp_eq_u32 vcc, -1, v155
    s_nop 0
    s_cbranch_vccnz km_retry1
km_back1:
    v_lshlrev_b32 v164, 16, v154
    v_and_b32 v165, 0xffff0000, v154
    v_lshlrev_b32 v166, 16, v155
    v_and_b32 v167, 0xffff0000, v155
    v_add_f32 v156, v164, v166
    v_sub_f32 v157, v164, v166
    v_add_f32 v160, v165, v167
    v_sub_f32 v161, v165, v167
    v_mul_f32 v158, 0x35000000, v156
    v_mul_f32 v159, 0x35000000, v157
    v_mul_f32 v156, 0x35000000, v156
    v_mul_f32 v157, 0x35000000, v157
    v_mul_f32 v162, 0x35000000, v160
    v_mul_f32 v163, 0x35000000, v161
    v_mul_f32 v160, 0x35000000, v160
    v_mul_f32 v161, 0x35000000, v161
    v_mfma_f32_16x16x32_bf16 v[36:39], v[76:79], v[132:135], v[156:159]
    s_nop 0
    v_mfma_f32_16x16x32_bf16 v[44:47], v[76:79], v[136:139], v[160:163]
    buffer_load_dwordx4 a[88:91], v2, s[8:11], s60 offen offset:2048
    v_mfma_f32_16x16x32_bf16 v[40:43], v[80:83], v[132:135], v[156:159]
    v_mfma_f32_16x16x32_bf16 v[48:51], v[80:83], v[136:139], v[160:163]
    s_lshl_b32 s27, s3, 5
    s_add_u32 s27, s27, 147456
    v_mul_u32_u24 v231, 144, v1
    v_add_u32 v231, s27, v231
    v_bfe_u32 v232, v0, 3, 2
    v_lshlrev_b32 v232, 4, v232
    v_lshrrev_b32 v150, 5, v0
    v_add_u32 v232, v232, v150
    v_mul_u32_u24 v232, 144, v232
    v_and_b32 v150, 7, v0
    v_lshl_add_u32 v232, v150, 4, v232
    v_add_u32 v232, 147456, v232
    v_cvt_pk_bf16_f32 v76, v36, v37
    v_cvt_pk_bf16_f32 v77, v38, v39
    v_cvt_pk_bf16_f32 v78, v40, v41
    buffer_load_dwordx4 a[92:95], v2, s[8:11], s60 offen offset:3072
    v_cvt_pk_bf16_f32 v79, v42, v43
    v_cvt_pk_bf16_f32 v80, v44, v45
    v_cvt_pk_bf16_f32 v81, v46, v47
    v_cvt_pk_bf16_f32 v82, v48, v49
    v_cvt_pk_bf16_f32 v83, v50, v51
    v_lshlrev_b32 v36, 16, v76
    v_and_b32 v37, 0xffff0000, v76
    v_lshlrev_b32 v38, 16, v77
    v_and_b32 v39, 0xffff0000, v77
    v_lshlrev_b32 v40, 16, v78
    v_and_b32 v41, 0xffff0000, v78
    v_lshlrev_b32 v42, 16, v79
    v_and_b32 v43, 0xffff0000, v79
    v_lshlrev_b32 v44, 16, v80
    v_and_b32 v45, 0xffff0000, v80
    v_lshlrev_b32 v46, 16, v81
    v_and_b32 v47, 0xffff0000, v81
    s_add_u32 s60, s58, 32768
    buffer_load_dwordx4 a[128:131], v2, s[8:11], s60 offen
    v_lshlrev_b32 v48, 16, v82
    v_and_b32 v49, 0xffff0000, v82
    v_lshlrev_b32 v50, 16, v83
    v_and_b32 v51, 0xffff0000, v83
    v_add_f32 v36, v36, v84
    v_add_f32 v37, v37, v85
    v_add_f32 v38, v38, v86
    v_add_f32 v39, v39, v87
    v_add_f32 v40, v40, v88
    v_add_f32 v41, v41, v89
    v_add_f32 v42, v42, v90
    v_add_f32 v43, v43, v91
    v_add_f32 v44, v44, v92
    v_add_f32 v45, v45, v93
    v_add_f32 v46, v46, v94
    v_add_f32 v47, v47, v95
    v_add_f32 v48, v48, v96
    buffer_load_dwordx4 a[132:135], v2, s[8:11], s60 offen offset:1024
    v_add_f32 v49, v49, v97
    v_add_f32 v50, v50, v98
    v_add_f32 v51, v51, v99
    v_cvt_pk_bf16_f32 v76, v36, v37
    v_cvt_pk_bf16_f32 v77, v38, v39
    v_cvt_pk_bf16_f32 v78, v40, v41
    v_cvt_pk_bf16_f32 v79, v42, v43
    v_cvt_pk_bf16_f32 v80, v44, v45
    v_cvt_pk_bf16_f32 v81, v46, v47
    v_cvt_pk_bf16_f32 v82, v48, v49
    v_cvt_pk_bf16_f32 v83, v50, v51
    v_lshlrev_b32 v84, 16, v76
    v_and_b32 v85, 0xffff0000, v76
    v_lshlrev_b32 v86, 16, v77
    v_and_b32 v87, 0xffff0000, v77
    v_lshlrev_b32 v88, 16, v78
    v_and_b32 v89, 0xffff0000, v78
    v_lshlrev_b32 v90, 16, v79
    buffer_load_dwordx4 a[136:139], v2, s[8:11], s60 offen offset:2048
    v_and_b32 v91, 0xffff0000, v79
    v_lshlrev_b32 v92, 16, v80
    v_and_b32 v93, 0xffff0000, v80
    v_lshlrev_b32 v94, 16, v81
    v_and_b32 v95, 0xffff0000, v81
    v_lshlrev_b32 v96, 16, v82
    v_and_b32 v97, 0xffff0000, v82
    v_lshlrev_b32 v98, 16, v83
    v_and_b32 v99, 0xffff0000, v83
    s_lshl_b32 s27, s3, 11
    s_add_u32 s27, s27, s44
    buffer_store_dwordx4 v[76:79], v2, s[8:11], s27 offen sc1
    buffer_store_dwordx4 v[80:83], v2, s[8:11], s27 offen offset:1024 sc1
    v_add_f32 v52, v84, v85
    v_add_f32 v53, v92, v93
    v_add_f32 v52, v52, v86
    v_add_f32 v53, v53, v94
    buffer_load_dwordx4 a[140:143], v2, s[8:11], s60 offen offset:3072
    v_add_f32 v52, v52, v87
    v_add_f32 v53, v53, v95
    v_add_f32 v52, v52, v88
    v_add_f32 v53, v53, v96
    v_add_f32 v52, v52, v89
    v_add_f32 v53, v53, v97
    v_add_f32 v52, v52, v90
    v_add_f32 v53, v53, v98
    v_add_f32 v52, v52, v91
    v_add_f32 v53, v53, v99
    s_nop 1
    v_permlane32_swap_b32 v52, v53
    v_add_f32 v52, v52, v53
    v_mov_b32 v54, v52
    s_nop 1
    v_permlane16_swap_b32 v52, v54
    v_add_f32 v52, v52, v54
    s_nop 1
    v_add_f32_dpp v52, v52, v52 quad_perm:[1,0,3,2] row_mask:0xf bank_mask:0xf
    s_nop 1
    v_add_f32_dpp v52, v52, v52 quad_perm:[2,3,0,1] row_mask:0xf bank_mask:0xf
    s_add_u32 s60, s58, 49152
    buffer_load_dwordx4 a[192:195], v2, s[8:11], s60 offen
    v_add_f32_dpp v52, v52, v52 row_half_mirror row_mask:0xf bank_mask:0xf
    s_nop 1
    v_add_f32_dpp v52, v52, v52 row_mirror row_mask:0xf bank_mask:0xf
    v_mul_f32 v55, 0x3b000000, v52
    v_mov_b32 v57, v55
    v_mov_b32 v56, v55
    s_nop 1
    v_permlane32_swap_b32 v55, v56
    v_sub_f32 v58, v84, v55
    v_sub_f32 v66, v92, v56
    v_sub_f32 v59, v85, v55
    v_sub_f32 v67, v93, v56
    v_sub_f32 v60, v86, v55
    v_sub_f32 v68, v94, v56
    v_sub_f32 v61, v87, v55
    v_sub_f32 v69, v95, v56
    v_sub_f32 v62, v88, v55
    v_sub_f32 v70, v96, v56
    v_sub_f32 v63, v89, v55
    buffer_load_dwordx4 a[196:199], v2, s[8:11], s60 offen offset:1024
    v_sub_f32 v71, v97, v56
    v_sub_f32 v64, v90, v55
    v_sub_f32 v72, v98, v56
    v_sub_f32 v65, v91, v55
    v_sub_f32 v73, v99, v56
    v_mul_f32 v52, v58, v58
    v_mul_f32 v53, v66, v66
    v_fmac_f32 v52, v59, v59
    v_fmac_f32 v53, v67, v67
    v_fmac_f32 v52, v60, v60
    v_fmac_f32 v53, v68, v68
    v_fmac_f32 v52, v61, v61
    v_fmac_f32 v53, v69, v69
    v_fmac_f32 v52, v62, v62
    v_fmac_f32 v53, v70, v70
    v_fmac_f32 v52, v63, v63
    v_fmac_f32 v53, v71, v71
    buffer_load_dwordx4 a[200:203], v2, s[8:11], s60 offen offset:2048
    v_fmac_f32 v52, v64, v64
    v_fmac_f32 v53, v72, v72
    v_fmac_f32 v52, v65, v65
    v_fmac_f32 v53, v73, v73
    v_cvt_pk_bf16_f32 v57, v57, v57
    v_lshlrev_b32 v57, 16, v57
    v_mov_b32 v55, v57
    v_mov_b32 v56, v55
    s_nop 1
    v_permlane32_swap_b32 v55, v56
    v_permlane32_swap_b32 v52, v53
    v_add_f32 v52, v52, v53
    v_mov_b32 v54, v52
    s_nop 1
    v_permlane16_swap_b32 v52, v54
    v_add_f32 v52, v52, v54
    s_nop 1
    v_add_f32_dpp v52, v52, v52 quad_perm:[1,0,3,2] row_mask:0xf bank_mask:0xf
    s_nop 1
    v_add_f32_dpp v52, v52, v52 quad_perm:[2,3,0,1] row_mask:0xf bank_mask:0xf
    s_nop 1
    v_add_f32_dpp v52, v52, v52 row_half_mirror row_mask:0xf bank_mask:0xf
    s_nop 1
    v_add_f32_dpp v52, v52, v52 row_mirror row_mask:0xf bank_mask:0xf
    buffer_load_dwordx4 a[204:207], v2, s[8:11], s60 offen offset:3072
    v_sub_f32 v58, v84, v55
    v_sub_f32 v66, v92, v56
    v_sub_f32 v59, v85, v55
    v_sub_f32 v67, v93, v56
    v_sub_f32 v60, v86, v55
    v_sub_f32 v68, v94, v56
    v_sub_f32 v61, v87, v55
    v_sub_f32 v69, v95, v56
    v_sub_f32 v62, v88, v55
    v_sub_f32 v70, v96, v56
    v_sub_f32 v63, v89, v55
    v_sub_f32 v71, v97, v56
    v_sub_f32 v64, v90, v55
    v_sub_f32 v72, v98, v56
    v_sub_f32 v65, v91, v55
    v_sub_f32 v73, v99, v56
    v_mul_f32 v52, 0x3b000000, v52
    s_add_u32 s60, s57, 0
    buffer_load_dwordx4 a[0:3], v2, s[8:11], s60 offen
    v_cvt_pk_bf16_f32 v52, v52, v52
    v_lshlrev_b32 v52, 16, v52
    v_add_f32 v52, 0x3727c5ac, v52
    v_cvt_pk_bf16_f32 v52, v52, v52
    v_lshlrev_b32 v52, 16, v52
    v_sqrt_f32 v52, v52
    s_nop 0
    v_cvt_pk_bf16_f32 v52, v52, v52
    v_lshlrev_b32 v52, 16, v52
    v_rcp_f32 v52, v52
    v_cvt_pk_bf16_f32 v58, v58, v59
    v_cvt_pk_bf16_f32 v60, v60, v61
    v_cvt_pk_bf16_f32 v62, v62, v63
    v_cvt_pk_bf16_f32 v64, v64, v65
    v_cvt_pk_bf16_f32 v66, v66, v67
    v_cvt_pk_bf16_f32 v68, v68, v69
    v_cvt_pk_bf16_f32 v70, v70, v71
    v_cvt_pk_bf16_f32 v72, v72, v73
    buffer_load_dwordx4 a[4:7], v2, s[8:11], s60 offen offset:1024
    v_mov_b32 v53, v52
    s_nop 1
    v_permlane32_swap_b32 v52, v53
    v_and_b32 v59, 0xffff0000, v58
    v_lshlrev_b32 v58, 16, v58
    v_and_b32 v61, 0xffff0000, v60
    v_lshlrev_b32 v60, 16, v60
    v_and_b32 v63, 0xffff0000, v62
    v_lshlrev_b32 v62, 16, v62
    v_and_b32 v65, 0xffff0000, v64
    v_lshlrev_b32 v64, 16, v64
    v_and_b32 v67, 0xffff0000, v66
    v_lshlrev_b32 v66, 16, v66
    v_and_b32 v69, 0xffff0000, v68
    v_lshlrev_b32 v68, 16, v68
    v_and_b32 v71, 0xffff0000, v70
    v_lshlrev_b32 v70, 16, v70
    v_and_b32 v73, 0xffff0000, v72
    buffer_load_dwordx4 a[8:11], v2, s[8:11], s60 offen offset:2048
    v_lshlrev_b32 v72, 16, v72
    v_mul_f32 v58, v58, v52
    v_mul_f32 v66, v66, v53
    v_mul_f32 v59, v59, v52
    v_mul_f32 v67, v67, v53
    v_mul_f32 v60, v60, v52
    v_mul_f32 v68, v68, v53
    v_mul_f32 v61, v61, v52
    v_mul_f32 v69, v69, v53
    v_mul_f32 v62, v62, v52
    v_mul_f32 v70, v70, v53
    v_mul_f32 v63, v63, v52
    v_mul_f32 v71, v71, v53
    v_mul_f32 v64, v64, v52
    v_mul_f32 v72, v72, v53
    v_mul_f32 v65, v65, v52
    v_mul_f32 v73, v73, v53
    buffer_load_dwordx4 a[12:15], v2, s[8:11], s60 offen offset:3072
    v_cvt_pk_bf16_f32 v140, v58, v59
    v_cvt_pk_bf16_f32 v144, v66, v67
    v_cvt_pk_bf16_f32 v141, v60, v61
    v_cvt_pk_bf16_f32 v145, v68, v69
    v_cvt_pk_bf16_f32 v142, v62, v63
    v_cvt_pk_bf16_f32 v146, v70, v71
    v_cvt_pk_bf16_f32 v143, v64, v65
    v_cvt_pk_bf16_f32 v147, v72, v73
    v_min_u32 v143, -2, v143
    v_min_u32 v147, -2, v147
    ds_write_b128 v231, v[140:143]
    ds_write_b128 v231, v[144:147] offset:16
    s_waitcnt vmcnt(9)
    s_waitcnt lgkmcnt(0)
    s_barrier
    ds_read_b128 v[76:79], v232
    ds_read_b128 v[80:83], v232 offset:1152
    s_waitcnt lgkmcnt(1)
    buffer_store_dwordx4 v[76:79], v6, s[8:11], s45 offen sc1
    s_waitcnt lgkmcnt(0)
    buffer_store_dwordx4 v[80:83], v6, s[8:11], s46 offen sc1
    v_lshrrev_b32 v9, 3, v5
    v_lshlrev_b32 v9, 13, v9
    v_lshl_add_u32 v9, v4, 7, v9
    v_and_b32 v10, 7, v5
    v_lshl_add_u32 v9, v10, 4, v9
    v_add_u32 v11, 65536, v2
    s_lshl_b32 s26, s35, 17
    s_lshl_b32 s27, s3, 15
    s_add_u32 s26, s26, s27
    s_add_u32 s26, s26, 8388608
    s_add_u32 s27, s26, 4096
    s_add_u32 s28, s26, 16384
    s_add_u32 s29, s26, 20480
    s_add_u32 s60, s57, 16384
    buffer_load_dwordx4 a[64:67], v2, s[8:11], s60 offen
    buffer_load_dwordx4 a[68:71], v2, s[8:11], s60 offen offset:1024
    buffer_load_dwordx4 a[72:75], v2, s[8:11], s60 offen offset:2048
    buffer_load_dwordx4 a[76:79], v2, s[8:11], s60 offen offset:3072
    s_add_u32 s60, s58, 28672
    buffer_load_dwordx4 a[112:115], v2, s[8:11], s60 offen
    buffer_load_dwordx4 a[116:119], v2, s[8:11], s60 offen offset:1024
    buffer_load_dwordx4 a[120:123], v2, s[8:11], s60 offen offset:2048
    buffer_load_dwordx4 a[124:127], v2, s[8:11], s60 offen offset:3072
    s_add_u32 s60, s58, 45056
    buffer_load_dwordx4 a[176:179], v2, s[8:11], s60 offen
    buffer_load_dwordx4 a[180:183], v2, s[8:11], s60 offen offset:1024
    buffer_load_dwordx4 a[184:187], v2, s[8:11], s60 offen offset:2048
    buffer_load_dwordx4 a[188:191], v2, s[8:11], s60 offen offset:3072
    buffer_load_dwordx4 v[136:139], v9, s[8:11], s27 offen offset:3584 sc1
    buffer_load_dwordx4 v[140:143], v9, s[8:11], s29 offen offset:3584 sc1
    buffer_load_dwordx4 v[16:19], v9, s[8:11], s26 offen offset:0 sc1
    buffer_load_dwordx4 v[20:23], v9, s[8:11], s28 offen offset:0 sc1
    buffer_load_dwordx4 v[24:27], v9, s[8:11], s26 offen offset:512 sc1
    buffer_load_dwordx4 v[28:31], v9, s[8:11], s28 offen offset:512 sc1
    buffer_load_dwordx4 v[32:35], v9, s[8:11], s26 offen offset:1024 sc1
    buffer_load_dwordx4 v[36:39], v9, s[8:11], s28 offen offset:1024 sc1
    buffer_load_dwordx4 v[40:43], v9, s[8:11], s26 offen offset:1536 sc1
    buffer_load_dwordx4 v[44:47], v9, s[8:11], s28 offen offset:1536 sc1
    s_waitcnt vmcnt(8)
    v_max_u32 v10, v139, v143
    v_cmp_eq_u32 vcc, -1, v10
    s_nop 0
    s_cbranch_vccnz km_retry2
km_back2:
    ds_read_b128 v[144:147], v2 offset:15360
    ds_read_b128 v[148:151], v2 offset:31744
    ds_read_b128 v[152:155], v2 offset:48128
    ds_read_b128 v[156:159], v2 offset:64512
    ds_read_b128 v[160:163], v2 offset:0
    ds_read_b128 v[164:167], v2 offset:16384
    ds_read_b128 v[168:171], v2 offset:32768
    buffer_load_dwordx4 v[48:51], v9, s[8:11], s26 offen offset:2048 sc1
    buffer_load_dwordx4 v[52:55], v9, s[8:11], s28 offen offset:2048 sc1
    ds_read_b128 v[172:175], v2 offset:49152
    s_waitcnt lgkmcnt(7)
    v_mfma_f32_16x16x32_bf16 v[176:179], v[144:147], v[136:139], 0
    v_mfma_f32_16x16x32_bf16 v[180:183], v[144:147], v[140:143], 0
    ds_read_b128 v[144:147], v2 offset:1024
    s_waitcnt lgkmcnt(7)
    v_mfma_f32_16x16x32_bf16 v[184:187], v[148:151], v[136:139], 0
    v_mfma_f32_16x16x32_bf16 v[188:191], v[148:151], v[140:143], 0
    ds_read_b128 v[148:151], v2 offset:17408
    s_waitcnt lgkmcnt(7)
    v_mfma_f32_16x16x32_bf16 v[192:195], v[152:155], v[136:139], 0
    v_mfma_f32_16x16x32_bf16 v[196:199], v[152:155], v[140:143], 0
    ds_read_b128 v[152:155], v2 offset:33792
    s_waitcnt lgkmcnt(7)
    v_mfma_f32_16x16x32_bf16 v[200:203], v[156:159], v[136:139], 0
    v_mfma_f32_16x16x32_bf16 v[204:207], v[156:159], v[140:143], 0
    buffer_load_dwordx4 v[56:59], v9, s[8:11], s26 offen offset:2560 sc1
    buffer_load_dwordx4 v[60:63], v9, s[8:11], s28 offen offset:2560 sc1
    s_waitcnt vmcnt(10)
    v_max_u32 v10, v19, v23
    v_cmp_eq_u32 vcc, -1, v10
    s_nop 0
    s_cbranch_vccnz km_retry3
km_back3:
    ds_read_b128 v[156:159], v2 offset:50176
    s_waitcnt lgkmcnt(7)
    v_mfma_f32_16x16x32_bf16 v[176:179], v[160:163], v[16:19], v[176:179]
    v_mfma_f32_16x16x32_bf16 v[180:183], v[160:163], v[20:23], v[180:183]
    ds_read_b128 v[160:163], v2 offset:2048
    s_waitcnt lgkmcnt(7)
    v_mfma_f32_16x16x32_bf16 v[184:187], v[164:167], v[16:19], v[184:187]
    v_mfma_f32_16x16x32_bf16 v[188:191], v[164:167], v[20:23], v[188:191]
    ds_read_b128 v[164:167], v2 offset:18432
    s_waitcnt lgkmcnt(7)
    v_mfma_f32_16x16x32_bf16 v[192:195], v[168:171], v[16:19], v[192:195]
    v_mfma_f32_16x16x32_bf16 v[196:199], v[168:171], v[20:23], v[196:199]
    ds_read_b128 v[168:171], v2 offset:34816
    s_waitcnt lgkmcnt(7)
    v_mfma_f32_16x16x32_bf16 v[200:203], v[172:175], v[16:19], v[200:203]
    v_mfma_f32_16x16x32_bf16 v[204:207], v[172:175], v[20:23], v[204:207]
    buffer_load_dwordx4 v[64:67], v9, s[8:11], s26 offen offset:3072 sc1
    buffer_load_dwordx4 v[68:71], v9, s[8:11], s28 offen offset:3072 sc1
    s_waitcnt vmcnt(10)
    v_max_u32 v10, v27, v31
    v_cmp_eq_u32 vcc, -1, v10
    s_nop 0
    s_cbranch_vccnz km_retry4
km_back4:
    ds_read_b128 v[172:175], v2 offset:51200
    s_waitcnt lgkmcnt(7)
    v_mfma_f32_16x16x32_bf16 v[176:179], v[144:147], v[24:27], v[176:179]
    v_mfma_f32_16x16x32_bf16 v[180:183], v[144:147], v[28:31], v[180:183]
    ds_read_b128 v[144:147], v2 offset:3072
    s_waitcnt lgkmcnt(7)
    v_mfma_f32_16x16x32_bf16 v[184:187], v[148:151], v[24:27], v[184:187]
    v_mfma_f32_16x16x32_bf16 v[188:191], v[148:151], v[28:31], v[188:191]
    ds_read_b128 v[148:151], v2 offset:19456
    s_waitcnt lgkmcnt(7)
    v_mfma_f32_16x16x32_bf16 v[192:195], v[152:155], v[24:27], v[192:195]
    v_mfma_f32_16x16x32_bf16 v[196:199], v[152:155], v[28:31], v[196:199]
    ds_read_b128 v[152:155], v2 offset:35840
    s_waitcnt lgkmcnt(7)
    v_mfma_f32_16x16x32_bf16 v[200:203], v[156:159], v[24:27], v[200:203]
    v_mfma_f32_16x16x32_bf16 v[204:207], v[156:159], v[28:31], v[204:207]
    buffer_load_dwordx4 v[72:75], v9, s[8:11], s26 offen offset:3584 sc1
    buffer_load_dwordx4 v[76:79], v9, s[8:11], s28 offen offset:3584 sc1
    s_waitcnt vmcnt(10)
    v_max_u32 v10, v35, v39
    v_cmp_eq_u32 vcc, -1, v10
    s_nop 0
    s_cbranch_vccnz km_retry5
km_back5:
    ds_read_b128 v[156:159], v2 offset:52224
    s_waitcnt lgkmcnt(7)
    v_mfma_f32_16x16x32_bf16 v[176:179], v[160:163], v[32:35], v[176:179]
    v_mfma_f32_16x16x32_bf16 v[180:183], v[160:163], v[36:39], v[180:183]
    ds_read_b128 v[160:163], v2 offset:4096
    s_waitcnt lgkmcnt(7)
    v_mfma_f32_16x16x32_bf16 v[184:187], v[164:167], v[32:35], v[184:187]
    v_mfma_f32_16x16x32_bf16 v[188:191], v[164:167], v[36:39], v[188:191]
    ds_read_b128 v[164:167], v2 offset:20480
    s_waitcnt lgkmcnt(7)
    v_mfma_f32_16x16x32_bf16 v[192:195], v[168:171], v[32:35], v[192:195]
    v_mfma_f32_16x16x32_bf16 v[196:199], v[168:171], v[36:39], v[196:199]
    ds_read_b128 v[168:171], v2 offset:36864
    s_waitcnt lgkmcnt(7)
    v_mfma_f32_16x16x32_bf16 v[200:203], v[172:175], v[32:35], v[200:203]
    v_mfma_f32_16x16x32_bf16 v[204:207], v[172:175], v[36:39], v[204:207]
    buffer_load_dwordx4 v[80:83], v9, s[8:11], s27 offen offset:0 sc1
    buffer_load_dwordx4 v[84:87], v9, s[8:11], s29 offen offset:0 sc1
    s_waitcnt vmcnt(10)
    v_max_u32 v10, v43, v47
    v_cmp_eq_u32 vcc, -1, v10
    s_nop 0
    s_cbranch_vccnz km_retry6
km_back6:
    ds_read_b128 v[172:175], v2 offset:53248
    s_waitcnt lgkmcnt(7)
    v_mfma_f32_16x16x32_bf16 v[176:179], v[144:147], v[40:43], v[176:179]
    v_mfma_f32_16x16x32_bf16 v[180:183], v[144:147], v[44:47], v[180:183]
    ds_read_b128 v[144:147], v2 offset:5120
    s_waitcnt lgkmcnt(7)
    v_mfma_f32_16x16x32_bf16 v[184:187], v[148:151], v[40:43], v[184:187]
    v_mfma_f32_16x16x32_bf16 v[188:191], v[148:151], v[44:47], v[188:191]
    ds_read_b128 v[148:151], v2 offset:21504
    s_waitcnt lgkmcnt(7)
    v_mfma_f32_16x16x32_bf16 v[192:195], v[152:155], v[40:43], v[192:195]
    v_mfma_f32_16x16x32_bf16 v[196:199], v[152:155], v[44:47], v[196:199]
    ds_read_b128 v[152:155], v2 offset:37888
    s_waitcnt lgkmcnt(7)
    v_mfma_f32_16x16x32_bf16 v[200:203], v[156:159], v[40:43], v[200:203]
    v_mfma_f32_16x16x32_bf16 v[204:207], v[156:159], v[44:47], v[204:207]
    buffer_load_dwordx4 v[88:91], v9, s[8:11], s27 offen offset:512 sc1
    buffer_load_dwordx4 v[92:95], v9, s[8:11], s29 offen offset:512 sc1
    s_waitcnt vmcnt(10)
    v_max_u32 v10, v51, v55
    v_cmp_eq_u32 vcc, -1, v10
    s_nop 0
    s_cbranch_vccnz km_retry7
km_back7:
    ds_read_b128 v[156:159], v2 offset:54272
    s_waitcnt lgkmcnt(7)
    v_mfma_f32_16x16x32_bf16 v[176:179], v[160:163], v[48:51], v[176:179]
    v_mfma_f32_16x16x32_bf16 v[180:183], v[160:163], v[52:55], v[180:183]
    ds_read_b128 v[160:163], v2 offset:6144
    s_waitcnt lgkmcnt(7)
    v_mfma_f32_16x16x32_bf16 v[184:187], v[164:167], v[48:51], v[184:187]
    v_mfma_f32_16x16x32_bf16 v[188:191], v[164:167], v[52:55], v[188:191]
    ds_read_b128 v[164:167], v2 offset:22528
    s_waitcnt lgkmcnt(7)
    v_mfma_f32_16x16x32_bf16 v[192:195], v[168:171], v[48:51], v[192:195]
    v_mfma_f32_16x16x32_bf16 v[196:199], v[168:171], v[52:55], v[196:199]
    ds_read_b128 v[168:171], v2 offset:38912
    s_waitcnt lgkmcnt(7)
    v_mfma_f32_16x16x32_bf16 v[200:203], v[172:175], v[48:51], v[200:203]
    v_mfma_f32_16x16x32_bf16 v[204:207], v[172:175], v[52:55], v[204:207]
    buffer_load_dwordx4 v[96:99], v9, s[8:11], s27 offen offset:1024 sc1
    buffer_load_dwordx4 v[100:103], v9, s[8:11], s29 offen offset:1024 sc1
    s_waitcnt vmcnt(10)
    v_max_u32 v10, v59, v63
    v_cmp_eq_u32 vcc, -1, v10
    s_nop 0
    s_cbranch_vccnz km_retry8
km_back8:
    ds_read_b128 v[172:175], v2 offset:55296
    s_waitcnt lgkmcnt(7)
    v_mfma_f32_16x16x32_bf16 v[176:179], v[144:147], v[56:59], v[176:179]
    v_mfma_f32_16x16x32_bf16 v[180:183], v[144:147], v[60:63], v[180:183]
    ds_read_b128 v[144:147], v2 offset:7168
    s_waitcnt lgkmcnt(7)
    v_mfma_f32_16x16x32_bf16 v[184:187], v[148:151], v[56:59], v[184:187]
    v_mfma_f32_16x16x32_bf16 v[188:191], v[148:151], v[60:63], v[188:191]
    ds_read_b128 v[148:151], v2 offset:23552
    s_waitcnt lgkmcnt(7)
    v_mfma_f32_16x16x32_bf16 v[192:195], v[152:155], v[56:59], v[192:195]
    v_mfma_f32_16x16x32_bf16 v[196:199], v[152:155], v[60:63], v[196:199]
    ds_read_b128 v[152:155], v2 offset:39936
    s_waitcnt lgkmcnt(7)
    v_mfma_f32_16x16x32_bf16 v[200:203], v[156:159], v[56:59], v[200:203]
    v_mfma_f32_16x16x32_bf16 v[204:207], v[156:159], v[60:63], v[204:207]
    buffer_load_dwordx4 v[104:107], v9, s[8:11], s27 offen offset:1536 sc1
    buffer_load_dwordx4 v[108:111], v9, s[8:11], s29 offen offset:1536 sc1
    s_waitcnt vmcnt(10)
    v_max_u32 v10, v67, v71
    v_cmp_eq_u32 vcc, -1, v10
    s_nop 0
    s_cbranch_vccnz km_retry9
km_back9:
    ds_read_b128 v[156:159], v2 offset:56320
    s_waitcnt lgkmcnt(7)
    v_mfma_f32_16x16x32_bf16 v[176:179], v[160:163], v[64:67], v[176:179]
    v_mfma_f32_16x16x32_bf16 v[180:183], v[160:163], v[68:71], v[180:183]
    ds_read_b128 v[160:163], v2 offset:8192
    s_waitcnt lgkmcnt(7)
    v_mfma_f32_16x16x32_bf16 v[184:187], v[164:167], v[64:67], v[184:187]
    v_mfma_f32_16x16x32_bf16 v[188:191], v[164:167], v[68:71], v[188:191]
    ds_read_b128 v[164:167], v2 offset:24576
    s_waitcnt lgkmcnt(7)
    v_mfma_f32_16x16x32_bf16 v[192:195], v[168:171], v[64:67], v[192:195]
    v_mfma_f32_16x16x32_bf16 v[196:199], v[168:171], v[68:71], v[196:199]
    ds_read_b128 v[168:171], v2 offset:40960
    s_waitcnt lgkmcnt(7)
    v_mfma_f32_16x16x32_bf16 v[200:203], v[172:175], v[64:67], v[200:203]
    v_mfma_f32_16x16x32_bf16 v[204:207], v[172:175], v[68:71], v[204:207]
    buffer_load_dwordx4 v[112:115], v9, s[8:11], s27 offen offset:2048 sc1
    buffer_load_dwordx4 v[116:119], v9, s[8:11], s29 offen offset:2048 sc1
    s_waitcnt vmcnt(10)
    v_max_u32 v10, v75, v79
    v_cmp_eq_u32 vcc, -1, v10
    s_nop 0
    s_cbranch_vccnz km_retry10
km_back10:
    ds_read_b128 v[172:175], v2 offset:57344
    s_waitcnt lgkmcnt(7)
    v_mfma_f32_16x16x32_bf16 v[176:179], v[144:147], v[72:75], v[176:179]
    v_mfma_f32_16x16x32_bf16 v[180:183], v[144:147], v[76:79], v[180:183]
    ds_read_b128 v[144:147], v2 offset:9216
    s_waitcnt lgkmcnt(7)
    v_mfma_f32_16x16x32_bf16 v[184:187], v[148:151], v[72:75], v[184:187]
    v_mfma_f32_16x16x32_bf16 v[188:191], v[148:151], v[76:79], v[188:191]
    ds_read_b128 v[148:151], v2 offset:25600
    s_waitcnt lgkmcnt(7)
    v_mfma_f32_16x16x32_bf16 v[192:195], v[152:155], v[72:75], v[192:195]
    v_mfma_f32_16x16x32_bf16 v[196:199], v[152:155], v[76:79], v[196:199]
    ds_read_b128 v[152:155], v2 offset:41984
    s_waitcnt lgkmcnt(7)
    v_mfma_f32_16x16x32_bf16 v[200:203], v[156:159], v[72:75], v[200:203]
    v_mfma_f32_16x16x32_bf16 v[204:207], v[156:159], v[76:79], v[204:207]
    buffer_load_dwordx4 v[120:123], v9, s[8:11], s27 offen offset:2560 sc1
    buffer_load_dwordx4 v[124:127], v9, s[8:11], s29 offen offset:2560 sc1
    s_waitcnt vmcnt(10)
    v_max_u32 v10, v83, v87
    v_cmp_eq_u32 vcc, -1, v10
    s_nop 0
    s_cbranch_vccnz km_retry11
km_back11:
    ds_read_b128 v[156:159], v2 offset:58368
    s_waitcnt lgkmcnt(7)
    v_mfma_f32_16x16x32_bf16 v[176:179], v[160:163], v[80:83], v[176:179]
    v_mfma_f32_16x16x32_bf16 v[180:183], v[160:163], v[84:87], v[180:183]
    ds_read_b128 v[160:163], v2 offset:10240
    s_waitcnt lgkmcnt(7)
    v_mfma_f32_16x16x32_bf16 v[184:187], v[164:167], v[80:83], v[184:187]
    v_mfma_f32_16x16x32_bf16 v[188:191], v[164:167], v[84:87], v[188:191]
    ds_read_b128 v[164:167], v2 offset:26624
    s_waitcnt lgkmcnt(7)
    v_mfma_f32_16x16x32_bf16 v[192:195], v[168:171], v[80:83], v[192:195]
    v_mfma_f32_16x16x32_bf16 v[196:199], v[168:171], v[84:87], v[196:199]
    ds_read_b128 v[168:171], v2 offset:43008
    s_waitcnt lgkmcnt(7)
    v_mfma_f32_16x16x32_bf16 v[200:203], v[172:175], v[80:83], v[200:203]
    v_mfma_f32_16x16x32_bf16 v[204:207], v[172:175], v[84:87], v[204:207]
    buffer_load_dwordx4 v[128:131], v9, s[8:11], s27 offen offset:3072 sc1
    buffer_load_dwordx4 v[132:135], v9, s[8:11], s29 offen offset:3072 sc1
    s_waitcnt vmcnt(10)
    v_max_u32 v10, v91, v95
    v_cmp_eq_u32 vcc, -1, v10
    s_nop 0
    s_cbranch_vccnz km_retry12
km_back12:
    ds_read_b128 v[172:175], v2 offset:59392
    s_waitcnt lgkmcnt(7)
    v_mfma_f32_16x16x32_bf16 v[176:179], v[144:147], v[88:91], v[176:179]
    v_mfma_f32_16x16x32_bf16 v[180:183], v[144:147], v[92:95], v[180:183]
    ds_read_b128 v[144:147], v2 offset:11264
    s_waitcnt lgkmcnt(7)
    v_mfma_f32_16x16x32_bf16 v[184:187], v[148:151], v[88:91], v[184:187]
    v_mfma_f32_16x16x32_bf16 v[188:191], v[148:151], v[92:95], v[188:191]
    ds_read_b128 v[148:151], v2 offset:27648
    s_waitcnt lgkmcnt(7)
    v_mfma_f32_16x16x32_bf16 v[192:195], v[152:155], v[88:91], v[192:195]
    v_mfma_f32_16x16x32_bf16 v[196:199], v[152:155], v[92:95], v[196:199]
    ds_read_b128 v[152:155], v2 offset:44032
    s_waitcnt lgkmcnt(7)
    v_mfma_f32_16x16x32_bf16 v[200:203], v[156:159], v[88:91], v[200:203]
    v_mfma_f32_16x16x32_bf16 v[204:207], v[156:159], v[92:95], v[204:207]
    s_waitcnt vmcnt(8)
    v_max_u32 v10, v99, v103
    v_cmp_eq_u32 vcc, -1, v10
    s_nop 0
    s_cbranch_vccnz km_retry13
km_back13:
    ds_read_b128 v[156:159], v2 offset:60416
    s_waitcnt lgkmcnt(7)
    v_mfma_f32_16x16x32_bf16 v[176:179], v[160:163], v[96:99], v[176:179]
    v_mfma_f32_16x16x32_bf16 v[180:183], v[160:163], v[100:103], v[180:183]
    ds_read_b128 v[160:163], v2 offset:12288
    s_waitcnt lgkmcnt(7)
    v_mfma_f32_16x16x32_bf16 v[184:187], v[164:167], v[96:99], v[184:187]
    v_mfma_f32_16x16x32_bf16 v[188:191], v[164:167], v[100:103], v[188:191]
    ds_read_b128 v[164:167], v2 offset:28672
    s_waitcnt lgkmcnt(7)
    v_mfma_f32_16x16x32_bf16 v[192:195], v[168:171], v[96:99], v[192:195]
    v_mfma_f32_16x16x32_bf16 v[196:199], v[168:171], v[100:103], v[196:199]
    ds_read_b128 v[168:171], v2 offset:45056
    s_waitcnt lgkmcnt(7)
    v_mfma_f32_16x16x32_bf16 v[200:203], v[172:175], v[96:99], v[200:203]
    v_mfma_f32_16x16x32_bf16 v[204:207], v[172:175], v[100:103], v[204:207]
    s_waitcnt vmcnt(6)
    v_max_u32 v10, v107, v111
    v_cmp_eq_u32 vcc, -1, v10
    s_nop 0
    s_cbranch_vccnz km_retry14
km_back14:
    ds_read_b128 v[172:175], v2 offset:61440
    s_waitcnt lgkmcnt(7)
    v_mfma_f32_16x16x32_bf16 v[176:179], v[144:147], v[104:107], v[176:179]
    v_mfma_f32_16x16x32_bf16 v[180:183], v[144:147], v[108:111], v[180:183]
    ds_read_b128 v[144:147], v2 offset:13312
    s_waitcnt lgkmcnt(7)
    v_mfma_f32_16x16x32_bf16 v[184:187], v[148:151], v[104:107], v[184:187]
    v_mfma_f32_16x16x32_bf16 v[188:191], v[148:151], v[108:111], v[188:191]
    ds_read_b128 v[148:151], v2 offset:29696
    s_waitcnt lgkmcnt(7)
    v_mfma_f32_16x16x32_bf16 v[192:195], v[152:155], v[104:107], v[192:195]
    v_mfma_f32_16x16x32_bf16 v[196:199], v[152:155], v[108:111], v[196:199]
    ds_read_b128 v[152:155], v2 offset:46080
    s_waitcnt lgkmcnt(7)
    v_mfma_f32_16x16x32_bf16 v[200:203], v[156:159], v[104:107], v[200:203]
    v_mfma_f32_16x16x32_bf16 v[204:207], v[156:159], v[108:111], v[204:207]
    s_waitcnt vmcnt(4)
    v_max_u32 v10, v115, v119
    v_cmp_eq_u32 vcc, -1, v10
    s_nop 0
    s_cbranch_vccnz km_retry15
km_back15:
    ds_read_b128 v[156:159], v2 offset:62464
    s_waitcnt lgkmcnt(7)
    v_mfma_f32_16x16x32_bf16 v[176:179], v[160:163], v[112:115], v[176:179]
    v_mfma_f32_16x16x32_bf16 v[180:183], v[160:163], v[116:119], v[180:183]
    ds_read_b128 v[160:163], v2 offset:14336
    s_waitcnt lgkmcnt(7)
    v_mfma_f32_16x16x32_bf16 v[184:187], v[164:167], v[112:115], v[184:187]
    v_mfma_f32_16x16x32_bf16 v[188:191], v[164:167], v[116:119], v[188:191]
    ds_read_b128 v[164:167], v2 offset:30720
    s_waitcnt lgkmcnt(7)
    v_mfma_f32_16x16x32_bf16 v[192:195], v[168:171], v[112:115], v[192:195]
    v_mfma_f32_16x16x32_bf16 v[196:199], v[168:171], v[116:119], v[196:199]
    ds_read_b128 v[168:171], v2 offset:47104
    s_waitcnt lgkmcnt(7)
    v_mfma_f32_16x16x32_bf16 v[200:203], v[172:175], v[112:115], v[200:203]
    v_mfma_f32_16x16x32_bf16 v[204:207], v[172:175], v[116:119], v[204:207]
    s_waitcnt vmcnt(2)
    v_max_u32 v10, v123, v127
    v_cmp_eq_u32 vcc, -1, v10
    s_nop 0
    s_cbranch_vccnz km_retry16
km_back16:
    ds_read_b128 v[172:175], v2 offset:63488
    s_waitcnt lgkmcnt(7)
    v_mfma_f32_16x16x32_bf16 v[176:179], v[144:147], v[120:123], v[176:179]
    v_mfma_f32_16x16x32_bf16 v[180:183], v[144:147], v[124:127], v[180:183]
    ds_read_b128 v[144:147], v11 offset:0
    s_waitcnt lgkmcnt(7)
    v_mfma_f32_16x16x32_bf16 v[184:187], v[148:151], v[120:123], v[184:187]
    v_mfma_f32_16x16x32_bf16 v[188:191], v[148:151], v[124:127], v[188:191]
    ds_read_b128 v[148:151], v11 offset:1024
    s_waitcnt lgkmcnt(7)
    v_mfma_f32_16x16x32_bf16 v[192:195], v[152:155], v[120:123], v[192:195]
    v_mfma_f32_16x16x32_bf16 v[196:199], v[152:155], v[124:127], v[196:199]
    ds_read_b128 v[152:155], v11 offset:2048
    s_waitcnt lgkmcnt(7)
    v_mfma_f32_16x16x32_bf16 v[200:203], v[156:159], v[120:123], v[200:203]
    v_mfma_f32_16x16x32_bf16 v[204:207], v[156:159], v[124:127], v[204:207]
    s_waitcnt vmcnt(0)
    v_max_u32 v10, v131, v135
    v_cmp_eq_u32 vcc, -1, v10
    s_nop 0
    s_cbranch_vccnz km_retry17
km_back17:
    ds_read_b128 v[156:159], v11 offset:3072
    s_waitcnt lgkmcnt(7)
    v_mfma_f32_16x16x32_bf16 v[176:179], v[160:163], v[128:131], v[176:179]
    v_mfma_f32_16x16x32_bf16 v[180:183], v[160:163], v[132:135], v[180:183]
    ds_read_b128 v[160:163], v11 offset:4096
    s_waitcnt lgkmcnt(7)
    v_mfma_f32_16x16x32_bf16 v[184:187], v[164:167], v[128:131], v[184:187]
    v_mfma_f32_16x16x32_bf16 v[188:191], v[164:167], v[132:135], v[188:191]
    ds_read_b128 v[164:167], v11 offset:5120
    s_waitcnt lgkmcnt(7)
    v_mfma_f32_16x16x32_bf16 v[192:195], v[168:171], v[128:131], v[192:195]
    v_mfma_f32_16x16x32_bf16 v[196:199], v[168:171], v[132:135], v[196:199]
    ds_read_b128 v[168:171], v11 offset:6144
    s_waitcnt lgkmcnt(7)
    v_mfma_f32_16x16x32_bf16 v[200:203], v[172:175], v[128:131], v[200:203]
    v_mfma_f32_16x16x32_bf16 v[204:207], v[172:175], v[132:135], v[204:207]
    s_barrier
    ds_read_b128 v[172:175], v11 offset:7168
    s_waitcnt lgkmcnt(7)
    v_mfma_f32_16x16x32_bf16 v[208:211], v[144:147], v[16:19], 0
    v_mfma_f32_16x16x32_bf16 v[212:215], v[144:147], v[20:23], 0
    ds_read_b128 v[144:147], v11 offset:8192
    s_waitcnt lgkmcnt(7)
    v_mfma_f32_16x16x32_bf16 v[208:211], v[148:151], v[24:27], v[208:211]
    v_cvt_pk_bf16_f32 v232, v176, v177
    v_cvt_pk_bf16_f32 v234, v178, v179
    v_mfma_f32_16x16x32_bf16 v[212:215], v[148:151], v[28:31], v[212:215]
    v_and_b32 v233, 0xffff0000, v232
    v_lshlrev_b32 v232, 16, v232
    v_and_b32 v235, 0xffff0000, v234
    ds_read_b128 v[148:151], v11 offset:9216
    v_lshlrev_b32 v234, 16, v234
    v_mul_f32 v236, 0xbfb8aa3b, v232
    v_mul_f32 v237, 0xbfb8aa3b, v233
    s_waitcnt lgkmcnt(7)
    v_mfma_f32_16x16x32_bf16 v[208:211], v[152:155], v[32:35], v[208:211]
    v_mul_f32 v238, 0xbfb8aa3b, v234
    v_mul_f32 v239, 0xbfb8aa3b, v235
    v_mfma_f32_16x16x32_bf16 v[212:215], v[152:155], v[36:39], v[212:215]
    v_exp_f32 v236, v236
    s_add_u32 s60, s57, 12288
    buffer_load_dwordx4 a[48:51], v2, s[8:11], s60 offen
    v_exp_f32 v237, v237
    v_exp_f32 v238, v238
    ds_read_b128 v[152:155], v11 offset:10240
    v_exp_f32 v239, v239
    v_add_f32 v236, 1.0, v236
    v_add_f32 v237, 1.0, v237
    s_waitcnt lgkmcnt(7)
    v_mfma_f32_16x16x32_bf16 v[208:211], v[156:159], v[40:43], v[208:211]
    v_add_f32 v238, 1.0, v238
    v_add_f32 v239, 1.0, v239
    v_mfma_f32_16x16x32_bf16 v[212:215], v[156:159], v[44:47], v[212:215]
    v_rcp_f32 v236, v236
    v_rcp_f32 v237, v237
    v_rcp_f32 v238, v238
    ds_read_b128 v[156:159], v11 offset:11264
    v_rcp_f32 v239, v239
    v_mul_f32 v232, v232, v236
    v_mul_f32 v233, v233, v237
    s_waitcnt lgkmcnt(7)
    v_mfma_f32_16x16x32_bf16 v[208:211], v[160:163], v[48:51], v[208:211]
    v_mul_f32 v234, v234, v238
    v_mul_f32 v235, v235, v239
    buffer_load_dwordx4 a[52:55], v2, s[8:11], s60 offen offset:1024
    v_mfma_f32_16x16x32_bf16 v[212:215], v[160:163], v[52:55], v[212:215]
    v_cvt_pk_bf16_f32 v240, v232, v233
    v_cvt_pk_bf16_f32 v241, v234, v235
    v_min_u32 v241, -2, v241
    ds_read_b128 v[160:163], v11 offset:12288
    v_cvt_pk_bf16_f32 v232, v180, v181
    v_cvt_pk_bf16_f32 v234, v182, v183
    v_and_b32 v233, 0xffff0000, v232
    s_waitcnt lgkmcnt(7)
    v_mfma_f32_16x16x32_bf16 v[208:211], v[164:167], v[56:59], v[208:211]
    v_lshlrev_b32 v232, 16, v232
    v_and_b32 v235, 0xffff0000, v234
    v_mfma_f32_16x16x32_bf16 v[212:215], v[164:167], v[60:63], v[212:215]
    v_lshlrev_b32 v234, 16, v234
    v_mul_f32 v236, 0xbfb8aa3b, v232
    v_mul_f32 v237, 0xbfb8aa3b, v233
    ds_read_b128 v[164:167], v11 offset:13312
    v_mul_f32 v238, 0xbfb8aa3b, v234
    v_mul_f32 v239, 0xbfb8aa3b, v235
    v_exp_f32 v236, v236
    s_waitcnt lgkmcnt(7)
    v_mfma_f32_16x16x32_bf16 v[208:211], v[168:171], v[64:67], v[208:211]
    buffer_load_dwordx4 a[56:59], v2, s[8:11], s60 offen offset:2048
    v_exp_f32 v237, v237
    v_exp_f32 v238, v238
    v_mfma_f32_16x16x32_bf16 v[212:215], v[168:171], v[68:71], v[212:215]
    v_exp_f32 v239, v239
    v_add_f32 v236, 1.0, v236
    v_add_f32 v237, 1.0, v237
    ds_read_b128 v[168:171], v11 offset:14336
    v_add_f32 v238, 1.0, v238
    v_add_f32 v239, 1.0, v239
    v_rcp_f32 v236, v236
    s_waitcnt lgkmcnt(7)
    v_mfma_f32_16x16x32_bf16 v[208:211], v[172:175], v[72:75], v[208:211]
    v_rcp_f32 v237, v237
    v_rcp_f32 v238, v238
    v_mfma_f32_16x16x32_bf16 v[212:215], v[172:175], v[76:79], v[212:215]
    v_rcp_f32 v239, v239
    v_mul_f32 v232, v232, v236
    v_mul_f32 v233, v233, v237
    ds_read_b128 v[172:175], v11 offset:15360
    v_mul_f32 v234, v234, v238
    buffer_load_dwordx4 a[60:63], v2, s[8:11], s60 offen offset:3072
    v_mul_f32 v235, v235, v239
    v_cvt_pk_bf16_f32 v248, v232, v233
    s_waitcnt lgkmcnt(7)
    v_mfma_f32_16x16x32_bf16 v[208:211], v[144:147], v[80:83], v[208:211]
    v_cvt_pk_bf16_f32 v249, v234, v235
    v_min_u32 v249, -2, v249
    v_cvt_pk_bf16_f32 v232, v184, v185
    v_mfma_f32_16x16x32_bf16 v[212:215], v[144:147], v[84:87], v[212:215]
    v_cvt_pk_bf16_f32 v234, v186, v187
    v_and_b32 v233, 0xffff0000, v232
    ds_read_b128 v[144:147], v11 offset:16384
    v_lshlrev_b32 v232, 16, v232
    v_and_b32 v235, 0xffff0000, v234
    v_lshlrev_b32 v234, 16, v234
    s_waitcnt lgkmcnt(7)
    v_mfma_f32_16x16x32_bf16 v[208:211], v[148:151], v[88:91], v[208:211]
    v_mul_f32 v236, 0xbfb8aa3b, v232
    v_mul_f32 v237, 0xbfb8aa3b, v233
    v_mul_f32 v238, 0xbfb8aa3b, v234
    v_mfma_f32_16x16x32_bf16 v[212:215], v[148:151], v[92:95], v[212:215]
    v_mul_f32 v239, 0xbfb8aa3b, v235
    v_exp_f32 v236, v236
    s_add_u32 s60, s57, 24576
    buffer_load_dwordx4 a[96:99], v2, s[8:11], s60 offen
    ds_read_b128 v[148:151], v11 offset:17408
    v_exp_f32 v237, v237
    v_exp_f32 v238, v238
    v_exp_f32 v239, v239
    s_waitcnt lgkmcnt(7)
    v_mfma_f32_16x16x32_bf16 v[208:211], v[152:155], v[96:99], v[208:211]
    v_add_f32 v236, 1.0, v236
    v_add_f32 v237, 1.0, v237
    v_add_f32 v238, 1.0, v238
    v_mfma_f32_16x16x32_bf16 v[212:215], v[152:155], v[100:103], v[212:215]
    v_add_f32 v239, 1.0, v239
    v_rcp_f32 v236, v236
    ds_read_b128 v[152:155], v11 offset:18432
    v_rcp_f32 v237, v237
    v_rcp_f32 v238, v238
    v_rcp_f32 v239, v239
    s_waitcnt lgkmcnt(7)
    v_mfma_f32_16x16x32_bf16 v[208:211], v[156:159], v[104:107], v[208:211]
    v_mul_f32 v232, v232, v236
    v_mul_f32 v233, v233, v237
    v_mul_f32 v234, v234, v238
    v_mfma_f32_16x16x32_bf16 v[212:215], v[156:159], v[108:111], v[212:215]
    buffer_load_dwordx4 a[100:103], v2, s[8:11], s60 offen offset:1024
    v_mul_f32 v235, v235, v239
    v_cvt_pk_bf16_f32 v242, v232, v233
    ds_read_b128 v[156:159], v11 offset:19456
    v_cvt_pk_bf16_f32 v243, v234, v235
    v_min_u32 v243, -2, v243
    v_cvt_pk_bf16_f32 v232, v188, v189
    s_waitcnt lgkmcnt(7)
    v_mfma_f32_16x16x32_bf16 v[208:211], v[160:163], v[112:115], v[208:211]
    v_cvt_pk_bf16_f32 v234, v190, v191
    v_and_b32 v233, 0xffff0000, v232
    v_lshlrev_b32 v232, 16, v232
    v_mfma_f32_16x16x32_bf16 v[212:215], v[160:163], v[116:119], v[212:215]
    v_and_b32 v235, 0xffff0000, v234
    v_lshlrev_b32 v234, 16, v234
    ds_read_b128 v[160:163], v11 offset:20480
    v_mul_f32 v236, 0xbfb8aa3b, v232
    v_mul_f32 v237, 0xbfb8aa3b, v233
    v_mul_f32 v238, 0xbfb8aa3b, v234
    s_waitcnt lgkmcnt(7)
    v_mfma_f32_16x16x32_bf16 v[208:211], v[164:167], v[120:123], v[208:211]
    v_mul_f32 v239, 0xbfb8aa3b, v235
    buffer_load_dwordx4 a[104:107], v2, s[8:11], s60 offen offset:2048
    v_exp_f32 v236, v236
    v_exp_f32 v237, v237
    v_mfma_f32_16x16x32_bf16 v[212:215], v[164:167], v[124:127], v[212:215]
    v_exp_f32 v238, v238
    v_exp_f32 v239, v239
    ds_read_b128 v[164:167], v11 offset:21504
    v_add_f32 v236, 1.0, v236
    v_add_f32 v237, 1.0, v237
    v_add_f32 v238, 1.0, v238
    s_waitcnt lgkmcnt(7)
    v_mfma_f32_16x16x32_bf16 v[208:211], v[168:171], v[128:131], v[208:211]
    v_add_f32 v239, 1.0, v239
    v_rcp_f32 v236, v236
    v_rcp_f32 v237, v237
    v_mfma_f32_16x16x32_bf16 v[212:215], v[168:171], v[132:135], v[212:215]
    v_rcp_f32 v238, v238
    v_rcp_f32 v239, v239
    ds_read_b128 v[168:171], v11 offset:22528
    v_mul_f32 v232, v232, v236
    v_mul_f32 v233, v233, v237
    v_mul_f32 v234, v234, v238
    buffer_load_dwordx4 a[108:111], v2, s[8:11], s60 offen offset:3072
    s_waitcnt lgkmcnt(7)
    v_mfma_f32_16x16x32_bf16 v[208:211], v[172:175], v[136:139], v[208:211]
    v_mul_f32 v235, v235, v239
    v_cvt_pk_bf16_f32 v250, v232, v233
    v_cvt_pk_bf16_f32 v251, v234, v235
    v_mfma_f32_16x16x32_bf16 v[212:215], v[172:175], v[140:143], v[212:215]
    v_min_u32 v251, -2, v251
    buffer_store_dwordx4 v[240:243], v2, s[8:11], s42 offen offset:0 sc1
    buffer_store_dwordx4 v[248:251], v2, s[8:11], s5 offen offset:0 sc1
    ds_read_b128 v[172:175], v11 offset:23552
    v_cvt_pk_bf16_f32 v232, v192, v193
    v_cvt_pk_bf16_f32 v234, v194, v195
    s_waitcnt lgkmcnt(7)
    v_mfma_f32_16x16x32_bf16 v[216:219], v[144:147], v[16:19], 0
    v_and_b32 v233, 0xffff0000, v232
    v_lshlrev_b32 v232, 16, v232
    v_and_b32 v235, 0xffff0000, v234
    v_mfma_f32_16x16x32_bf16 v[220:223], v[144:147], v[20:23], 0
    v_lshlrev_b32 v234, 16, v234
    v_mul_f32 v236, 0xbfb8aa3b, v232
    ds_read_b128 v[144:147], v11 offset:24576
    v_mul_f32 v237, 0xbfb8aa3b, v233
    s_add_u32 s60, s57, 8192
    buffer_load_dwordx4 a[32:35], v2, s[8:11], s60 offen
    v_mul_f32 v238, 0xbfb8aa3b, v234
    v_mul_f32 v239, 0xbfb8aa3b, v235
    s_waitcnt lgkmcnt(7)
    v_mfma_f32_16x16x32_bf16 v[216:219], v[148:151], v[24:27], v[216:219]
    v_exp_f32 v236, v236
    v_exp_f32 v237, v237
    v_mfma_f32_16x16x32_bf16 v[220:223], v[148:151], v[28:31], v[220:223]
    v_exp_f32 v238, v238
    v_exp_f32 v239, v239
    v_add_f32 v236, 1.0, v236
    ds_read_b128 v[148:151], v11 offset:25600
    v_add_f32 v237, 1.0, v237
    v_add_f32 v238, 1.0, v238
    s_waitcnt lgkmcnt(7)
    v_mfma_f32_16x16x32_bf16 v[216:219], v[152:155], v[32:35], v[216:219]
    v_add_f32 v239, 1.0, v239
    v_rcp_f32 v236, v236
    v_rcp_f32 v237, v237
    v_mfma_f32_16x16x32_bf16 v[220:223], v[152:155], v[36:39], v[220:223]
    v_rcp_f32 v238, v238
    v_rcp_f32 v239, v239
    ds_read_b128 v[152:155], v11 offset:26624
    buffer_load_dwordx4 a[36:39], v2, s[8:11], s60 offen offset:1024
    v_mul_f32 v232, v232, v236
    v_mul_f32 v233, v233, v237
    v_mul_f32 v234, v234, v238
    s_waitcnt lgkmcnt(7)
    v_mfma_f32_16x16x32_bf16 v[216:219], v[156:159], v[40:43], v[216:219]
    v_mul_f32 v235, v235, v239
    v_cvt_pk_bf16_f32 v244, v232, v233
    v_mfma_f32_16x16x32_bf16 v[220:223], v[156:159], v[44:47], v[220:223]
    v_cvt_pk_bf16_f32 v245, v234, v235
    v_min_u32 v245, -2, v245
    v_cvt_pk_bf16_f32 v232, v196, v197
    ds_read_b128 v[156:159], v11 offset:27648
    v_cvt_pk_bf16_f32 v234, v198, v199
    v_and_b32 v233, 0xffff0000, v232
    s_waitcnt lgkmcnt(7)
    v_mfma_f32_16x16x32_bf16 v[216:219], v[160:163], v[48:51], v[216:219]
    v_lshlrev_b32 v232, 16, v232
    v_and_b32 v235, 0xffff0000, v234
    v_lshlrev_b32 v234, 16, v234
    v_mfma_f32_16x16x32_bf16 v[220:223], v[160:163], v[52:55], v[220:223]
    v_mul_f32 v236, 0xbfb8aa3b, v232
    buffer_load_dwordx4 a[40:43], v2, s[8:11], s60 offen offset:2048
    v_mul_f32 v237, 0xbfb8aa3b, v233
    ds_read_b128 v[160:163], v11 offset:28672
    v_mul_f32 v238, 0xbfb8aa3b, v234
    v_mul_f32 v239, 0xbfb8aa3b, v235
    v_exp_f32 v236, v236
    s_waitcnt lgkmcnt(7)
    v_mfma_f32_16x16x32_bf16 v[216:219], v[164:167], v[56:59], v[216:219]
    v_exp_f32 v237, v237
    v_exp_f32 v238, v238
    v_mfma_f32_16x16x32_bf16 v[220:223], v[164:167], v[60:63], v[220:223]
    v_exp_f32 v239, v239
    v_add_f32 v236, 1.0, v236
    v_add_f32 v237, 1.0, v237
    ds_read_b128 v[164:167], v11 offset:29696
    v_add_f32 v238, 1.0, v238
    v_add_f32 v239, 1.0, v239
    s_waitcnt lgkmcnt(7)
    v_mfma_f32_16x16x32_bf16 v[216:219], v[168:171], v[64:67], v[216:219]
    v_rcp_f32 v236, v236
    v_rcp_f32 v237, v237
    v_rcp_f32 v238, v238
    v_mfma_f32_16x16x32_bf16 v[220:223], v[168:171], v[68:71], v[220:223]
    buffer_load_dwordx4 a[44:47], v2, s[8:11], s60 offen offset:3072
    v_rcp_f32 v239, v239
    v_mul_f32 v232, v232, v236
    ds_read_b128 v[168:171], v11 offset:30720
    v_mul_f32 v233, v233, v237
    v_mul_f32 v234, v234, v238
    v_mul_f32 v235, v235, v239
    s_waitcnt lgkmcnt(7)
    v_mfma_f32_16x16x32_bf16 v[216:219], v[172:175], v[72:75], v[216:219]
    v_cvt_pk_bf16_f32 v252, v232, v233
    v_cvt_pk_bf16_f32 v253, v234, v235
    v_mfma_f32_16x16x32_bf16 v[220:223], v[172:175], v[76:79], v[220:223]
    v_min_u32 v253, -2, v253
    v_cvt_pk_bf16_f32 v232, v200, v201
    v_cvt_pk_bf16_f32 v234, v202, v203
    ds_read_b128 v[172:175], v11 offset:31744
    v_and_b32 v233, 0xffff0000, v232
    v_lshlrev_b32 v232, 16, v232
    s_waitcnt lgkmcnt(7)
    v_mfma_f32_16x16x32_bf16 v[216:219], v[144:147], v[80:83], v[216:219]
    v_and_b32 v235, 0xffff0000, v234
    v_lshlrev_b32 v234, 16, v234
    v_mul_f32 v236, 0xbfb8aa3b, v232
    s_add_u32 s60, s58, 40960
    buffer_load_dwordx4 a[160:163], v2, s[8:11], s60 offen
    v_mfma_f32_16x16x32_bf16 v[220:223], v[144:147], v[84:87], v[220:223]
    v_mul_f32 v237, 0xbfb8aa3b, v233
    v_mul_f32 v238, 0xbfb8aa3b, v234
    ds_read_b128 v[144:147], v11 offset:32768
    v_mul_f32 v239, 0xbfb8aa3b, v235
    v_exp_f32 v236, v236
    v_exp_f32 v237, v237
    s_waitcnt lgkmcnt(7)
    v_mfma_f32_16x16x32_bf16 v[216:219], v[148:151], v[88:91], v[216:219]
    v_exp_f32 v238, v238
    v_exp_f32 v239, v239
    v_mfma_f32_16x16x32_bf16 v[220:223], v[148:151], v[92:95], v[220:223]
    v_add_f32 v236, 1.0, v236
    v_add_f32 v237, 1.0, v237
    v_add_f32 v238, 1.0, v238
    ds_read_b128 v[148:151], v11 offset:33792
    v_add_f32 v239, 1.0, v239
    v_rcp_f32 v236, v236
    s_waitcnt lgkmcnt(7)
    v_mfma_f32_16x16x32_bf16 v[216:219], v[152:155], v[96:99], v[216:219]
    v_rcp_f32 v237, v237
    buffer_load_dwordx4 a[164:167], v2, s[8:11], s60 offen offset:1024
    v_rcp_f32 v238, v238
    v_rcp_f32 v239, v239
    v_mfma_f32_16x16x32_bf16 v[220:223], v[152:155], v[100:103], v[220:223]
    v_mul_f32 v232, v232, v236
    v_mul_f32 v233, v233, v237
    ds_read_b128 v[152:155], v11 offset:34816
    v_mul_f32 v234, v234, v238
    v_mul_f32 v235, v235, v239
    v_cvt_pk_bf16_f32 v246, v232, v233
    s_waitcnt lgkmcnt(7)
    v_mfma_f32_16x16x32_bf16 v[216:219], v[156:159], v[104:107], v[216:219]
    v_cvt_pk_bf16_f32 v247, v234, v235
    v_min_u32 v247, -2, v247
    v_mfma_f32_16x16x32_bf16 v[220:223], v[156:159], v[108:111], v[220:223]
    v_cvt_pk_bf16_f32 v232, v204, v205
    v_cvt_pk_bf16_f32 v234, v206, v207
    v_and_b32 v233, 0xffff0000, v232
    ds_read_b128 v[156:159], v11 offset:35840
    v_lshlrev_b32 v232, 16, v232
    v_and_b32 v235, 0xffff0000, v234
    s_waitcnt lgkmcnt(7)
    v_mfma_f32_16x16x32_bf16 v[216:219], v[160:163], v[112:115], v[216:219]
    buffer_load_dwordx4 a[168:171], v2, s[8:11], s60 offen offset:2048
    v_lshlrev_b32 v234, 16, v234
    v_mul_f32 v236, 0xbfb8aa3b, v232
    v_mul_f32 v237, 0xbfb8aa3b, v233
    v_mfma_f32_16x16x32_bf16 v[220:223], v[160:163], v[116:119], v[220:223]
    v_mul_f32 v238, 0xbfb8aa3b, v234
    v_mul_f32 v239, 0xbfb8aa3b, v235
    ds_read_b128 v[160:163], v11 offset:36864
    v_exp_f32 v236, v236
    v_exp_f32 v237, v237
    v_exp_f32 v238, v238
    s_waitcnt lgkmcnt(7)
    v_mfma_f32_16x16x32_bf16 v[216:219], v[164:167], v[120:123], v[216:219]
    v_exp_f32 v239, v239
    v_add_f32 v236, 1.0, v236
    v_mfma_f32_16x16x32_bf16 v[220:223], v[164:167], v[124:127], v[220:223]
    v_add_f32 v237, 1.0, v237
    v_add_f32 v238, 1.0, v238
    v_add_f32 v239, 1.0, v239
    ds_read_b128 v[164:167], v11 offset:37888
    v_rcp_f32 v236, v236
    v_rcp_f32 v237, v237
    buffer_load_dwordx4 a[172:175], v2, s[8:11], s60 offen offset:3072
    s_waitcnt lgkmcnt(7)
    v_mfma_f32_16x16x32_bf16 v[216:219], v[168:171], v[128:131], v[216:219]
    v_rcp_f32 v238, v238
    v_rcp_f32 v239, v239
    v_mul_f32 v232, v232, v236
    v_mfma_f32_16x16x32_bf16 v[220:223], v[168:171], v[132:135], v[220:223]
    v_mul_f32 v233, v233, v237
    v_mul_f32 v234, v234, v238
    ds_read_b128 v[168:171], v11 offset:38912
    v_mul_f32 v235, v235, v239
    v_cvt_pk_bf16_f32 v254, v232, v233
    v_cvt_pk_bf16_f32 v255, v234, v235
    s_waitcnt lgkmcnt(7)
    v_mfma_f32_16x16x32_bf16 v[216:219], v[172:175], v[136:139], v[216:219]
    v_min_u32 v255, -2, v255
    s_waitcnt vmcnt(9)
    v_mfma_f32_16x16x32_bf16 v[220:223], v[172:175], v[140:143], v[220:223]
    buffer_store_dwordx4 v[244:247], v2, s[8:11], s42 offen offset:1024 sc1
    s_waitcnt vmcnt(9)
    buffer_store_dwordx4 v[252:255], v2, s[8:11], s5 offen offset:1024 sc1
    ds_read_b128 v[172:175], v11 offset:39936
    v_cvt_pk_bf16_f32 v232, v208, v209
    s_add_u32 s60, s58, 53248
    buffer_load_dwordx4 a[208:211], v2, s[8:11], s60 offen
    v_cvt_pk_bf16_f32 v234, v210, v211
    s_waitcnt lgkmcnt(7)
    v_mfma_f32_16x16x32_bf16 v[224:227], v[144:147], v[16:19], 0
    v_and_b32 v233, 0xffff0000, v232
    v_lshlrev_b32 v232, 16, v232
    v_and_b32 v235, 0xffff0000, v234
    v_mfma_f32_16x16x32_bf16 v[228:231], v[144:147], v[20:23], 0
    v_lshlrev_b32 v234, 16, v234
    v_mul_f32 v236, 0xbfb8aa3b, v232
    v_mul_f32 v237, 0xbfb8aa3b, v233
    ds_read_b128 v[144:147], v11 offset:40960
    v_mul_f32 v238, 0xbfb8aa3b, v234
    v_mul_f32 v239, 0xbfb8aa3b, v235
    v_exp_f32 v236, v236
    s_waitcnt lgkmcnt(7)
    v_mfma_f32_16x16x32_bf16 v[224:227], v[148:151], v[24:27], v[224:227]
    v_exp_f32 v237, v237
    v_exp_f32 v238, v238
    v_exp_f32 v239, v239
    v_mfma_f32_16x16x32_bf16 v[228:231], v[148:151], v[28:31], v[228:231]
    v_add_f32 v236, 1.0, v236
    buffer_load_dwordx4 a[212:215], v2, s[8:11], s60 offen offset:1024
    v_add_f32 v237, 1.0, v237
    v_add_f32 v238, 1.0, v238
    ds_read_b128 v[148:151], v11 offset:41984
    v_add_f32 v239, 1.0, v239
    v_rcp_f32 v236, v236
    v_rcp_f32 v237, v237
    s_waitcnt lgkmcnt(7)
    v_mfma_f32_16x16x32_bf16 v[224:227], v[152:155], v[32:35], v[224:227]
    v_rcp_f32 v238, v238
    v_rcp_f32 v239, v239
    v_mul_f32 v232, v232, v236
    v_mfma_f32_16x16x32_bf16 v[228:231], v[152:155], v[36:39], v[228:231]
    v_mul_f32 v233, v233, v237
    v_mul_f32 v234, v234, v238
    ds_read_b128 v[152:155], v11 offset:43008
    v_mul_f32 v235, v235, v239
    v_cvt_pk_bf16_f32 v240, v232, v233
    v_cvt_pk_bf16_f32 v241, v234, v235
    s_waitcnt lgkmcnt(7)
    v_mfma_f32_16x16x32_bf16 v[224:227], v[156:159], v[40:43], v[224:227]
    v_min_u32 v241, -2, v241
    v_cvt_pk_bf16_f32 v232, v212, v213
    buffer_load_dwordx4 a[216:219], v2, s[8:11], s60 offen offset:2048
    v_cvt_pk_bf16_f32 v234, v214, v215
    v_mfma_f32_16x16x32_bf16 v[228:231], v[156:159], v[44:47], v[228:231]
    v_and_b32 v233, 0xffff0000, v232
    v_lshlrev_b32 v232, 16, v232
    v_and_b32 v235, 0xffff0000, v234
    ds_read_b128 v[156:159], v11 offset:44032
    v_lshlrev_b32 v234, 16, v234
    v_mul_f32 v236, 0xbfb8aa3b, v232
    v_mul_f32 v237, 0xbfb8aa3b, v233
    s_waitcnt lgkmcnt(7)
    v_mfma_f32_16x16x32_bf16 v[224:227], v[160:163], v[48:51], v[224:227]
    v_mul_f32 v238, 0xbfb8aa3b, v234
    v_mul_f32 v239, 0xbfb8aa3b, v235
    v_exp_f32 v236, v236
    v_mfma_f32_16x16x32_bf16 v[228:231], v[160:163], v[52:55], v[228:231]
    v_exp_f32 v237, v237
    v_exp_f32 v238, v238
    v_exp_f32 v239, v239
    ds_read_b128 v[160:163], v11 offset:45056
    v_add_f32 v236, 1.0, v236
    v_add_f32 v237, 1.0, v237
    buffer_load_dwordx4 a[220:223], v2, s[8:11], s60 offen offset:3072
    v_add_f32 v238, 1.0, v238
    s_waitcnt lgkmcnt(7)
    v_mfma_f32_16x16x32_bf16 v[224:227], v[164:167], v[56:59], v[224:227]
    v_add_f32 v239, 1.0, v239
    v_rcp_f32 v236, v236
    v_mfma_f32_16x16x32_bf16 v[228:231], v[164:167], v[60:63], v[228:231]
    v_rcp_f32 v237, v237
    v_rcp_f32 v238, v238
    v_rcp_f32 v239, v239
    ds_read_b128 v[164:167], v11 offset:46080
    v_mul_f32 v232, v232, v236
    v_mul_f32 v233, v233, v237
    v_mul_f32 v234, v234, v238
    s_waitcnt lgkmcnt(7)
    v_mfma_f32_16x16x32_bf16 v[224:227], v[168:171], v[64:67], v[224:227]
    v_mul_f32 v235, v235, v239
    v_cvt_pk_bf16_f32 v248, v232, v233
    v_cvt_pk_bf16_f32 v249, v234, v235
    v_mfma_f32_16x16x32_bf16 v[228:231], v[168:171], v[68:71], v[228:231]
    v_min_u32 v249, -2, v249
    v_cvt_pk_bf16_f32 v232, v216, v217
    s_add_u32 s60, s58, 36864
    buffer_load_dwordx4 a[144:147], v2, s[8:11], s60 offen
    v_cvt_pk_bf16_f32 v234, v218, v219
    ds_read_b128 v[168:171], v11 offset:47104
    v_and_b32 v233, 0xffff0000, v232
    v_lshlrev_b32 v232, 16, v232
    v_and_b32 v235, 0xffff0000, v234
    s_waitcnt lgkmcnt(7)
    v_mfma_f32_16x16x32_bf16 v[224:227], v[172:175], v[72:75], v[224:227]
    v_lshlrev_b32 v234, 16, v234
    v_mul_f32 v236, 0xbfb8aa3b, v232
    v_mul_f32 v237, 0xbfb8aa3b, v233
    v_mfma_f32_16x16x32_bf16 v[228:231], v[172:175], v[76:79], v[228:231]
    v_mul_f32 v238, 0xbfb8aa3b, v234
    v_mul_f32 v239, 0xbfb8aa3b, v235
    v_exp_f32 v236, v236
    ds_read_b128 v[172:175], v11 offset:48128
    v_exp_f32 v237, v237
    v_exp_f32 v238, v238
    s_waitcnt lgkmcnt(7)
    v_mfma_f32_16x16x32_bf16 v[224:227], v[144:147], v[80:83], v[224:227]
    v_exp_f32 v239, v239
    v_add_f32 v236, 1.0, v236
    v_add_f32 v237, 1.0, v237
    buffer_load_dwordx4 a[148:151], v2, s[8:11], s60 offen offset:1024
    v_mfma_f32_16x16x32_bf16 v[228:231], v[144:147], v[84:87], v[228:231]
    v_add_f32 v238, 1.0, v238
    v_add_f32 v239, 1.0, v239
    v_rcp_f32 v236, v236
    s_waitcnt lgkmcnt(6)
    v_mfma_f32_16x16x32_bf16 v[224:227], v[148:151], v[88:91], v[224:227]
    v_rcp_f32 v237, v237
    v_rcp_f32 v238, v238
    v_rcp_f32 v239, v239
    v_mfma_f32_16x16x32_bf16 v[228:231], v[148:151], v[92:95], v[228:231]
    v_mul_f32 v232, v232, v236
    v_mul_f32 v233, v233, v237
    v_mul_f32 v234, v234, v238
    s_waitcnt lgkmcnt(5)
    v_mfma_f32_16x16x32_bf16 v[224:227], v[152:155], v[96:99], v[224:227]
    v_mul_f32 v235, v235, v239
    v_cvt_pk_bf16_f32 v242, v232, v233
    v_cvt_pk_bf16_f32 v243, v234, v235
    v_mfma_f32_16x16x32_bf16 v[228:231], v[152:155], v[100:103], v[228:231]
    v_min_u32 v243, -2, v243
    v_cvt_pk_bf16_f32 v232, v220, v221
    v_cvt_pk_bf16_f32 v234, v222, v223
    buffer_load_dwordx4 a[152:155], v2, s[8:11], s60 offen offset:2048
    s_waitcnt lgkmcnt(4)
    v_mfma_f32_16x16x32_bf16 v[224:227], v[156:159], v[104:107], v[224:227]
    v_and_b32 v233, 0xffff0000, v232
    v_lshlrev_b32 v232, 16, v232
    v_and_b32 v235, 0xffff0000, v234
    v_mfma_f32_16x16x32_bf16 v[228:231], v[156:159], v[108:111], v[228:231]
    v_lshlrev_b32 v234, 16, v234
    v_mul_f32 v236, 0xbfb8aa3b, v232
    s_waitcnt lgkmcnt(3)
    v_mfma_f32_16x16x32_bf16 v[224:227], v[160:163], v[112:115], v[224:227]
    v_mul_f32 v237, 0xbfb8aa3b, v233
    v_mul_f32 v238, 0xbfb8aa3b, v234
    v_mul_f32 v239, 0xbfb8aa3b, v235
    v_mfma_f32_16x16x32_bf16 v[228:231], v[160:163], v[116:119], v[228:231]
    v_exp_f32 v236, v236
    v_exp_f32 v237, v237
    v_exp_f32 v238, v238
    s_waitcnt lgkmcnt(2)
    v_mfma_f32_16x16x32_bf16 v[224:227], v[164:167], v[120:123], v[224:227]
    v_exp_f32 v239, v239
    v_add_f32 v236, 1.0, v236
    v_add_f32 v237, 1.0, v237
    buffer_load_dwordx4 a[156:159], v2, s[8:11], s60 offen offset:3072
    v_mfma_f32_16x16x32_bf16 v[228:231], v[164:167], v[124:127], v[228:231]
    v_add_f32 v238, 1.0, v238
    v_add_f32 v239, 1.0, v239
    v_rcp_f32 v236, v236
    s_waitcnt lgkmcnt(1)
    v_mfma_f32_16x16x32_bf16 v[224:227], v[168:171], v[128:131], v[224:227]
    v_rcp_f32 v237, v237
    v_rcp_f32 v238, v238
    v_rcp_f32 v239, v239
    v_mfma_f32_16x16x32_bf16 v[228:231], v[168:171], v[132:135], v[228:231]
    v_mul_f32 v232, v232, v236
    v_mul_f32 v233, v233, v237
    v_mul_f32 v234, v234, v238
    s_waitcnt lgkmcnt(0)
    v_mfma_f32_16x16x32_bf16 v[224:227], v[172:175], v[136:139], v[224:227]
    v_mul_f32 v235, v235, v239
    v_cvt_pk_bf16_f32 v250, v232, v233
    v_cvt_pk_bf16_f32 v251, v234, v235
    v_mfma_f32_16x16x32_bf16 v[228:231], v[172:175], v[140:143], v[228:231]
    v_min_u32 v251, -2, v251
    buffer_store_dwordx4 v[240:243], v2, s[8:11], s42 offen offset:2048 sc1
    buffer_store_dwordx4 v[248:251], v2, s[8:11], s5 offen offset:2048 sc1
    s_mul_i32 s26, s33, 229376
    s_mul_i32 s27, s3, 14336
    s_add_u32 s26, s26, s27
    s_add_u32 s26, s26, 14155776
    s_add_u32 s27, s3, 0
    s_and_b32 s27, s27, 3
    s_mul_i32 s28, s27, 57344
    v_add_u32 v9, s28, v2
    s_add_u32 s27, s3, 1
    s_and_b32 s27, s27, 3
    s_mul_i32 s29, s27, 57344
    v_add_u32 v11, s29, v2
    s_add_u32 s27, s3, 2
    s_and_b32 s27, s27, 3
    s_mul_i32 s30, s27, 57344
    v_add_u32 v12, s30, v2
    s_add_u32 s27, s3, 3
    s_and_b32 s27, s27, 3
    s_mul_i32 s31, s27, 57344
    v_add_u32 v13, s31, v2
    s_mul_i32 s27, s56, 7168
    s_add_u32 s57, s26, s27
    s_add_u32 s58, s57, 4096
    s_sub_u32 s59, s26, s27
    s_add_u32 s59, s59, 7168
    s_add_u32 s60, s59, 4096
    v_cvt_pk_bf16_f32 v232, v224, v225
    v_cvt_pk_bf16_f32 v234, v226, v227
    v_and_b32 v233, 0xffff0000, v232
    v_lshlrev_b32 v232, 16, v232
    v_and_b32 v235, 0xffff0000, v234
    v_lshlrev_b32 v234, 16, v234
    v_mul_f32 v236, 0xbfb8aa3b, v232
    v_mul_f32 v237, 0xbfb8aa3b, v233
    v_mul_f32 v238, 0xbfb8aa3b, v234
    v_mul_f32 v239, 0xbfb8aa3b, v235
    v_exp_f32 v236, v236
    v_exp_f32 v237, v237
    v_exp_f32 v238, v238
    v_exp_f32 v239, v239
    v_add_f32 v236, 1.0, v236
    v_add_f32 v237, 1.0, v237
    v_add_f32 v238, 1.0, v238
    v_add_f32 v239, 1.0, v239
    v_rcp_f32 v236, v236
    v_rcp_f32 v237, v237
    v_rcp_f32 v238, v238
    v_rcp_f32 v239, v239
    v_mul_f32 v232, v232, v236
    v_mul_f32 v233, v233, v237
    v_mul_f32 v234, v234, v238
    v_mul_f32 v235, v235, v239
    v_cvt_pk_bf16_f32 v244, v232, v233
    v_cvt_pk_bf16_f32 v245, v234, v235
    v_min_u32 v245, -2, v245
    v_cvt_pk_bf16_f32 v232, v228, v229
    v_cvt_pk_bf16_f32 v234, v230, v231
    v_and_b32 v233, 0xffff0000, v232
    v_lshlrev_b32 v232, 16, v232
    v_and_b32 v235, 0xffff0000, v234
    v_lshlrev_b32 v234, 16, v234
    v_mul_f32 v236, 0xbfb8aa3b, v232
    v_mul_f32 v237, 0xbfb8aa3b, v233
    v_mul_f32 v238, 0xbfb8aa3b, v234
    v_mul_f32 v239, 0xbfb8aa3b, v235
    v_exp_f32 v236, v236
    v_exp_f32 v237, v237
    v_exp_f32 v238, v238
    v_exp_f32 v239, v239
    v_add_f32 v236, 1.0, v236
    v_add_f32 v237, 1.0, v237
    v_add_f32 v238, 1.0, v238
    v_add_f32 v239, 1.0, v239
    v_rcp_f32 v236, v236
    v_rcp_f32 v237, v237
    v_rcp_f32 v238, v238
    v_rcp_f32 v239, v239
    v_mul_f32 v232, v232, v236
    v_mul_f32 v233, v233, v237
    v_mul_f32 v234, v234, v238
    v_mul_f32 v235, v235, v239
    v_cvt_pk_bf16_f32 v252, v232, v233
    v_cvt_pk_bf16_f32 v253, v234, v235
    v_min_u32 v253, -2, v253
    buffer_store_dwordx2 v[244:245], v3, s[8:11], s47 offen sc1
    buffer_store_dwordx2 v[252:253], v3, s[8:11], s48 offen sc1
    buffer_load_dwordx4 v[16:19], v9, s[8:11], s57 offen offset:1024 sc1
    buffer_load_dwordx4 v[20:23], v11, s[8:11], s57 offen offset:1024 sc1
    buffer_load_dwordx4 v[24:27], v12, s[8:11], s57 offen offset:1024 sc1
    buffer_load_dwordx4 v[28:31], v13, s[8:11], s57 offen offset:1024 sc1
    buffer_load_dwordx4 v[32:35], v9, s[8:11], s58 offen offset:1024 sc1
    buffer_load_dwordx4 v[36:39], v11, s[8:11], s58 offen offset:1024 sc1
    buffer_load_dwordx4 v[40:43], v12, s[8:11], s58 offen offset:1024 sc1
    buffer_load_dwordx4 v[44:47], v13, s[8:11], s58 offen offset:1024 sc1
    buffer_load_dwordx4 v[48:51], v9, s[8:11], s59 offen offset:1024 sc1
    buffer_load_dwordx4 v[52:55], v11, s[8:11], s59 offen offset:1024 sc1
    buffer_load_dwordx4 v[56:59], v12, s[8:11], s59 offen offset:1024 sc1
    buffer_load_dwordx4 v[60:63], v13, s[8:11], s59 offen offset:1024 sc1
    buffer_load_dwordx4 v[64:67], v9, s[8:11], s60 offen offset:1024 sc1
    buffer_load_dwordx4 v[68:71], v11, s[8:11], s60 offen offset:1024 sc1
    buffer_load_dwordx4 v[72:75], v12, s[8:11], s60 offen offset:1024 sc1
    buffer_load_dwordx4 v[76:79], v13, s[8:11], s60 offen offset:1024 sc1
    v_add_u32 v240, s28, v3
    v_add_u32 v241, s29, v3
    v_add_u32 v242, s30, v3
    v_add_u32 v243, s31, v3
    v_and_b32 v247, 3, v1
    v_mul_u32_u24 v247, 57344, v247
    v_bfe_u32 v10, v1, 3, 1
    v_mul_u32_u24 v10, 7168, v10
    v_add_u32 v247, v247, v10
    v_bfe_u32 v10, v1, 2, 1
    v_lshl_add_u32 v247, v10, 9, v247
    v_bfe_u32 v244, v5, 1, 2
    v_lshlrev_b32 v244, 5, v244
    v_lshrrev_b32 v10, 3, v5
    v_add_u32 v244, v244, v10
    v_and_b32 v10, 1, v5
    v_lshl_add_u32 v244, v10, 10, v244
    v_lshlrev_b32 v244, 10, v244
    v_lshl_add_u32 v244, v4, 5, v244
    s_lshl_b32 s50, s37, 7
    s_lshl_b32 s51, s36, 3
    s_add_u32 s50, s50, s51
    s_lshl_b32 s51, s3, 1
    s_add_u32 s50, s50, s51
    s_lshl_b32 s50, s50, 10
    s_lshl_b32 s51, s39, 7
    s_add_u32 s50, s50, s51
    v_lshlrev_b32 v245, 10, v5
    v_and_b32 v10, 1, v4
    v_lshl_add_u32 v245, v10, 9, v245
    v_lshrrev_b32 v10, 1, v4
    v_lshl_add_u32 v245, v10, 4, v245
    s_lshl_b32 s51, s33, 16
    s_lshl_b32 s54, s3, 14
    s_add_u32 s51, s51, s54
    s_lshl_b32 s54, s39, 5
    s_add_u32 s51, s51, s54
    s_add_u32 s51, s51, 6291456
    s_add_u32 s54, s3, 1
    s_and_b32 s54, s54, 3
    s_mul_i32 s54, s54, 3
    s_add_u32 s54, s54, 0
    s_lshl_b32 s54, s54, 12
    s_add_u32 s54, s54, 114688
    v_add_u32 v249, s54, v2
    s_add_u32 s54, s3, 2
    s_and_b32 s54, s54, 3
    s_mul_i32 s54, s54, 3
    s_add_u32 s54, s54, 1
    s_lshl_b32 s54, s54, 12
    s_add_u32 s54, s54, 114688
    v_add_u32 v250, s54, v2
    s_add_u32 s54, s3, 3
    s_and_b32 s54, s54, 3
    s_mul_i32 s54, s54, 3
    s_add_u32 s54, s54, 2
    s_lshl_b32 s54, s54, 12
    s_add_u32 s54, s54, 114688
    v_add_u32 v251, s54, v2
    s_mul_i32 s54, s3, 12288
    s_add_u32 s54, s54, 114688
    v_add_u32 v246, s54, v2
    s_waitcnt vmcnt(13)
    v_max3_u32 v10, v19, v23, v27
    s_waitcnt vmcnt(12)
    v_max_u32 v10, v10, v31
    v_cmp_eq_u32 vcc, -1, v10
    s_nop 0
    s_cbranch_vccnz km_retry18
km_back18:
    v_mfma_f32_16x16x32_bf16 v[192:195], a[16:19], v[20:23], 0
    v_mfma_f32_16x16x32_bf16 v[196:199], a[20:23], v[20:23], 0
    v_mfma_f32_16x16x32_bf16 v[200:203], a[24:27], v[20:23], 0
    v_mfma_f32_16x16x32_bf16 v[204:207], a[28:31], v[20:23], 0
    buffer_load_dwordx4 v[80:83], v9, s[8:11], s57 offen offset:0 sc1
    v_mfma_f32_16x16x32_bf16 v[208:211], a[16:19], v[24:27], 0
    v_mfma_f32_16x16x32_bf16 v[212:215], a[20:23], v[24:27], 0
    v_mfma_f32_16x16x32_bf16 v[216:219], a[24:27], v[24:27], 0
    v_mfma_f32_16x16x32_bf16 v[220:223], a[28:31], v[24:27], 0
    buffer_load_dwordx4 v[84:87], v11, s[8:11], s57 offen offset:0 sc1
    v_mfma_f32_16x16x32_bf16 v[224:227], a[16:19], v[28:31], 0
    v_mfma_f32_16x16x32_bf16 v[228:231], a[20:23], v[28:31], 0
    v_mfma_f32_16x16x32_bf16 v[232:235], a[24:27], v[28:31], 0
    v_mfma_f32_16x16x32_bf16 v[236:239], a[28:31], v[28:31], 0
    buffer_load_dwordx4 v[88:91], v12, s[8:11], s57 offen offset:0 sc1
    v_mfma_f32_16x16x32_bf16 v[176:179], a[16:19], v[16:19], 0
    v_mfma_f32_16x16x32_bf16 v[180:183], a[20:23], v[16:19], 0
    v_mfma_f32_16x16x32_bf16 v[184:187], a[24:27], v[16:19], 0
    v_mfma_f32_16x16x32_bf16 v[188:191], a[28:31], v[16:19], 0
    buffer_load_dwordx4 v[92:95], v13, s[8:11], s57 offen offset:0 sc1
    s_waitcnt vmcnt(13)
    v_max3_u32 v10, v35, v39, v43
    s_waitcnt vmcnt(12)
    v_max_u32 v10, v10, v47
    v_cmp_eq_u32 vcc, -1, v10
    s_nop 0
    s_cbranch_vccnz km_retry19
km_back19:
    v_mfma_f32_16x16x32_bf16 v[192:195], a[80:83], v[36:39], v[192:195]
    v_mfma_f32_16x16x32_bf16 v[196:199], a[84:87], v[36:39], v[196:199]
    v_mfma_f32_16x16x32_bf16 v[200:203], a[88:91], v[36:39], v[200:203]
    v_mfma_f32_16x16x32_bf16 v[204:207], a[92:95], v[36:39], v[204:207]
    buffer_load_dwordx4 v[96:99], v9, s[8:11], s58 offen offset:0 sc1
    v_mfma_f32_16x16x32_bf16 v[208:211], a[80:83], v[40:43], v[208:211]
    v_mfma_f32_16x16x32_bf16 v[212:215], a[84:87], v[40:43], v[212:215]
    v_mfma_f32_16x16x32_bf16 v[216:219], a[88:91], v[40:43], v[216:219]
    v_mfma_f32_16x16x32_bf16 v[220:223], a[92:95], v[40:43], v[220:223]
    buffer_load_dwordx4 v[100:103], v11, s[8:11], s58 offen offset:0 sc1
    v_mfma_f32_16x16x32_bf16 v[224:227], a[80:83], v[44:47], v[224:227]
    v_mfma_f32_16x16x32_bf16 v[228:231], a[84:87], v[44:47], v[228:231]
    v_mfma_f32_16x16x32_bf16 v[232:235], a[88:91], v[44:47], v[232:235]
    v_mfma_f32_16x16x32_bf16 v[236:239], a[92:95], v[44:47], v[236:239]
    buffer_load_dwordx4 v[104:107], v12, s[8:11], s58 offen offset:0 sc1
    v_mfma_f32_16x16x32_bf16 v[176:179], a[80:83], v[32:35], v[176:179]
    v_mfma_f32_16x16x32_bf16 v[180:183], a[84:87], v[32:35], v[180:183]
    v_mfma_f32_16x16x32_bf16 v[184:187], a[88:91], v[32:35], v[184:187]
    v_mfma_f32_16x16x32_bf16 v[188:191], a[92:95], v[32:35], v[188:191]
    buffer_load_dwordx4 v[108:111], v13, s[8:11], s58 offen offset:0 sc1
    s_waitcnt vmcnt(13)
    v_max3_u32 v10, v51, v55, v59
    s_waitcnt vmcnt(12)
    v_max_u32 v10, v10, v63
    v_cmp_eq_u32 vcc, -1, v10
    s_nop 0
    s_cbranch_vccnz km_retry20
km_back20:
    v_mfma_f32_16x16x32_bf16 v[192:195], a[128:131], v[52:55], v[192:195]
    v_mfma_f32_16x16x32_bf16 v[196:199], a[132:135], v[52:55], v[196:199]
    v_mfma_f32_16x16x32_bf16 v[200:203], a[136:139], v[52:55], v[200:203]
    v_mfma_f32_16x16x32_bf16 v[204:207], a[140:143], v[52:55], v[204:207]
    buffer_load_dwordx4 v[112:115], v9, s[8:11], s59 offen offset:0 sc1
    v_mfma_f32_16x16x32_bf16 v[208:211], a[128:131], v[56:59], v[208:211]
    v_mfma_f32_16x16x32_bf16 v[212:215], a[132:135], v[56:59], v[212:215]
    v_mfma_f32_16x16x32_bf16 v[216:219], a[136:139], v[56:59], v[216:219]
    v_mfma_f32_16x16x32_bf16 v[220:223], a[140:143], v[56:59], v[220:223]
    buffer_load_dwordx4 v[116:119], v11, s[8:11], s59 offen offset:0 sc1
    v_mfma_f32_16x16x32_bf16 v[224:227], a[128:131], v[60:63], v[224:227]
    v_mfma_f32_16x16x32_bf16 v[228:231], a[132:135], v[60:63], v[228:231]
    v_mfma_f32_16x16x32_bf16 v[232:235], a[136:139], v[60:63], v[232:235]
    v_mfma_f32_16x16x32_bf16 v[236:239], a[140:143], v[60:63], v[236:239]
    buffer_load_dwordx4 v[120:123], v12, s[8:11], s59 offen offset:0 sc1
    v_mfma_f32_16x16x32_bf16 v[176:179], a[128:131], v[48:51], v[176:179]
    v_mfma_f32_16x16x32_bf16 v[180:183], a[132:135], v[48:51], v[180:183]
    v_mfma_f32_16x16x32_bf16 v[184:187], a[136:139], v[48:51], v[184:187]
    v_mfma_f32_16x16x32_bf16 v[188:191], a[140:143], v[48:51], v[188:191]
    buffer_load_dwordx4 v[124:127], v13, s[8:11], s59 offen offset:0 sc1
    s_waitcnt vmcnt(13)
    v_max3_u32 v10, v67, v71, v75
    s_waitcnt vmcnt(12)
    v_max_u32 v10, v10, v79
    v_cmp_eq_u32 vcc, -1, v10
    s_nop 0
    s_cbranch_vccnz km_retry21
km_back21:
    v_mfma_f32_16x16x32_bf16 v[192:195], a[192:195], v[68:71], v[192:195]
    v_mfma_f32_16x16x32_bf16 v[196:199], a[196:199], v[68:71], v[196:199]
    v_mfma_f32_16x16x32_bf16 v[200:203], a[200:203], v[68:71], v[200:203]
    v_mfma_f32_16x16x32_bf16 v[204:207], a[204:207], v[68:71], v[204:207]
    buffer_load_dwordx4 v[128:131], v9, s[8:11], s60 offen offset:0 sc1
    v_mfma_f32_16x16x32_bf16 v[208:211], a[192:195], v[72:75], v[208:211]
    v_mfma_f32_16x16x32_bf16 v[212:215], a[196:199], v[72:75], v[212:215]
    v_mfma_f32_16x16x32_bf16 v[216:219], a[200:203], v[72:75], v[216:219]
    v_mfma_f32_16x16x32_bf16 v[220:223], a[204:207], v[72:75], v[220:223]
    buffer_load_dwordx4 v[132:135], v11, s[8:11], s60 offen offset:0 sc1
    v_mfma_f32_16x16x32_bf16 v[224:227], a[192:195], v[76:79], v[224:227]
    v_mfma_f32_16x16x32_bf16 v[228:231], a[196:199], v[76:79], v[228:231]
    v_mfma_f32_16x16x32_bf16 v[232:235], a[200:203], v[76:79], v[232:235]
    v_mfma_f32_16x16x32_bf16 v[236:239], a[204:207], v[76:79], v[236:239]
    buffer_load_dwordx4 v[136:139], v12, s[8:11], s60 offen offset:0 sc1
    v_mfma_f32_16x16x32_bf16 v[176:179], a[192:195], v[64:67], v[176:179]
    v_mfma_f32_16x16x32_bf16 v[180:183], a[196:199], v[64:67], v[180:183]
    v_mfma_f32_16x16x32_bf16 v[184:187], a[200:203], v[64:67], v[184:187]
    v_mfma_f32_16x16x32_bf16 v[188:191], a[204:207], v[64:67], v[188:191]
    buffer_load_dwordx4 v[140:143], v13, s[8:11], s60 offen offset:0 sc1
    buffer_load_dword v248, v247, s[8:11], s26 offen offset:3580 sc1
    s_waitcnt vmcnt(15)
    v_mfma_f32_16x16x32_bf16 v[192:195], a[0:3], v[84:87], v[192:195]
    v_mfma_f32_16x16x32_bf16 v[196:199], a[4:7], v[84:87], v[196:199]
    v_mfma_f32_16x16x32_bf16 v[200:203], a[8:11], v[84:87], v[200:203]
    v_mfma_f32_16x16x32_bf16 v[204:207], a[12:15], v[84:87], v[204:207]
    s_waitcnt vmcnt(14)
    v_mfma_f32_16x16x32_bf16 v[208:211], a[0:3], v[88:91], v[208:211]
    v_mfma_f32_16x16x32_bf16 v[212:215], a[4:7], v[88:91], v[212:215]
    v_mfma_f32_16x16x32_bf16 v[216:219], a[8:11], v[88:91], v[216:219]
    v_mfma_f32_16x16x32_bf16 v[220:223], a[12:15], v[88:91], v[220:223]
    s_waitcnt vmcnt(13)
    v_mfma_f32_16x16x32_bf16 v[224:227], a[0:3], v[92:95], v[224:227]
    v_mfma_f32_16x16x32_bf16 v[228:231], a[4:7], v[92:95], v[228:231]
    v_mfma_f32_16x16x32_bf16 v[232:235], a[8:11], v[92:95], v[232:235]
    v_mfma_f32_16x16x32_bf16 v[236:239], a[12:15], v[92:95], v[236:239]
    v_mfma_f32_16x16x32_bf16 v[176:179], a[0:3], v[80:83], v[176:179]
    v_mfma_f32_16x16x32_bf16 v[180:183], a[4:7], v[80:83], v[180:183]
    v_mfma_f32_16x16x32_bf16 v[184:187], a[8:11], v[80:83], v[184:187]
    v_mfma_f32_16x16x32_bf16 v[188:191], a[12:15], v[80:83], v[188:191]
    s_waitcnt vmcnt(11)
    v_mfma_f32_16x16x32_bf16 v[192:195], a[64:67], v[100:103], v[192:195]
    v_mfma_f32_16x16x32_bf16 v[196:199], a[68:71], v[100:103], v[196:199]
    v_mfma_f32_16x16x32_bf16 v[200:203], a[72:75], v[100:103], v[200:203]
    v_mfma_f32_16x16x32_bf16 v[204:207], a[76:79], v[100:103], v[204:207]
    s_waitcnt vmcnt(10)
    v_mfma_f32_16x16x32_bf16 v[208:211], a[64:67], v[104:107], v[208:211]
    v_mfma_f32_16x16x32_bf16 v[212:215], a[68:71], v[104:107], v[212:215]
    v_mfma_f32_16x16x32_bf16 v[216:219], a[72:75], v[104:107], v[216:219]
    v_mfma_f32_16x16x32_bf16 v[220:223], a[76:79], v[104:107], v[220:223]
    s_waitcnt vmcnt(9)
    v_mfma_f32_16x16x32_bf16 v[224:227], a[64:67], v[108:111], v[224:227]
    v_mfma_f32_16x16x32_bf16 v[228:231], a[68:71], v[108:111], v[228:231]
    v_mfma_f32_16x16x32_bf16 v[232:235], a[72:75], v[108:111], v[232:235]
    v_mfma_f32_16x16x32_bf16 v[236:239], a[76:79], v[108:111], v[236:239]
    v_mfma_f32_16x16x32_bf16 v[176:179], a[64:67], v[96:99], v[176:179]
    v_mfma_f32_16x16x32_bf16 v[180:183], a[68:71], v[96:99], v[180:183]
    v_mfma_f32_16x16x32_bf16 v[184:187], a[72:75], v[96:99], v[184:187]
    v_mfma_f32_16x16x32_bf16 v[188:191], a[76:79], v[96:99], v[188:191]
    s_waitcnt vmcnt(0)
    v_cmp_eq_u32 vcc, -1, v248
    s_nop 0
    s_cbranch_vccnz km_retry22
km_back22:
    v_mfma_f32_16x16x32_bf16 v[192:195], a[112:115], v[116:119], v[192:195]
    v_mfma_f32_16x16x32_bf16 v[196:199], a[116:119], v[116:119], v[196:199]
    v_mfma_f32_16x16x32_bf16 v[200:203], a[120:123], v[116:119], v[200:203]
    v_mfma_f32_16x16x32_bf16 v[204:207], a[124:127], v[116:119], v[204:207]
    buffer_load_dwordx2 v[144:145], v240, s[8:11], s57 offen offset:3072 sc1
    buffer_load_dwordx2 v[146:147], v240, s[8:11], s57 offen offset:3584 sc1
    buffer_load_dwordx2 v[148:149], v241, s[8:11], s57 offen offset:3072 sc1
    buffer_load_dwordx2 v[150:151], v241, s[8:11], s57 offen offset:3584 sc1
    buffer_load_dwordx2 v[152:153], v242, s[8:11], s57 offen offset:3072 sc1
    buffer_load_dwordx2 v[154:155], v242, s[8:11], s57 offen offset:3584 sc1
    buffer_load_dwordx2 v[156:157], v243, s[8:11], s57 offen offset:3072 sc1
    buffer_load_dwordx2 v[158:159], v243, s[8:11], s57 offen offset:3584 sc1
    v_mfma_f32_16x16x32_bf16 v[208:211], a[112:115], v[120:123], v[208:211]
    v_mfma_f32_16x16x32_bf16 v[212:215], a[116:119], v[120:123], v[212:215]
    v_mfma_f32_16x16x32_bf16 v[216:219], a[120:123], v[120:123], v[216:219]
    v_mfma_f32_16x16x32_bf16 v[220:223], a[124:127], v[120:123], v[220:223]
    buffer_load_dwordx4 v[160:163], v9, s[8:11], s58 offen offset:2048 sc1
    buffer_load_dwordx4 v[164:167], v11, s[8:11], s58 offen offset:2048 sc1
    buffer_load_dwordx4 v[168:171], v12, s[8:11], s58 offen offset:2048 sc1
    buffer_load_dwordx4 v[172:175], v13, s[8:11], s58 offen offset:2048 sc1
    buffer_load_dwordx4 v[16:19], v9, s[8:11], s57 offen offset:2048 sc1
    buffer_load_dwordx4 v[20:23], v11, s[8:11], s57 offen offset:2048 sc1
    buffer_load_dwordx4 v[24:27], v12, s[8:11], s57 offen offset:2048 sc1
    buffer_load_dwordx4 v[28:31], v13, s[8:11], s57 offen offset:2048 sc1
    v_mfma_f32_16x16x32_bf16 v[224:227], a[112:115], v[124:127], v[224:227]
    v_mfma_f32_16x16x32_bf16 v[228:231], a[116:119], v[124:127], v[228:231]
    v_mfma_f32_16x16x32_bf16 v[232:235], a[120:123], v[124:127], v[232:235]
    v_mfma_f32_16x16x32_bf16 v[236:239], a[124:127], v[124:127], v[236:239]
    buffer_load_dwordx2 v[32:33], v240, s[8:11], s59 offen offset:3072 sc1
    buffer_load_dwordx2 v[34:35], v240, s[8:11], s59 offen offset:3584 sc1
    buffer_load_dwordx2 v[36:37], v241, s[8:11], s59 offen offset:3072 sc1
    buffer_load_dwordx2 v[38:39], v241, s[8:11], s59 offen offset:3584 sc1
    buffer_load_dwordx2 v[40:41], v242, s[8:11], s59 offen offset:3072 sc1
    buffer_load_dwordx2 v[42:43], v242, s[8:11], s59 offen offset:3584 sc1
    buffer_load_dwordx2 v[44:45], v243, s[8:11], s59 offen offset:3072 sc1
    buffer_load_dwordx2 v[46:47], v243, s[8:11], s59 offen offset:3584 sc1
    v_mfma_f32_16x16x32_bf16 v[176:179], a[112:115], v[112:115], v[176:179]
    v_mfma_f32_16x16x32_bf16 v[180:183], a[116:119], v[112:115], v[180:183]
    v_mfma_f32_16x16x32_bf16 v[184:187], a[120:123], v[112:115], v[184:187]
    v_mfma_f32_16x16x32_bf16 v[188:191], a[124:127], v[112:115], v[188:191]
    buffer_load_dwordx4 v[48:51], v9, s[8:11], s60 offen offset:2048 sc1
    buffer_load_dwordx4 v[52:55], v11, s[8:11], s60 offen offset:2048 sc1
    buffer_load_dwordx4 v[56:59], v12, s[8:11], s60 offen offset:2048 sc1
    buffer_load_dwordx4 v[60:63], v13, s[8:11], s60 offen offset:2048 sc1
    buffer_load_dwordx4 v[64:67], v9, s[8:11], s59 offen offset:2048 sc1
    buffer_load_dwordx4 v[68:71], v11, s[8:11], s59 offen offset:2048 sc1
    buffer_load_dwordx4 v[72:75], v12, s[8:11], s59 offen offset:2048 sc1
    buffer_load_dwordx4 v[76:79], v13, s[8:11], s59 offen offset:2048 sc1
    v_mfma_f32_16x16x32_bf16 v[192:195], a[176:179], v[132:135], v[192:195]
    v_mfma_f32_16x16x32_bf16 v[196:199], a[180:183], v[132:135], v[196:199]
    v_mfma_f32_16x16x32_bf16 v[200:203], a[184:187], v[132:135], v[200:203]
    v_mfma_f32_16x16x32_bf16 v[204:207], a[188:191], v[132:135], v[204:207]
    v_mfma_f32_16x16x32_bf16 v[208:211], a[176:179], v[136:139], v[208:211]
    v_mfma_f32_16x16x32_bf16 v[212:215], a[180:183], v[136:139], v[212:215]
    v_mfma_f32_16x16x32_bf16 v[216:219], a[184:187], v[136:139], v[216:219]
    v_mfma_f32_16x16x32_bf16 v[220:223], a[188:191], v[136:139], v[220:223]
    v_mfma_f32_16x16x32_bf16 v[224:227], a[176:179], v[140:143], v[224:227]
    v_mfma_f32_16x16x32_bf16 v[228:231], a[180:183], v[140:143], v[228:231]
    v_mfma_f32_16x16x32_bf16 v[232:235], a[184:187], v[140:143], v[232:235]
    v_mfma_f32_16x16x32_bf16 v[236:239], a[188:191], v[140:143], v[236:239]
    v_mfma_f32_16x16x32_bf16 v[176:179], a[176:179], v[128:131], v[176:179]
    v_mfma_f32_16x16x32_bf16 v[180:183], a[180:183], v[128:131], v[180:183]
    v_mfma_f32_16x16x32_bf16 v[184:187], a[184:187], v[128:131], v[184:187]
    v_mfma_f32_16x16x32_bf16 v[188:191], a[188:191], v[128:131], v[188:191]
    s_waitcnt vmcnt(29)
    v_max3_u32 v10, v145, v147, v149
    s_waitcnt vmcnt(27)
    v_max3_u32 v10, v10, v151, v153
    s_waitcnt vmcnt(25)
    v_max3_u32 v10, v10, v155, v157
    s_waitcnt vmcnt(24)
    v_max_u32 v10, v10, v159
    v_cmp_eq_u32 vcc, -1, v10
    s_nop 0
    s_cbranch_vccnz km_retry23
km_back23:
    v_mfma_f32_16x16x32_bf16 v[192:195], a[48:51], v[148:151], v[192:195]
    v_mfma_f32_16x16x32_bf16 v[196:199], a[52:55], v[148:151], v[196:199]
    v_mfma_f32_16x16x32_bf16 v[200:203], a[56:59], v[148:151], v[200:203]
    v_mfma_f32_16x16x32_bf16 v[204:207], a[60:63], v[148:151], v[204:207]
    v_mfma_f32_16x16x32_bf16 v[208:211], a[48:51], v[152:155], v[208:211]
    v_mfma_f32_16x16x32_bf16 v[212:215], a[52:55], v[152:155], v[212:215]
    v_mfma_f32_16x16x32_bf16 v[216:219], a[56:59], v[152:155], v[216:219]
    v_mfma_f32_16x16x32_bf16 v[220:223], a[60:63], v[152:155], v[220:223]
    buffer_load_dwordx4 v[80:83], v245, s[8:11], s51 offen sc1
    v_mfma_f32_16x16x32_bf16 v[224:227], a[48:51], v[156:159], v[224:227]
    v_mfma_f32_16x16x32_bf16 v[228:231], a[52:55], v[156:159], v[228:231]
    v_mfma_f32_16x16x32_bf16 v[232:235], a[56:59], v[156:159], v[232:235]
    v_mfma_f32_16x16x32_bf16 v[236:239], a[60:63], v[156:159], v[236:239]
    v_mfma_f32_16x16x32_bf16 v[176:179], a[48:51], v[144:147], v[176:179]
    v_mfma_f32_16x16x32_bf16 v[180:183], a[52:55], v[144:147], v[180:183]
    v_mfma_f32_16x16x32_bf16 v[184:187], a[56:59], v[144:147], v[184:187]
    v_mfma_f32_16x16x32_bf16 v[188:191], a[60:63], v[144:147], v[188:191]
    buffer_load_dwordx4 v[84:87], v245, s[8:11], s51 offen offset:256 sc1
    s_waitcnt vmcnt(23)
    v_max3_u32 v10, v163, v167, v171
    s_waitcnt vmcnt(22)
    v_max_u32 v10, v10, v175
    v_cmp_eq_u32 vcc, -1, v10
    s_nop 0
    s_cbranch_vccnz km_retry24
km_back24:
    v_mfma_f32_16x16x32_bf16 v[192:195], a[96:99], v[164:167], v[192:195]
    v_mfma_f32_16x16x32_bf16 v[196:199], a[100:103], v[164:167], v[196:199]
    v_mfma_f32_16x16x32_bf16 v[200:203], a[104:107], v[164:167], v[200:203]
    v_mfma_f32_16x16x32_bf16 v[204:207], a[108:111], v[164:167], v[204:207]
    v_mfma_f32_16x16x32_bf16 v[208:211], a[96:99], v[168:171], v[208:211]
    v_mfma_f32_16x16x32_bf16 v[212:215], a[100:103], v[168:171], v[212:215]
    v_mfma_f32_16x16x32_bf16 v[216:219], a[104:107], v[168:171], v[216:219]
    v_mfma_f32_16x16x32_bf16 v[220:223], a[108:111], v[168:171], v[220:223]
    v_mfma_f32_16x16x32_bf16 v[224:227], a[96:99], v[172:175], v[224:227]
    v_mfma_f32_16x16x32_bf16 v[228:231], a[100:103], v[172:175], v[228:231]
    v_mfma_f32_16x16x32_bf16 v[232:235], a[104:107], v[172:175], v[232:235]
    v_mfma_f32_16x16x32_bf16 v[236:239], a[108:111], v[172:175], v[236:239]
    v_mfma_f32_16x16x32_bf16 v[176:179], a[96:99], v[160:163], v[176:179]
    v_mfma_f32_16x16x32_bf16 v[180:183], a[100:103], v[160:163], v[180:183]
    v_mfma_f32_16x16x32_bf16 v[184:187], a[104:107], v[160:163], v[184:187]
    v_mfma_f32_16x16x32_bf16 v[188:191], a[108:111], v[160:163], v[188:191]
    s_waitcnt vmcnt(19)
    v_max3_u32 v10, v19, v23, v27
    s_waitcnt vmcnt(18)
    v_max_u32 v10, v10, v31
    v_cmp_eq_u32 vcc, -1, v10
    s_nop 0
    s_cbranch_vccnz km_retry25
km_back25:
    v_mfma_f32_16x16x32_bf16 v[192:195], a[32:35], v[20:23], v[192:195]
    v_mfma_f32_16x16x32_bf16 v[196:199], a[36:39], v[20:23], v[196:199]
    v_mfma_f32_16x16x32_bf16 v[200:203], a[40:43], v[20:23], v[200:203]
    v_mfma_f32_16x16x32_bf16 v[204:207], a[44:47], v[20:23], v[204:207]
    v_mfma_f32_16x16x32_bf16 v[208:211], a[32:35], v[24:27], v[208:211]
    v_mfma_f32_16x16x32_bf16 v[212:215], a[36:39], v[24:27], v[212:215]
    v_mfma_f32_16x16x32_bf16 v[216:219], a[40:43], v[24:27], v[216:219]
    v_mfma_f32_16x16x32_bf16 v[220:223], a[44:47], v[24:27], v[220:223]
    v_mfma_f32_16x16x32_bf16 v[224:227], a[32:35], v[28:31], v[224:227]
    v_mfma_f32_16x16x32_bf16 v[228:231], a[36:39], v[28:31], v[228:231]
    v_mfma_f32_16x16x32_bf16 v[232:235], a[40:43], v[28:31], v[232:235]
    v_mfma_f32_16x16x32_bf16 v[236:239], a[44:47], v[28:31], v[236:239]
    v_mfma_f32_16x16x32_bf16 v[176:179], a[32:35], v[16:19], v[176:179]
    v_mfma_f32_16x16x32_bf16 v[180:183], a[36:39], v[16:19], v[180:183]
    v_mfma_f32_16x16x32_bf16 v[184:187], a[40:43], v[16:19], v[184:187]
    v_mfma_f32_16x16x32_bf16 v[188:191], a[44:47], v[16:19], v[188:191]
    s_waitcnt vmcnt(15)
    v_max3_u32 v10, v33, v35, v37
    s_waitcnt vmcnt(13)
    v_max3_u32 v10, v10, v39, v41
    s_waitcnt vmcnt(11)
    v_max3_u32 v10, v10, v43, v45
    s_waitcnt vmcnt(10)
    v_max_u32 v10, v10, v47
    v_cmp_eq_u32 vcc, -1, v10
    s_nop 0
    s_cbranch_vccnz km_retry26
km_back26:
    s_waitcnt vmcnt(1)
    v_lshlrev_b32 v96, 16, v80
    v_and_b32 v97, 0xffff0000, v80
    v_lshlrev_b32 v98, 16, v81
    v_and_b32 v99, 0xffff0000, v81
    v_lshlrev_b32 v100, 16, v82
    v_and_b32 v101, 0xffff0000, v82
    v_lshlrev_b32 v102, 16, v83
    v_and_b32 v103, 0xffff0000, v83
    s_waitcnt vmcnt(0)
    v_lshlrev_b32 v104, 16, v84
    v_and_b32 v105, 0xffff0000, v84
    v_lshlrev_b32 v106, 16, v85
    v_and_b32 v107, 0xffff0000, v85
    v_lshlrev_b32 v108, 16, v86
    v_and_b32 v109, 0xffff0000, v86
    v_lshlrev_b32 v110, 16, v87
    v_and_b32 v111, 0xffff0000, v87
    v_mfma_f32_16x16x32_bf16 v[192:195], a[160:163], v[36:39], v[192:195]
    v_mfma_f32_16x16x32_bf16 v[196:199], a[164:167], v[36:39], v[196:199]
    v_mfma_f32_16x16x32_bf16 v[200:203], a[168:171], v[36:39], v[200:203]
    v_mfma_f32_16x16x32_bf16 v[204:207], a[172:175], v[36:39], v[204:207]
    v_mfma_f32_16x16x32_bf16 v[208:211], a[160:163], v[40:43], v[208:211]
    v_mfma_f32_16x16x32_bf16 v[212:215], a[164:167], v[40:43], v[212:215]
    v_mfma_f32_16x16x32_bf16 v[216:219], a[168:171], v[40:43], v[216:219]
    v_mfma_f32_16x16x32_bf16 v[220:223], a[172:175], v[40:43], v[220:223]
    v_mfma_f32_16x16x32_bf16 v[224:227], a[160:163], v[44:47], v[224:227]
    v_mfma_f32_16x16x32_bf16 v[228:231], a[164:167], v[44:47], v[228:231]
    v_mfma_f32_16x16x32_bf16 v[232:235], a[168:171], v[44:47], v[232:235]
    v_mfma_f32_16x16x32_bf16 v[236:239], a[172:175], v[44:47], v[236:239]
    v_mfma_f32_16x16x32_bf16 v[176:179], a[160:163], v[32:35], v[176:179]
    v_mfma_f32_16x16x32_bf16 v[180:183], a[164:167], v[32:35], v[180:183]
    v_mfma_f32_16x16x32_bf16 v[184:187], a[168:171], v[32:35], v[184:187]
    v_mfma_f32_16x16x32_bf16 v[188:191], a[172:175], v[32:35], v[188:191]
    v_max3_u32 v10, v51, v55, v59
    v_max_u32 v10, v10, v63
    v_cmp_eq_u32 vcc, -1, v10
    s_nop 0
    s_cbranch_vccnz km_retry27
km_back27:
    v_mfma_f32_16x16x32_bf16 v[192:195], a[208:211], v[52:55], v[192:195]
    v_mfma_f32_16x16x32_bf16 v[196:199], a[212:215], v[52:55], v[196:199]
    v_mfma_f32_16x16x32_bf16 v[200:203], a[216:219], v[52:55], v[200:203]
    v_mfma_f32_16x16x32_bf16 v[204:207], a[220:223], v[52:55], v[204:207]
    v_mfma_f32_16x16x32_bf16 v[208:211], a[208:211], v[56:59], v[208:211]
    v_mfma_f32_16x16x32_bf16 v[212:215], a[212:215], v[56:59], v[212:215]
    v_mfma_f32_16x16x32_bf16 v[216:219], a[216:219], v[56:59], v[216:219]
    v_mfma_f32_16x16x32_bf16 v[220:223], a[220:223], v[56:59], v[220:223]
    v_mfma_f32_16x16x32_bf16 v[224:227], a[208:211], v[60:63], v[224:227]
    v_mfma_f32_16x16x32_bf16 v[228:231], a[212:215], v[60:63], v[228:231]
    v_mfma_f32_16x16x32_bf16 v[232:235], a[216:219], v[60:63], v[232:235]
    v_mfma_f32_16x16x32_bf16 v[236:239], a[220:223], v[60:63], v[236:239]
    v_mfma_f32_16x16x32_bf16 v[176:179], a[208:211], v[48:51], v[176:179]
    v_mfma_f32_16x16x32_bf16 v[180:183], a[212:215], v[48:51], v[180:183]
    v_mfma_f32_16x16x32_bf16 v[184:187], a[216:219], v[48:51], v[184:187]
    v_mfma_f32_16x16x32_bf16 v[188:191], a[220:223], v[48:51], v[188:191]
    v_max3_u32 v10, v67, v71, v75
    v_max_u32 v10, v10, v79
    v_cmp_eq_u32 vcc, -1, v10
    s_nop 0
    s_cbranch_vccnz km_retry28
km_back28:
    v_mfma_f32_16x16x32_bf16 v[192:195], a[144:147], v[68:71], v[192:195]
    v_mfma_f32_16x16x32_bf16 v[196:199], a[148:151], v[68:71], v[196:199]
    v_mfma_f32_16x16x32_bf16 v[200:203], a[152:155], v[68:71], v[200:203]
    v_mfma_f32_16x16x32_bf16 v[204:207], a[156:159], v[68:71], v[204:207]
    v_mfma_f32_16x16x32_bf16 v[208:211], a[144:147], v[72:75], v[208:211]
    v_mfma_f32_16x16x32_bf16 v[212:215], a[148:151], v[72:75], v[212:215]
    v_mfma_f32_16x16x32_bf16 v[216:219], a[152:155], v[72:75], v[216:219]
    v_mfma_f32_16x16x32_bf16 v[220:223], a[156:159], v[72:75], v[220:223]
    s_nop 0
    ds_write_b128 v249, v[192:195] offset:0
    ds_write_b128 v249, v[196:199] offset:1024
    ds_write_b128 v249, v[200:203] offset:2048
    ds_write_b128 v249, v[204:207] offset:3072
    v_mfma_f32_16x16x32_bf16 v[224:227], a[144:147], v[76:79], v[224:227]
    v_mfma_f32_16x16x32_bf16 v[228:231], a[148:151], v[76:79], v[228:231]
    v_mfma_f32_16x16x32_bf16 v[232:235], a[152:155], v[76:79], v[232:235]
    v_mfma_f32_16x16x32_bf16 v[236:239], a[156:159], v[76:79], v[236:239]
    ds_write_b128 v250, v[208:211] offset:0
    ds_write_b128 v250, v[212:215] offset:1024
    ds_write_b128 v250, v[216:219] offset:2048
    ds_write_b128 v250, v[220:223] offset:3072
    v_mfma_f32_16x16x32_bf16 v[176:179], a[144:147], v[64:67], v[176:179]
    v_mfma_f32_16x16x32_bf16 v[180:183], a[148:151], v[64:67], v[180:183]
    v_mfma_f32_16x16x32_bf16 v[184:187], a[152:155], v[64:67], v[184:187]
    v_mfma_f32_16x16x32_bf16 v[188:191], a[156:159], v[64:67], v[188:191]
    ds_write_b128 v251, v[224:227] offset:0
    ds_write_b128 v251, v[228:231] offset:1024
    ds_write_b128 v251, v[232:235] offset:2048
    ds_write_b128 v251, v[236:239] offset:3072
    s_waitcnt lgkmcnt(0)
    s_barrier
    ds_read_b128 v[192:195], v246 offset:0
    ds_read_b128 v[208:211], v246 offset:4096
    ds_read_b128 v[224:227], v246 offset:8192
    ds_read_b128 v[196:199], v246 offset:1024
    ds_read_b128 v[212:215], v246 offset:5120
    ds_read_b128 v[228:231], v246 offset:9216
    ds_read_b128 v[200:203], v246 offset:2048
    ds_read_b128 v[216:219], v246 offset:6144
    ds_read_b128 v[232:235], v246 offset:10240
    ds_read_b128 v[204:207], v246 offset:3072
    ds_read_b128 v[220:223], v246 offset:7168
    ds_read_b128 v[236:239], v246 offset:11264
    s_waitcnt lgkmcnt(11)
    v_add_f32 v176, v176, v192
    v_add_f32 v177, v177, v193
    v_add_f32 v178, v178, v194
    v_add_f32 v179, v179, v195
    s_waitcnt lgkmcnt(9)
    v_add_f32 v208, v208, v224
    v_add_f32 v209, v209, v225
    v_add_f32 v210, v210, v226
    v_add_f32 v211, v211, v227
    v_add_f32 v176, v176, v208
    v_add_f32 v177, v177, v209
    v_add_f32 v178, v178, v210
    v_add_f32 v179, v179, v211
    v_cvt_pk_bf16_f32 v16, v176, v177
    v_cvt_pk_bf16_f32 v17, v178, v179
    v_lshlrev_b32 v176, 16, v16
    v_and_b32 v177, 0xffff0000, v16
    v_lshlrev_b32 v178, 16, v17
    v_and_b32 v179, 0xffff0000, v17
    v_add_f32 v176, v176, v96
    v_add_f32 v177, v177, v97
    v_add_f32 v178, v178, v98
    v_add_f32 v179, v179, v99
    v_cvt_pk_bf16_f32 v24, v176, v177
    v_cvt_pk_bf16_f32 v25, v178, v179
    s_waitcnt lgkmcnt(8)
    v_add_f32 v180, v180, v196
    v_add_f32 v181, v181, v197
    v_add_f32 v182, v182, v198
    v_add_f32 v183, v183, v199
    s_waitcnt lgkmcnt(6)
    v_add_f32 v212, v212, v228
    v_add_f32 v213, v213, v229
    v_add_f32 v214, v214, v230
    v_add_f32 v215, v215, v231
    v_add_f32 v180, v180, v212
    v_add_f32 v181, v181, v213
    v_add_f32 v182, v182, v214
    v_add_f32 v183, v183, v215
    v_cvt_pk_bf16_f32 v18, v180, v181
    v_cvt_pk_bf16_f32 v19, v182, v183
    v_lshlrev_b32 v180, 16, v18
    v_and_b32 v181, 0xffff0000, v18
    v_lshlrev_b32 v182, 16, v19
    v_and_b32 v183, 0xffff0000, v19
    v_add_f32 v180, v180, v100
    v_add_f32 v181, v181, v101
    v_add_f32 v182, v182, v102
    v_add_f32 v183, v183, v103
    v_cvt_pk_bf16_f32 v26, v180, v181
    v_cvt_pk_bf16_f32 v27, v182, v183
    buffer_store_dwordx4 v[24:27], v244, s[16:19], s50 offen offset:0
    s_waitcnt lgkmcnt(5)
    v_add_f32 v184, v184, v200
    v_add_f32 v185, v185, v201
    v_add_f32 v186, v186, v202
    v_add_f32 v187, v187, v203
    s_waitcnt lgkmcnt(3)
    v_add_f32 v216, v216, v232
    v_add_f32 v217, v217, v233
    v_add_f32 v218, v218, v234
    v_add_f32 v219, v219, v235
    v_add_f32 v184, v184, v216
    v_add_f32 v185, v185, v217
    v_add_f32 v186, v186, v218
    v_add_f32 v187, v187, v219
    v_cvt_pk_bf16_f32 v20, v184, v185
    v_cvt_pk_bf16_f32 v21, v186, v187
    v_lshlrev_b32 v184, 16, v20
    v_and_b32 v185, 0xffff0000, v20
    v_lshlrev_b32 v186, 16, v21
    v_and_b32 v187, 0xffff0000, v21
    v_add_f32 v184, v184, v104
    v_add_f32 v185, v185, v105
    v_add_f32 v186, v186, v106
    v_add_f32 v187, v187, v107
    v_cvt_pk_bf16_f32 v28, v184, v185
    v_cvt_pk_bf16_f32 v29, v186, v187
    s_waitcnt lgkmcnt(2)
    v_add_f32 v188, v188, v204
    v_add_f32 v189, v189, v205
    v_add_f32 v190, v190, v206
    v_add_f32 v191, v191, v207
    s_waitcnt lgkmcnt(0)
    v_add_f32 v220, v220, v236
    v_add_f32 v221, v221, v237
    v_add_f32 v222, v222, v238
    v_add_f32 v223, v223, v239
    v_add_f32 v188, v188, v220
    v_add_f32 v189, v189, v221
    v_add_f32 v190, v190, v222
    v_add_f32 v191, v191, v223
    v_cvt_pk_bf16_f32 v22, v188, v189
    v_cvt_pk_bf16_f32 v23, v190, v191
    v_lshlrev_b32 v188, 16, v22
    v_and_b32 v189, 0xffff0000, v22
    v_lshlrev_b32 v190, 16, v23
    v_and_b32 v191, 0xffff0000, v23
    v_add_f32 v188, v188, v108
    v_add_f32 v189, v189, v109
    v_add_f32 v190, v190, v110
    v_add_f32 v191, v191, v111
    v_cvt_pk_bf16_f32 v30, v188, v189
    v_cvt_pk_bf16_f32 v31, v190, v191
    buffer_store_dwordx4 v[28:31], v244, s[16:19], s50 offen offset:16
    s_endpgm
km_special:
    s_barrier
    s_waitcnt vmcnt(8)
    s_and_b32 s26, s3, 1
    s_lshl_b32 s26, s26, 5
    s_lshr_b32 s27, s3, 1
    s_add_u32 s26, s26, s27
    v_lshlrev_b32 v94, 1, v5
    v_add_u32 v94, s26, v94
    v_mul_u32_u24 v95, 264, v4
    v_add_lshl_u32 v92, v94, v95, 2
    v_add_u32 v92, 123648, v92
    v_sub_u32 v96, 64, v94
    v_and_b32 v96, 63, v96
    v_cmp_eq_u32 vcc, 0, v94
    v_mov_b32 v97, 792
    v_mov_b32 v98, 858
    v_cndmask_b32 v97, v97, v98, vcc
    v_sub_u32 v97, v97, v95
    v_add_lshl_u32 v93, v96, v97, 2
    v_add_u32 v93, 123648, v93
    ds_write_b32 v92, v36 offset:0
    ds_write_b32 v92, v40 offset:8960
    ds_write_b32 v92, v37 offset:264
    ds_write_b32 v92, v41 offset:9224
    ds_write_b32 v92, v38 offset:528
    ds_write_b32 v92, v42 offset:9488
    ds_write_b32 v92, v39 offset:792
    ds_write_b32 v92, v43 offset:9752
    ds_write_b32 v92, v44 offset:4224
    ds_write_b32 v92, v48 offset:13184
    ds_write_b32 v92, v45 offset:4488
    ds_write_b32 v92, v49 offset:13448
    ds_write_b32 v92, v46 offset:4752
    ds_write_b32 v92, v50 offset:13712
    ds_write_b32 v92, v47 offset:5016
    ds_write_b32 v92, v51 offset:13976
    s_mov_b64 exec, 0xffff
    ds_write_b32 v92, v36 offset:8448
    ds_write_b32 v92, v40 offset:17408
    s_mov_b64 exec, -1
    s_waitcnt lgkmcnt(0)
    s_barrier
    ds_read_b32 v148, v93 offset:5016
    ds_read_b32 v152, v93 offset:13976
    ds_read_b32 v149, v93 offset:4752
    ds_read_b32 v153, v93 offset:13712
    ds_read_b32 v150, v93 offset:4488
    ds_read_b32 v154, v93 offset:13448
    ds_read_b32 v151, v93 offset:4224
    ds_read_b32 v155, v93 offset:13184
    ds_read_b32 v156, v93 offset:792
    ds_read_b32 v160, v93 offset:9752
    ds_read_b32 v157, v93 offset:528
    ds_read_b32 v161, v93 offset:9488
    ds_read_b32 v158, v93 offset:264
    ds_read_b32 v162, v93 offset:9224
    ds_read_b32 v159, v93 offset:0
    ds_read_b32 v163, v93 offset:8960
    v_and_b32 v101, 0xffff0000, v84
    v_lshlrev_b32 v100, 16, v84
    v_and_b32 v103, 0xffff0000, v85
    v_lshlrev_b32 v102, 16, v85
    v_and_b32 v105, 0xffff0000, v86
    v_lshlrev_b32 v104, 16, v86
    v_and_b32 v107, 0xffff0000, v87
    v_lshlrev_b32 v106, 16, v87
    v_and_b32 v109, 0xffff0000, v88
    v_lshlrev_b32 v108, 16, v88
    v_and_b32 v111, 0xffff0000, v89
    v_lshlrev_b32 v110, 16, v89
    v_and_b32 v113, 0xffff0000, v90
    v_lshlrev_b32 v112, 16, v90
    v_and_b32 v115, 0xffff0000, v91
    v_lshlrev_b32 v114, 16, v91
    v_mul_f32 v52, v36, v12
    v_mul_f32 v56, v40, v12
    v_fma_f32 v52, -v40, v13, v52
    v_fma_f32 v56, v36, v13, v56
    s_waitcnt lgkmcnt(15)
    v_fmac_f32 v52, v100, v148
    v_fmac_f32 v56, v101, v148
    s_waitcnt lgkmcnt(14)
    v_fmac_f32 v52, v101, v152
    v_fma_f32 v56, -v100, v152, v56
    v_mul_f32 v53, v37, v14
    v_mul_f32 v57, v41, v14
    v_fma_f32 v53, -v41, v15, v53
    v_fma_f32 v57, v37, v15, v57
    s_waitcnt lgkmcnt(13)
    v_fmac_f32 v53, v102, v149
    v_fmac_f32 v57, v103, v149
    s_waitcnt lgkmcnt(12)
    v_fmac_f32 v53, v103, v153
    v_fma_f32 v57, -v102, v153, v57
    v_mul_f32 v54, v38, v16
    v_mul_f32 v58, v42, v16
    v_fma_f32 v54, -v42, v17, v54
    v_fma_f32 v58, v38, v17, v58
    s_waitcnt lgkmcnt(11)
    v_fmac_f32 v54, v104, v150
    v_fmac_f32 v58, v105, v150
    s_waitcnt lgkmcnt(10)
    v_fmac_f32 v54, v105, v154
    v_fma_f32 v58, -v104, v154, v58
    v_mul_f32 v55, v39, v18
    v_mul_f32 v59, v43, v18
    v_fma_f32 v55, -v43, v19, v55
    v_fma_f32 v59, v39, v19, v59
    s_waitcnt lgkmcnt(9)
    v_fmac_f32 v55, v106, v151
    v_fmac_f32 v59, v107, v151
    s_waitcnt lgkmcnt(8)
    v_fmac_f32 v55, v107, v155
    v_fma_f32 v59, -v106, v155, v59
    v_mul_f32 v60, v44, v20
    v_mul_f32 v64, v48, v20
    v_fma_f32 v60, -v48, v21, v60
    v_fma_f32 v64, v44, v21, v64
    s_waitcnt lgkmcnt(7)
    v_fmac_f32 v60, v108, v156
    v_fmac_f32 v64, v109, v156
    s_waitcnt lgkmcnt(6)
    v_fmac_f32 v60, v109, v160
    v_fma_f32 v64, -v108, v160, v64
    v_mul_f32 v61, v45, v22
    v_mul_f32 v65, v49, v22
    v_fma_f32 v61, -v49, v23, v61
    v_fma_f32 v65, v45, v23, v65
    s_waitcnt lgkmcnt(5)
    v_fmac_f32 v61, v110, v157
    v_fmac_f32 v65, v111, v157
    s_waitcnt lgkmcnt(4)
    v_fmac_f32 v61, v111, v161
    v_fma_f32 v65, -v110, v161, v65
    v_mul_f32 v62, v46, v24
    v_mul_f32 v66, v50, v24
    v_fma_f32 v62, -v50, v25, v62
    v_fma_f32 v66, v46, v25, v66
    s_waitcnt lgkmcnt(3)
    v_fmac_f32 v62, v112, v158
    v_fmac_f32 v66, v113, v158
    s_waitcnt lgkmcnt(2)
    v_fmac_f32 v62, v113, v162
    v_fma_f32 v66, -v112, v162, v66
    v_mul_f32 v63, v47, v26
    v_mul_f32 v67, v51, v26
    v_fma_f32 v63, -v51, v27, v63
    v_fma_f32 v67, v47, v27, v67
    s_waitcnt lgkmcnt(1)
    v_fmac_f32 v63, v114, v159
    v_fmac_f32 v67, v115, v159
    s_waitcnt lgkmcnt(0)
    v_fmac_f32 v63, v115, v163
    v_fma_f32 v67, -v114, v163, v67
    s_branch km_filtered
km_retry0:
    s_mov_b32 s100, 131072
km_retry0_l:
    s_sleep 2
    buffer_load_dwordx4 v[12:15], v221, s[8:11], s40 offen sc1
    buffer_load_dwordx4 v[16:19], v221, s[8:11], s40 offen offset:256 sc1
    s_waitcnt vmcnt(0)
    v_max3_u32 v150, v13, v15, v17
    v_max_u32 v150, v150, v19
    v_cmp_eq_u32 vcc, -1, v150
    s_nop 0
    s_cbranch_vccz km_back0
    s_sub_u32 s100, s100, 1
    s_cmp_lg_u32 s100, 0
    s_cbranch_scc1 km_retry0_l
    s_branch km_back0
km_retry1:
    s_mov_b32 s100, 131072
km_retry1_l:
    s_sleep 2
    buffer_load_dwordx2 v[154:155], v152, s[8:11], s28 offen sc1
    s_waitcnt vmcnt(0)
    v_cmp_eq_u32 vcc, -1, v155
    s_nop 0
    s_cbranch_vccz km_back1
    s_sub_u32 s100, s100, 1
    s_cmp_lg_u32 s100, 0
    s_cbranch_scc1 km_retry1_l
    s_branch km_back1
km_retry2:
    s_mov_b32 s100, 131072
km_retry2_l:
    s_sleep 2
    buffer_load_dwordx4 v[136:139], v9, s[8:11], s27 offen offset:3584 sc1
    buffer_load_dwordx4 v[140:143], v9, s[8:11], s29 offen offset:3584 sc1
    buffer_load_dwordx4 v[16:19], v9, s[8:11], s26 offen offset:0 sc1
    buffer_load_dwordx4 v[20:23], v9, s[8:11], s28 offen offset:0 sc1
    buffer_load_dwordx4 v[24:27], v9, s[8:11], s26 offen offset:512 sc1
    buffer_load_dwordx4 v[28:31], v9, s[8:11], s28 offen offset:512 sc1
    buffer_load_dwordx4 v[32:35], v9, s[8:11], s26 offen offset:1024 sc1
    buffer_load_dwordx4 v[36:39], v9, s[8:11], s28 offen offset:1024 sc1
    buffer_load_dwordx4 v[40:43], v9, s[8:11], s26 offen offset:1536 sc1
    buffer_load_dwordx4 v[44:47], v9, s[8:11], s28 offen offset:1536 sc1
    s_waitcnt vmcnt(0)
    v_max_u32 v10, v139, v143
    v_cmp_eq_u32 vcc, -1, v10
    s_nop 0
    s_cbranch_vccz km_back2
    s_sub_u32 s100, s100, 1
    s_cmp_lg_u32 s100, 0
    s_cbranch_scc1 km_retry2_l
    s_branch km_back2
km_retry3:
    s_mov_b32 s100, 131072
km_retry3_l:
    s_sleep 2
    buffer_load_dwordx4 v[16:19], v9, s[8:11], s26 offen offset:0 sc1
    buffer_load_dwordx4 v[20:23], v9, s[8:11], s28 offen offset:0 sc1
    s_waitcnt vmcnt(0)
    v_max_u32 v10, v19, v23
    v_cmp_eq_u32 vcc, -1, v10
    s_nop 0
    s_cbranch_vccz km_back3
    s_sub_u32 s100, s100, 1
    s_cmp_lg_u32 s100, 0
    s_cbranch_scc1 km_retry3_l
    s_branch km_back3
km_retry4:
    s_mov_b32 s100, 131072
km_retry4_l:
    s_sleep 2
    buffer_load_dwordx4 v[24:27], v9, s[8:11], s26 offen offset:512 sc1
    buffer_load_dwordx4 v[28:31], v9, s[8:11], s28 offen offset:512 sc1
    s_waitcnt vmcnt(0)
    v_max_u32 v10, v27, v31
    v_cmp_eq_u32 vcc, -1, v10
    s_nop 0
    s_cbranch_vccz km_back4
    s_sub_u32 s100, s100, 1
    s_cmp_lg_u32 s100, 0
    s_cbranch_scc1 km_retry4_l
    s_branch km_back4
km_retry5:
    s_mov_b32 s100, 131072
km_retry5_l:
    s_sleep 2
    buffer_load_dwordx4 v[32:35], v9, s[8:11], s26 offen offset:1024 sc1
    buffer_load_dwordx4 v[36:39], v9, s[8:11], s28 offen offset:1024 sc1
    s_waitcnt vmcnt(0)
    v_max_u32 v10, v35, v39
    v_cmp_eq_u32 vcc, -1, v10
    s_nop 0
    s_cbranch_vccz km_back5
    s_sub_u32 s100, s100, 1
    s_cmp_lg_u32 s100, 0
    s_cbranch_scc1 km_retry5_l
    s_branch km_back5
km_retry6:
    s_mov_b32 s100, 131072
km_retry6_l:
    s_sleep 2
    buffer_load_dwordx4 v[40:43], v9, s[8:11], s26 offen offset:1536 sc1
    buffer_load_dwordx4 v[44:47], v9, s[8:11], s28 offen offset:1536 sc1
    s_waitcnt vmcnt(0)
    v_max_u32 v10, v43, v47
    v_cmp_eq_u32 vcc, -1, v10
    s_nop 0
    s_cbranch_vccz km_back6
    s_sub_u32 s100, s100, 1
    s_cmp_lg_u32 s100, 0
    s_cbranch_scc1 km_retry6_l
    s_branch km_back6
km_retry7:
    s_mov_b32 s100, 131072
km_retry7_l:
    s_sleep 2
    buffer_load_dwordx4 v[48:51], v9, s[8:11], s26 offen offset:2048 sc1
    buffer_load_dwordx4 v[52:55], v9, s[8:11], s28 offen offset:2048 sc1
    s_waitcnt vmcnt(0)
    v_max_u32 v10, v51, v55
    v_cmp_eq_u32 vcc, -1, v10
    s_nop 0
    s_cbranch_vccz km_back7
    s_sub_u32 s100, s100, 1
    s_cmp_lg_u32 s100, 0
    s_cbranch_scc1 km_retry7_l
    s_branch km_back7
km_retry8:
    s_mov_b32 s100, 131072
km_retry8_l:
    s_sleep 2
    buffer_load_dwordx4 v[56:59], v9, s[8:11], s26 offen offset:2560 sc1
    buffer_load_dwordx4 v[60:63], v9, s[8:11], s28 offen offset:2560 sc1
    s_waitcnt vmcnt(0)
    v_max_u32 v10, v59, v63
    v_cmp_eq_u32 vcc, -1, v10
    s_nop 0
    s_cbranch_vccz km_back8
    s_sub_u32 s100, s100, 1
    s_cmp_lg_u32 s100, 0
    s_cbranch_scc1 km_retry8_l
    s_branch km_back8
km_retry9:
    s_mov_b32 s100, 131072
km_retry9_l:
    s_sleep 2
    buffer_load_dwordx4 v[64:67], v9, s[8:11], s26 offen offset:3072 sc1
    buffer_load_dwordx4 v[68:71], v9, s[8:11], s28 offen offset:3072 sc1
    s_waitcnt vmcnt(0)
    v_max_u32 v10, v67, v71
    v_cmp_eq_u32 vcc, -1, v10
    s_nop 0
    s_cbranch_vccz km_back9
    s_sub_u32 s100, s100, 1
    s_cmp_lg_u32 s100, 0
    s_cbranch_scc1 km_retry9_l
    s_branch km_back9
km_retry10:
    s_mov_b32 s100, 131072
km_retry10_l:
    s_sleep 2
    buffer_load_dwordx4 v[72:75], v9, s[8:11], s26 offen offset:3584 sc1
    buffer_load_dwordx4 v[76:79], v9, s[8:11], s28 offen offset:3584 sc1
    s_waitcnt vmcnt(0)
    v_max_u32 v10, v75, v79
    v_cmp_eq_u32 vcc, -1, v10
    s_nop 0
    s_cbranch_vccz km_back10
    s_sub_u32 s100, s100, 1
    s_cmp_lg_u32 s100, 0
    s_cbranch_scc1 km_retry10_l
    s_branch km_back10
km_retry11:
    s_mov_b32 s100, 131072
km_retry11_l:
    s_sleep 2
    buffer_load_dwordx4 v[80:83], v9, s[8:11], s27 offen offset:0 sc1
    buffer_load_dwordx4 v[84:87], v9, s[8:11], s29 offen offset:0 sc1
    s_waitcnt vmcnt(0)
    v_max_u32 v10, v83, v87
    v_cmp_eq_u32 vcc, -1, v10
    s_nop 0
    s_cbranch_vccz km_back11
    s_sub_u32 s100, s100, 1
    s_cmp_lg_u32 s100, 0
    s_cbranch_scc1 km_retry11_l
    s_branch km_back11
km_retry12:
    s_mov_b32 s100, 131072
km_retry12_l:
    s_sleep 2
    buffer_load_dwordx4 v[88:91], v9, s[8:11], s27 offen offset:512 sc1
    buffer_load_dwordx4 v[92:95], v9, s[8:11], s29 offen offset:512 sc1
    s_waitcnt vmcnt(0)
    v_max_u32 v10, v91, v95
    v_cmp_eq_u32 vcc, -1, v10
    s_nop 0
    s_cbranch_vccz km_back12
    s_sub_u32 s100, s100, 1
    s_cmp_lg_u32 s100, 0
    s_cbranch_scc1 km_retry12_l
    s_branch km_back12
km_retry13:
    s_mov_b32 s100, 131072
km_retry13_l:
    s_sleep 2
    buffer_load_dwordx4 v[96:99], v9, s[8:11], s27 offen offset:1024 sc1
    buffer_load_dwordx4 v[100:103], v9, s[8:11], s29 offen offset:1024 sc1
    s_waitcnt vmcnt(0)
    v_max_u32 v10, v99, v103
    v_cmp_eq_u32 vcc, -1, v10
    s_nop 0
    s_cbranch_vccz km_back13
    s_sub_u32 s100, s100, 1
    s_cmp_lg_u32 s100, 0
    s_cbranch_scc1 km_retry13_l
    s_branch km_back13
km_retry14:
    s_mov_b32 s100, 131072
km_retry14_l:
    s_sleep 2
    buffer_load_dwordx4 v[104:107], v9, s[8:11], s27 offen offset:1536 sc1
    buffer_load_dwordx4 v[108:111], v9, s[8:11], s29 offen offset:1536 sc1
    s_waitcnt vmcnt(0)
    v_max_u32 v10, v107, v111
    v_cmp_eq_u32 vcc, -1, v10
    s_nop 0
    s_cbranch_vccz km_back14
    s_sub_u32 s100, s100, 1
    s_cmp_lg_u32 s100, 0
    s_cbranch_scc1 km_retry14_l
    s_branch km_back14
km_retry15:
    s_mov_b32 s100, 131072
km_retry15_l:
    s_sleep 2
    buffer_load_dwordx4 v[112:115], v9, s[8:11], s27 offen offset:2048 sc1
    buffer_load_dwordx4 v[116:119], v9, s[8:11], s29 offen offset:2048 sc1
    s_waitcnt vmcnt(0)
    v_max_u32 v10, v115, v119
    v_cmp_eq_u32 vcc, -1, v10
    s_nop 0
    s_cbranch_vccz km_back15
    s_sub_u32 s100, s100, 1
    s_cmp_lg_u32 s100, 0
    s_cbranch_scc1 km_retry15_l
    s_branch km_back15
km_retry16:
    s_mov_b32 s100, 131072
km_retry16_l:
    s_sleep 2
    buffer_load_dwordx4 v[120:123], v9, s[8:11], s27 offen offset:2560 sc1
    buffer_load_dwordx4 v[124:127], v9, s[8:11], s29 offen offset:2560 sc1
    s_waitcnt vmcnt(0)
    v_max_u32 v10, v123, v127
    v_cmp_eq_u32 vcc, -1, v10
    s_nop 0
    s_cbranch_vccz km_back16
    s_sub_u32 s100, s100, 1
    s_cmp_lg_u32 s100, 0
    s_cbranch_scc1 km_retry16_l
    s_branch km_back16
km_retry17:
    s_mov_b32 s100, 131072
km_retry17_l:
    s_sleep 2
    buffer_load_dwordx4 v[128:131], v9, s[8:11], s27 offen offset:3072 sc1
    buffer_load_dwordx4 v[132:135], v9, s[8:11], s29 offen offset:3072 sc1
    s_waitcnt vmcnt(0)
    v_max_u32 v10, v131, v135
    v_cmp_eq_u32 vcc, -1, v10
    s_nop 0
    s_cbranch_vccz km_back17
    s_sub_u32 s100, s100, 1
    s_cmp_lg_u32 s100, 0
    s_cbranch_scc1 km_retry17_l
    s_branch km_back17
km_retry18:
    s_mov_b32 s100, 131072
km_retry18_l:
    s_sleep 2
    buffer_load_dwordx4 v[16:19], v9, s[8:11], s57 offen offset:1024 sc1
    buffer_load_dwordx4 v[20:23], v11, s[8:11], s57 offen offset:1024 sc1
    buffer_load_dwordx4 v[24:27], v12, s[8:11], s57 offen offset:1024 sc1
    buffer_load_dwordx4 v[28:31], v13, s[8:11], s57 offen offset:1024 sc1
    s_waitcnt vmcnt(0)
    v_max3_u32 v10, v19, v23, v27
    v_max_u32 v10, v10, v31
    v_cmp_eq_u32 vcc, -1, v10
    s_nop 0
    s_cbranch_vccz km_back18
    s_sub_u32 s100, s100, 1
    s_cmp_lg_u32 s100, 0
    s_cbranch_scc1 km_retry18_l
    s_branch km_back18
km_retry19:
    s_mov_b32 s100, 131072
km_retry19_l:
    s_sleep 2
    buffer_load_dwordx4 v[32:35], v9, s[8:11], s58 offen offset:1024 sc1
    buffer_load_dwordx4 v[36:39], v11, s[8:11], s58 offen offset:1024 sc1
    buffer_load_dwordx4 v[40:43], v12, s[8:11], s58 offen offset:1024 sc1
    buffer_load_dwordx4 v[44:47], v13, s[8:11], s58 offen offset:1024 sc1
    s_waitcnt vmcnt(0)
    v_max3_u32 v10, v35, v39, v43
    v_max_u32 v10, v10, v47
    v_cmp_eq_u32 vcc, -1, v10
    s_nop 0
    s_cbranch_vccz km_back19
    s_sub_u32 s100, s100, 1
    s_cmp_lg_u32 s100, 0
    s_cbranch_scc1 km_retry19_l
    s_branch km_back19
km_retry20:
    s_mov_b32 s100, 131072
km_retry20_l:
    s_sleep 2
    buffer_load_dwordx4 v[48:51], v9, s[8:11], s59 offen offset:1024 sc1
    buffer_load_dwordx4 v[52:55], v11, s[8:11], s59 offen offset:1024 sc1
    buffer_load_dwordx4 v[56:59], v12, s[8:11], s59 offen offset:1024 sc1
    buffer_load_dwordx4 v[60:63], v13, s[8:11], s59 offen offset:1024 sc1
    s_waitcnt vmcnt(0)
    v_max3_u32 v10, v51, v55, v59
    v_max_u32 v10, v10, v63
    v_cmp_eq_u32 vcc, -1, v10
    s_nop 0
    s_cbranch_vccz km_back20
    s_sub_u32 s100, s100, 1
    s_cmp_lg_u32 s100, 0
    s_cbranch_scc1 km_retry20_l
    s_branch km_back20
km_retry21:
    s_mov_b32 s100, 131072
km_retry21_l:
    s_sleep 2
    buffer_load_dwordx4 v[64:67], v9, s[8:11], s60 offen offset:1024 sc1
    buffer_load_dwordx4 v[68:71], v11, s[8:11], s60 offen offset:1024 sc1
    buffer_load_dwordx4 v[72:75], v12, s[8:11], s60 offen offset:1024 sc1
    buffer_load_dwordx4 v[76:79], v13, s[8:11], s60 offen offset:1024 sc1
    s_waitcnt vmcnt(0)
    v_max3_u32 v10, v67, v71, v75
    v_max_u32 v10, v10, v79
    v_cmp_eq_u32 vcc, -1, v10
    s_nop 0
    s_cbranch_vccz km_back21
    s_sub_u32 s100, s100, 1
    s_cmp_lg_u32 s100, 0
    s_cbranch_scc1 km_retry21_l
    s_branch km_back21
km_retry22:
    s_mov_b32 s100, 131072
km_retry22_l:
    s_sleep 1
    buffer_load_dword v248, v247, s[8:11], s26 offen offset:3580 sc1
    s_waitcnt vmcnt(0)
    v_cmp_eq_u32 vcc, -1, v248
    s_nop 0
    s_cbranch_vccz km_back22
    s_sub_u32 s100, s100, 1
    s_cmp_lg_u32 s100, 0
    s_cbranch_scc1 km_retry22_l
    s_branch km_back22
km_retry23:
    s_mov_b32 s100, 131072
km_retry23_l:
    s_sleep 2
    buffer_load_dwordx2 v[144:145], v240, s[8:11], s57 offen offset:3072 sc1
    buffer_load_dwordx2 v[146:147], v240, s[8:11], s57 offen offset:3584 sc1
    buffer_load_dwordx2 v[148:149], v241, s[8:11], s57 offen offset:3072 sc1
    buffer_load_dwordx2 v[150:151], v241, s[8:11], s57 offen offset:3584 sc1
    buffer_load_dwordx2 v[152:153], v242, s[8:11], s57 offen offset:3072 sc1
    buffer_load_dwordx2 v[154:155], v242, s[8:11], s57 offen offset:3584 sc1
    buffer_load_dwordx2 v[156:157], v243, s[8:11], s57 offen offset:3072 sc1
    buffer_load_dwordx2 v[158:159], v243, s[8:11], s57 offen offset:3584 sc1
    s_waitcnt vmcnt(0)
    v_max3_u32 v10, v145, v147, v149
    v_max3_u32 v10, v10, v151, v153
    v_max3_u32 v10, v10, v155, v157
    v_max_u32 v10, v10, v159
    v_cmp_eq_u32 vcc, -1, v10
    s_nop 0
    s_cbranch_vccz km_back23
    s_sub_u32 s100, s100, 1
    s_cmp_lg_u32 s100, 0
    s_cbranch_scc1 km_retry23_l
    s_branch km_back23
km_retry24:
    s_mov_b32 s100, 131072
km_retry24_l:
    s_sleep 2
    buffer_load_dwordx4 v[160:163], v9, s[8:11], s58 offen offset:2048 sc1
    buffer_load_dwordx4 v[164:167], v11, s[8:11], s58 offen offset:2048 sc1
    buffer_load_dwordx4 v[168:171], v12, s[8:11], s58 offen offset:2048 sc1
    buffer_load_dwordx4 v[172:175], v13, s[8:11], s58 offen offset:2048 sc1
    s_waitcnt vmcnt(0)
    v_max3_u32 v10, v163, v167, v171
    v_max_u32 v10, v10, v175
    v_cmp_eq_u32 vcc, -1, v10
    s_nop 0
    s_cbranch_vccz km_back24
    s_sub_u32 s100, s100, 1
    s_cmp_lg_u32 s100, 0
    s_cbranch_scc1 km_retry24_l
    s_branch km_back24
km_retry25:
    s_mov_b32 s100, 131072
km_retry25_l:
    s_sleep 2
    buffer_load_dwordx4 v[16:19], v9, s[8:11], s57 offen offset:2048 sc1
    buffer_load_dwordx4 v[20:23], v11, s[8:11], s57 offen offset:2048 sc1
    buffer_load_dwordx4 v[24:27], v12, s[8:11], s57 offen offset:2048 sc1
    buffer_load_dwordx4 v[28:31], v13, s[8:11], s57 offen offset:2048 sc1
    s_waitcnt vmcnt(0)
    v_max3_u32 v10, v19, v23, v27
    v_max_u32 v10, v10, v31
    v_cmp_eq_u32 vcc, -1, v10
    s_nop 0
    s_cbranch_vccz km_back25
    s_sub_u32 s100, s100, 1
    s_cmp_lg_u32 s100, 0
    s_cbranch_scc1 km_retry25_l
    s_branch km_back25
km_retry26:
    s_mov_b32 s100, 131072
km_retry26_l:
    s_sleep 2
    buffer_load_dwordx2 v[32:33], v240, s[8:11], s59 offen offset:3072 sc1
    buffer_load_dwordx2 v[34:35], v240, s[8:11], s59 offen offset:3584 sc1
    buffer_load_dwordx2 v[36:37], v241, s[8:11], s59 offen offset:3072 sc1
    buffer_load_dwordx2 v[38:39], v241, s[8:11], s59 offen offset:3584 sc1
    buffer_load_dwordx2 v[40:41], v242, s[8:11], s59 offen offset:3072 sc1
    buffer_load_dwordx2 v[42:43], v242, s[8:11], s59 offen offset:3584 sc1
    buffer_load_dwordx2 v[44:45], v243, s[8:11], s59 offen offset:3072 sc1
    buffer_load_dwordx2 v[46:47], v243, s[8:11], s59 offen offset:3584 sc1
    s_waitcnt vmcnt(0)
    v_max3_u32 v10, v33, v35, v37
    v_max3_u32 v10, v10, v39, v41
    v_max3_u32 v10, v10, v43, v45
    v_max_u32 v10, v10, v47
    v_cmp_eq_u32 vcc, -1, v10
    s_nop 0
    s_cbranch_vccz km_back26
    s_sub_u32 s100, s100, 1
    s_cmp_lg_u32 s100, 0
    s_cbranch_scc1 km_retry26_l
    s_branch km_back26
km_retry27:
    s_mov_b32 s100, 131072
km_retry27_l:
    s_sleep 2
    buffer_load_dwordx4 v[48:51], v9, s[8:11], s60 offen offset:2048 sc1
    buffer_load_dwordx4 v[52:55], v11, s[8:11], s60 offen offset:2048 sc1
    buffer_load_dwordx4 v[56:59], v12, s[8:11], s60 offen offset:2048 sc1
    buffer_load_dwordx4 v[60:63], v13, s[8:11], s60 offen offset:2048 sc1
    s_waitcnt vmcnt(0)
    v_max3_u32 v10, v51, v55, v59
    v_max_u32 v10, v10, v63
    v_cmp_eq_u32 vcc, -1, v10
    s_nop 0
    s_cbranch_vccz km_back27
    s_sub_u32 s100, s100, 1
    s_cmp_lg_u32 s100, 0
    s_cbranch_scc1 km_retry27_l
    s_branch km_back27
km_retry28:
    s_mov_b32 s100, 131072
km_retry28_l:
    s_sleep 2
    buffer_load_dwordx4 v[64:67], v9, s[8:11], s59 offen offset:2048 sc1
    buffer_load_dwordx4 v[68:71], v11, s[8:11], s59 offen offset:2048 sc1
    buffer_load_dwordx4 v[72:75], v12, s[8:11], s59 offen offset:2048 sc1
    buffer_load_dwordx4 v[76:79], v13, s[8:11], s59 offen offset:2048 sc1
    s_waitcnt vmcnt(0)
    v_max3_u32 v10, v67, v71, v75
    v_max_u32 v10, v10, v79
    v_cmp_eq_u32 vcc, -1, v10
    s_nop 0
    s_cbranch_vccz km_back28
    s_sub_u32 s100, s100, 1
    s_cmp_lg_u32 s100, 0
    s_cbranch_scc1 km_retry28_l
    s_branch km_back28
km_end:
    s_endpgm
.section .rodata,"a"
.p2align 6
.amdhsa_kernel k1_kernel
  .amdhsa_next_free_vgpr 136
  .amdhsa_next_free_sgpr 76
  .amdhsa_accum_offset 136
  .amdhsa_group_segment_fixed_size 0
  .amdhsa_kernarg_size 72
  .amdhsa_user_sgpr_count 2
  .amdhsa_user_sgpr_kernarg_segment_ptr 1
  .amdhsa_system_sgpr_workgroup_id_x 1
  .amdhsa_float_denorm_mode_32 3
  .amdhsa_float_denorm_mode_16_64 3
.end_amdhsa_kernel
.section .rodata,"a"
.p2align 6
.amdhsa_kernel km_kernel
  .amdhsa_next_free_vgpr 512
  .amdhsa_next_free_sgpr 102
  .amdhsa_accum_offset 256
  .amdhsa_group_segment_fixed_size 0
  .amdhsa_kernarg_size 72
  .amdhsa_user_sgpr_count 2
  .amdhsa_user_sgpr_kernarg_segment_ptr 1
  .amdhsa_system_sgpr_workgroup_id_x 1
  .amdhsa_float_denorm_mode_32 3
  .amdhsa_float_denorm_mode_16_64 3
.end_amdhsa_kernel
.section .rodata,"a"
.p2align 8
.type tab1,@object
tab1:
.quad 0x3f803f803f803f80,0x3f803f803f803f80,0x3f553f6d3f7b3f80,0x3e483ec43f0e3f35,0x3ec43f353f6d3f80,0xbf6dbf35bec4248d,0xbe483ec43f553f80,0xbf0ebf6dbf7bbf35
.quad 0xbf35248d3f353f80,0x3f35a554bf35bf80,0xbf7bbec43f0e3f80,0x3f553f6d3e48bf35,0xbf6dbf353ec43f80,0xbec43f353f6da554,0xbf0ebf6d3e483f80,0xbf7bbec43f553f35
.quad 0xa554bf80248d3f80,0xa554bf80248d3f80,0x3f0ebf6dbe483f80,0x3f7bbec4bf553f35,0x3f6dbf35bec43f80,0x3ec43f35bf6d248d,0x3f7bbec4bf0e3f80,0xbf553f6dbe48bf35
.quad 0x3f35a554bf353f80,0xbf35248d3f35bf80,0x3e483ec4bf553f80,0x3f0ebf6d3f7bbf35,0xbec43f35bf6d3f80,0x3f6dbf353ec4a554,0xbf553f6dbf7b3f80,0xbe483ec4bf0e3f35
.quad 0x3f803f803f803f80,0x3f803f803f803f80,0xbf0ebec4be48248d,0xbf7bbf6dbf55bf35,0xbec4bf35bf6dbf80,0x3f6d3f353ec4a554,0x3f7b3f6d3f0ea554,0xbf55bec43e483f35
.quad 0xbf35248d3f353f80,0x3f35a554bf35bf80,0xbe48bf6dbf55248d,0xbf0e3ec43f7b3f35,0x3f6d3f35bec4bf80,0x3ec4bf35bf6d248d,0xbf553ec43f7ba554,0xbe483f6d3f0ebf35
.quad 0xa554bf80248d3f80,0xa554bf80248d3f80,0x3f553ec4bf7b248d,0x3e483f6dbf0ebf35,0xbf6d3f353ec4bf80,0xbec4bf353f6da554,0x3e48bf6d3f55a554,0x3f0e3ec4bf7b3f35
.quad 0x3f35a554bf353f80,0xbf35248d3f35bf80,0xbf7b3f6dbf0e248d,0x3f55bec4be483f35,0x3ec4bf353f6dbf80,0xbf6d3f35bec4248d,0x3f0ebec43e48a554,0x3f7bbf6d3f55bf35
.quad 0x3f803f803f803f80,0x3f803f803f803f80,0xbf55bf6dbf7bbf80,0xbe48bec4bf0ebf35,0x3ec43f353f6d3f80,0xbf6dbf35bec4248d,0x3e48bec4bf55bf80,0x3f0e3f6d3f7b3f35
.quad 0xbf35248d3f353f80,0x3f35a554bf35bf80,0x3f7b3ec4bf0ebf80,0xbf55bf6dbe483f35,0xbf6dbf353ec43f80,0xbec43f353f6da554,0x3f0e3f6dbe48bf80,0x3f7b3ec4bf55bf35
.quad 0xa554bf80248d3f80,0xa554bf80248d3f80,0xbf0e3f6d3e48bf80,0xbf7b3ec43f55bf35,0x3f6dbf35bec43f80,0x3ec43f35bf6d248d,0xbf7b3ec43f0ebf80,0x3f55bf6d3e483f35
.quad 0x3f35a554bf353f80,0xbf35248d3f35bf80,0xbe48bec43f55bf80,0xbf0e3f6dbf7b3f35,0xbec43f35bf6d3f80,0x3f6dbf353ec4a554,0x3f55bf6d3f7bbf80,0x3e48bec43f0ebf35
.quad 0x3f803f803f803f80,0x3f803f803f803f80,0x3f0e3ec43e48a554,0x3f7b3f6d3f553f35,0xbec4bf35bf6dbf80,0x3f6d3f353ec4a554,0xbf7bbf6dbf0e248d,0x3f553ec4be48bf35
.quad 0xbf35248d3f353f80,0x3f35a554bf35bf80,0x3e483f6d3f55a554,0x3f0ebec4bf7bbf35,0x3f6d3f35bec4bf80,0x3ec4bf35bf6d248d,0x3f55bec4bf7b248d,0x3e48bf6dbf0e3f35
.quad 0xa554bf80248d3f80,0xa554bf80248d3f80,0xbf55bec43f7ba554,0xbe48bf6d3f0e3f35,0xbf6d3f353ec4bf80,0xbec4bf353f6da554,0xbe483f6dbf55248d,0xbf0ebec43f7bbf35
.quad 0x3f35a554bf353f80,0xbf35248d3f35bf80,0x3f7bbf6d3f0ea554,0xbf553ec43e48bf35,0x3ec4bf353f6dbf80,0xbf6d3f35bec4248d,0xbf0e3ec4be48248d,0xbf7b3f6dbf553f35
.quad 0x0,0x0,0xbf0ebec4be480000,0xbf7bbf6dbf55bf35,0xbf6dbf35bec40000,0xbec4bf35bf6dbf80,0xbf7bbf6dbf0e0000,0x3f553ec4be48bf35
.quad 0xbf35bf80bf350000,0x3f353f803f35a50d,0xbe48bf6dbf550000,0xbf0e3ec43f7b3f35,0x3ec4bf35bf6d0000,0xbf6dbf353ec43f80,0x3f55bec4bf7b0000,0x3e48bf6dbf0e3f35
.quad 0x3f80a50dbf800000,0x3f80a50dbf800000,0x3f553ec4bf7b0000,0x3e483f6dbf0ebf35,0x3ec43f35bf6d0000,0xbf6d3f353ec4bf80,0xbe483f6dbf550000,0xbf0ebec43f7bbf35
.quad 0xbf353f80bf350000,0x3f35bf803f35a50d,0xbf7b3f6dbf0e0000,0x3f55bec4be483f35,0xbf6d3f35bec40000,0xbec43f35bf6d3f80,0xbf0e3ec4be480000,0xbf7b3f6dbf553f35
.quad 0x0,0x0,0xbf55bf6dbf7bbf80,0xbe48bec4bf0ebf35,0x3f6d3f353ec4a50d,0x3ec43f353f6d3f80,0xbe483ec43f553f80,0xbf0ebf6dbf7bbf35
.quad 0xbf35bf80bf350000,0x3f353f803f35a50d,0x3f7b3ec4bf0ebf80,0xbf55bf6dbe483f35,0xbec43f353f6da50d,0x3f6d3f35bec4bf80,0xbf0ebf6d3e483f80,0xbf7bbec43f553f35
.quad 0x3f80a50dbf800000,0x3f80a50dbf800000,0xbf0e3f6d3e48bf80,0xbf7b3ec43f55bf35,0xbec4bf353f6da50d,0x3f6dbf35bec43f80,0x3f7bbec4bf0e3f80,0xbf553f6dbe48bf35
.quad 0xbf353f80bf350000,0x3f35bf803f35a50d,0xbe48bec43f55bf80,0xbf0e3f6dbf7b3f35,0x3f6dbf353ec4a50d,0x3ec4bf353f6dbf80,0xbf553f6dbf7b3f80,0xbe483ec4bf0e3f35
.quad 0x0,0x0,0x3f0e3ec43e48a50d,0x3f7b3f6d3f553f35,0xbf6dbf35bec40000,0xbec4bf35bf6dbf80,0x3f7b3f6d3f0ea50d,0xbf55bec43e483f35
.quad 0xbf35bf80bf350000,0x3f353f803f35a50d,0x3e483f6d3f55a50d,0x3f0ebec4bf7bbf35,0x3ec4bf35bf6d0000,0xbf6dbf353ec43f80,0xbf553ec43f7ba50d,0xbe483f6d3f0ebf35
.quad 0x3f80a50dbf800000,0x3f80a50dbf800000,0xbf55bec43f7ba50d,0xbe48bf6d3f0e3f35,0x3ec43f35bf6d0000,0xbf6d3f353ec4bf80,0x3e48bf6d3f55a50d,0x3f0e3ec4bf7b3f35
.quad 0xbf353f80bf350000,0x3f35bf803f35a50d,0x3f7bbf6d3f0ea50d,0xbf553ec43e48bf35,0xbf6d3f35bec40000,0xbec43f35bf6d3f80,0x3f0ebec43e48a50d,0x3f7bbf6d3f55bf35
.quad 0x0,0x0,0x3f553f6d3f7b3f80,0x3e483ec43f0e3f35,0x3f6d3f353ec4a50d,0x3ec43f353f6d3f80,0x3e48bec4bf55bf80,0x3f0e3f6d3f7b3f35
.quad 0xbf35bf80bf350000,0x3f353f803f35a50d,0xbf7bbec43f0e3f80,0x3f553f6d3e48bf35,0xbec43f353f6da50d,0x3f6d3f35bec4bf80,0x3f0e3f6dbe48bf80,0x3f7b3ec4bf55bf35
.quad 0x3f80a50dbf800000,0x3f80a50dbf800000,0x3f0ebf6dbe483f80,0x3f7bbec4bf553f35,0xbec4bf353f6da50d,0x3f6dbf35bec43f80,0xbf7b3ec43f0ebf80,0x3f55bf6d3e483f35
.quad 0xbf353f80bf350000,0x3f35bf803f35a50d,0x3e483ec4bf553f80,0x3f0ebf6d3f7bbf35,0x3f6dbf353ec4a50d,0x3ec4bf353f6dbf80,0x3f55bf6d3f7bbf80,0x3e48bec43f0ebf35
.quad 0x8000800080008000,0x8000800080008000,0x3f0e3ec43e488000,0x3f7b3f6d3f553f35,0x3f6d3f353ec48000,0x3ec43f353f6d3f80,0x3f7b3f6d3f0e8000,0xbf55bec43e483f35
.quad 0x3f353f803f358000,0xbf35bf80bf35250d,0x3e483f6d3f558000,0x3f0ebec4bf7bbf35,0xbec43f353f6d8000,0x3f6d3f35bec4bf80,0xbf553ec43f7b8000,0xbe483f6d3f0ebf35
.quad 0xbf80250d3f808000,0xbf80250d3f808000,0xbf55bec43f7b8000,0xbe48bf6d3f0e3f35,0xbec4bf353f6d8000,0x3f6dbf35bec43f80,0x3e48bf6d3f558000,0x3f0e3ec4bf7b3f35
.quad 0x3f35bf803f358000,0xbf353f80bf35250d,0x3f7bbf6d3f0e8000,0xbf553ec43e48bf35,0x3f6dbf353ec48000,0x3ec4bf353f6dbf80,0x3f0ebec43e488000,0x3f7bbf6d3f55bf35
.quad 0x8000800080008000,0x8000800080008000,0x3f553f6d3f7b3f80,0x3e483ec43f0e3f35,0xbf6dbf35bec4250d,0xbec4bf35bf6dbf80,0x3e48bec4bf55bf80,0x3f0e3f6d3f7b3f35
.quad 0x3f353f803f358000,0xbf35bf80bf35250d,0xbf7bbec43f0e3f80,0x3f553f6d3e48bf35,0x3ec4bf35bf6d250d,0xbf6dbf353ec43f80,0x3f0e3f6dbe48bf80,0x3f7b3ec4bf55bf35
.quad 0xbf80250d3f808000,0xbf80250d3f808000,0x3f0ebf6dbe483f80,0x3f7bbec4bf553f35,0x3ec43f35bf6d250d,0xbf6d3f353ec4bf80,0xbf7b3ec43f0ebf80,0x3f55bf6d3e483f35
.quad 0x3f35bf803f358000,0xbf353f80bf35250d,0x3e483ec4bf553f80,0x3f0ebf6d3f7bbf35,0xbf6d3f35bec4250d,0xbec43f35bf6d3f80,0x3f55bf6d3f7bbf80,0x3e48bec43f0ebf35
.quad 0x8000800080008000,0x8000800080008000,0xbf0ebec4be48250d,0xbf7bbf6dbf55bf35,0x3f6d3f353ec48000,0x3ec43f353f6d3f80,0xbf7bbf6dbf0e250d,0x3f553ec4be48bf35
.quad 0x3f353f803f358000,0xbf35bf80bf35250d,0xbe48bf6dbf55250d,0xbf0e3ec43f7b3f35,0xbec43f353f6d8000,0x3f6d3f35bec4bf80,0x3f55bec4bf7b250d,0x3e48bf6dbf0e3f35
.quad 0xbf80250d3f808000,0xbf80250d3f808000,0x3f553ec4bf7b250d,0x3e483f6dbf0ebf35,0xbec4bf353f6d8000,0x3f6dbf35bec43f80,0xbe483f6dbf55250d,0xbf0ebec43f7bbf35
.quad 0x3f35bf803f358000,0xbf353f80bf35250d,0xbf7b3f6dbf0e250d,0x3f55bec4be483f35,0x3f6dbf353ec48000,0x3ec4bf353f6dbf80,0xbf0e3ec4be48250d,0xbf7b3f6dbf553f35
.quad 0x8000800080008000,0x8000800080008000,0xbf55bf6dbf7bbf80,0xbe48bec4bf0ebf35,0xbf6dbf35bec4250d,0xbec4bf35bf6dbf80,0xbe483ec43f553f80,0xbf0ebf6dbf7bbf35
.quad 0x3f353f803f358000,0xbf35bf80bf35250d,0x3f7b3ec4bf0ebf80,0xbf55bf6dbe483f35,0x3ec4bf35bf6d250d,0xbf6dbf353ec43f80,0xbf0ebf6d3e483f80,0xbf7bbec43f553f35
.quad 0xbf80250d3f808000,0xbf80250d3f808000,0xbf0e3f6d3e48bf80,0xbf7b3ec43f55bf35,0x3ec43f35bf6d250d,0xbf6d3f353ec4bf80,0x3f7bbec4bf0e3f80,0xbf553f6dbe48bf35
.quad 0x3f35bf803f358000,0xbf353f80bf35250d,0xbe48bec43f55bf80,0xbf0e3f6dbf7b3f35,0xbf6d3f35bec4250d,0xbec43f35bf6d3f80,0xbf553f6dbf7b3f80,0xbe483ec4bf0e3f35
.quad 0xbf803f80bf803f80,0xbf803f80bf803f80,0xbf553f6dbf7b3f80,0xbe483ec4bf0e3f35,0xbec43f35bf6d3f80,0x3f6dbf353ec4248d,0x3e483ec4bf553f80,0x3f0ebf6d3f7bbf35
.quad 0x3f35248dbf353f80,0xbf35a5543f35bf80,0x3f7bbec4bf0e3f80,0xbf553f6dbe48bf35,0x3f6dbf35bec43f80,0x3ec43f35bf6da554,0x3f0ebf6dbe483f80,0x3f7bbec4bf553f35
.quad 0x248dbf80a5543f80,0x248dbf80a5543f80,0xbf0ebf6d3e483f80,0xbf7bbec43f553f35,0xbf6dbf353ec43f80,0xbec43f353f6d248d,0xbf7bbec43f0e3f80,0x3f553f6d3e48bf35
.quad 0xbf35a5543f353f80,0x3f35248dbf35bf80,0xbe483ec43f553f80,0xbf0ebf6dbf7bbf35,0x3ec43f353f6d3f80,0xbf6dbf35bec4a554,0x3f553f6d3f7b3f80,0x3e483ec43f0e3f35
.quad 0xbf803f80bf803f80,0xbf803f80bf803f80,0x3f0ebec43e48248d,0x3f7bbf6d3f55bf35,0x3ec4bf353f6dbf80,0xbf6d3f35bec4a554,0xbf7b3f6dbf0ea554,0x3f55bec4be483f35
.quad 0x3f35248dbf353f80,0xbf35a5543f35bf80,0x3e48bf6d3f55248d,0x3f0e3ec4bf7b3f35,0xbf6d3f353ec4bf80,0xbec4bf353f6d248d,0x3f553ec4bf7ba554,0x3e483f6dbf0ebf35
.quad 0x248dbf80a5543f80,0x248dbf80a5543f80,0xbf553ec43f7b248d,0xbe483f6d3f0ebf35,0x3f6d3f35bec4bf80,0x3ec4bf35bf6da554,0xbe48bf6dbf55a554,0xbf0e3ec43f7b3f35
.quad 0xbf35a5543f353f80,0x3f35248dbf35bf80,0x3f7b3f6d3f0e248d,0xbf55bec43e483f35,0xbec4bf35bf6dbf80,0x3f6d3f353ec4248d,0xbf0ebec4be48a554,0xbf7bbf6dbf55bf35
.quad 0xbf803f80bf803f80,0xbf803f80bf803f80,0x3f55bf6d3f7bbf80,0x3e48bec43f0ebf35,0xbec43f35bf6d3f80,0x3f6dbf353ec4248d,0xbe48bec43f55bf80,0xbf0e3f6dbf7b3f35
.quad 0x3f35248dbf353f80,0xbf35a5543f35bf80,0xbf7b3ec43f0ebf80,0x3f55bf6d3e483f35,0x3f6dbf35bec43f80,0x3ec43f35bf6da554,0xbf0e3f6d3e48bf80,0xbf7b3ec43f55bf35
.quad 0x248dbf80a5543f80,0x248dbf80a5543f80,0x3f0e3f6dbe48bf80,0x3f7b3ec4bf55bf35,0xbf6dbf353ec43f80,0xbec43f353f6d248d,0x3f7b3ec4bf0ebf80,0xbf55bf6dbe483f35
.quad 0xbf35a5543f353f80,0x3f35248dbf35bf80,0x3e48bec4bf55bf80,0x3f0e3f6d3f7b3f35,0x3ec43f353f6d3f80,0xbf6dbf35bec4a554,0xbf55bf6dbf7bbf80,0xbe48bec4bf0ebf35
.quad 0xbf803f80bf803f80,0xbf803f80bf803f80,0xbf0e3ec4be48a554,0xbf7b3f6dbf553f35,0x3ec4bf353f6dbf80,0xbf6d3f35bec4a554,0x3f7bbf6d3f0e248d,0xbf553ec43e48bf35
.quad 0x3f35248dbf353f80,0xbf35a5543f35bf80,0xbe483f6dbf55a554,0xbf0ebec43f7bbf35,0xbf6d3f353ec4bf80,0xbec4bf353f6d248d,0xbf55bec43f7b248d,0xbe48bf6d3f0e3f35
.quad 0x248dbf80a5543f80,0x248dbf80a5543f80,0x3f55bec4bf7ba554,0x3e48bf6dbf0e3f35,0x3f6d3f35bec4bf80,0x3ec4bf35bf6da554,0x3e483f6d3f55248d,0x3f0ebec4bf7bbf35
.quad 0xbf35a5543f353f80,0x3f35248dbf35bf80,0xbf7bbf6dbf0ea554,0x3f553ec4be48bf35,0xbec4bf35bf6dbf80,0x3f6d3f353ec4248d,0x3f0e3ec43e48248d,0x3f7b3f6d3f553f35
.quad 0xa50d0000a50d0000,0xa50d0000a50d0000,0x3f0ebec43e480000,0x3f7bbf6d3f55bf35,0x3f6dbf353ec40000,0x3ec4bf353f6dbf80,0x3f7bbf6d3f0e0000,0xbf553ec43e48bf35
.quad 0x3f35bf803f350000,0xbf353f80bf35a50d,0x3e48bf6d3f550000,0x3f0e3ec4bf7b3f35,0xbec4bf353f6d0000,0x3f6dbf35bec43f80,0xbf55bec43f7b0000,0xbe48bf6d3f0e3f35
.quad 0xbf80a50d3f800000,0xbf80a50d3f800000,0xbf553ec43f7b0000,0xbe483f6d3f0ebf35,0xbec43f353f6d0000,0x3f6d3f35bec4bf80,0x3e483f6d3f550000,0x3f0ebec4bf7bbf35
.quad 0x3f353f803f350000,0xbf35bf80bf35a50d,0x3f7b3f6d3f0e0000,0xbf55bec43e483f35,0x3f6d3f353ec40000,0x3ec43f353f6d3f80,0x3f0e3ec43e480000,0x3f7b3f6d3f553f35
.quad 0xa50d0000a50d0000,0xa50d0000a50d0000,0x3f55bf6d3f7bbf80,0x3e48bec43f0ebf35,0xbf6d3f35bec4a50d,0xbec43f35bf6d3f80,0x3e483ec4bf553f80,0x3f0ebf6d3f7bbf35
.quad 0x3f35bf803f350000,0xbf353f80bf35a50d,0xbf7b3ec43f0ebf80,0x3f55bf6d3e483f35,0x3ec43f35bf6da50d,0xbf6d3f353ec4bf80,0x3f0ebf6dbe483f80,0x3f7bbec4bf553f35
.quad 0xbf80a50d3f800000,0xbf80a50d3f800000,0x3f0e3f6dbe48bf80,0x3f7b3ec4bf55bf35,0x3ec4bf35bf6da50d,0xbf6dbf353ec43f80,0xbf7bbec43f0e3f80,0x3f553f6d3e48bf35
.quad 0x3f353f803f350000,0xbf35bf80bf35a50d,0x3e48bec4bf55bf80,0x3f0e3f6d3f7b3f35,0xbf6dbf35bec4a50d,0xbec4bf35bf6dbf80,0x3f553f6d3f7b3f80,0x3e483ec43f0e3f35
.quad 0xa50d0000a50d0000,0xa50d0000a50d0000,0xbf0e3ec4be48a50d,0xbf7b3f6dbf553f35,0x3f6dbf353ec40000,0x3ec4bf353f6dbf80,0xbf7b3f6dbf0ea50d,0x3f55bec4be483f35
.quad 0x3f35bf803f350000,0xbf353f80bf35a50d,0xbe483f6dbf55a50d,0xbf0ebec43f7bbf35,0xbec4bf353f6d0000,0x3f6dbf35bec43f80,0x3f553ec4bf7ba50d,0x3e483f6dbf0ebf35
.quad 0xbf80a50d3f800000,0xbf80a50d3f800000,0x3f55bec4bf7ba50d,0x3e48bf6dbf0e3f35,0xbec43f353f6d0000,0x3f6d3f35bec4bf80,0xbe48bf6dbf55a50d,0xbf0e3ec43f7b3f35
.quad 0x3f353f803f350000,0xbf35bf80bf35a50d,0xbf7bbf6dbf0ea50d,0x3f553ec4be48bf35,0x3f6d3f353ec40000,0x3ec43f353f6d3f80,0xbf0ebec4be48a50d,0xbf7bbf6dbf55bf35
.quad 0xa50d0000a50d0000,0xa50d0000a50d0000,0xbf553f6dbf7b3f80,0xbe483ec4bf0e3f35,0xbf6d3f35bec4a50d,0xbec43f35bf6d3f80,0xbe48bec43f55bf80,0xbf0e3f6dbf7b3f35
.quad 0x3f35bf803f350000,0xbf353f80bf35a50d,0x3f7bbec4bf0e3f80,0xbf553f6dbe48bf35,0x3ec43f35bf6da50d,0xbf6d3f353ec4bf80,0xbf0e3f6d3e48bf80,0xbf7b3ec43f55bf35
.quad 0xbf80a50d3f800000,0xbf80a50d3f800000,0xbf0ebf6d3e483f80,0xbf7bbec43f553f35,0x3ec4bf35bf6da50d,0xbf6dbf353ec43f80,0x3f7b3ec4bf0ebf80,0xbf55bf6dbe483f35
.quad 0x3f353f803f350000,0xbf35bf80bf35a50d,0xbe483ec43f553f80,0xbf0ebf6dbf7bbf35,0xbf6dbf35bec4a50d,0xbec4bf35bf6dbf80,0xbf55bf6dbf7bbf80,0xbe48bec4bf0ebf35
.quad 0x250d8000250d8000,0x250d8000250d8000,0xbf0e3ec4be488000,0xbf7b3f6dbf553f35,0xbf6d3f35bec48000,0xbec43f35bf6d3f80,0xbf7b3f6dbf0e8000,0x3f55bec4be483f35
.quad 0xbf353f80bf358000,0x3f35bf803f35250d,0xbe483f6dbf558000,0xbf0ebec43f7bbf35,0x3ec43f35bf6d8000,0xbf6d3f353ec4bf80,0x3f553ec4bf7b8000,0x3e483f6dbf0ebf35
.quad 0x3f80250dbf808000,0x3f80250dbf808000,0x3f55bec4bf7b8000,0x3e48bf6dbf0e3f35,0x3ec4bf35bf6d8000,0xbf6dbf353ec43f80,0xbe48bf6dbf558000,0xbf0e3ec43f7b3f35
.quad 0xbf35bf80bf358000,0x3f353f803f35250d,0xbf7bbf6dbf0e8000,0x3f553ec4be48bf35,0xbf6dbf35bec48000,0xbec4bf35bf6dbf80,0xbf0ebec4be488000,0xbf7bbf6dbf55bf35
.quad 0x250d8000250d8000,0x250d8000250d8000,0xbf553f6dbf7b3f80,0xbe483ec4bf0e3f35,0x3f6dbf353ec4250d,0x3ec4bf353f6dbf80,0xbe48bec43f55bf80,0xbf0e3f6dbf7b3f35
.quad 0xbf353f80bf358000,0x3f35bf803f35250d,0x3f7bbec4bf0e3f80,0xbf553f6dbe48bf35,0xbec4bf353f6d250d,0x3f6dbf35bec43f80,0xbf0e3f6d3e48bf80,0xbf7b3ec43f55bf35
.quad 0x3f80250dbf808000,0x3f80250dbf808000,0xbf0ebf6d3e483f80,0xbf7bbec43f553f35,0xbec43f353f6d250d,0x3f6d3f35bec4bf80,0x3f7b3ec4bf0ebf80,0xbf55bf6dbe483f35
.quad 0xbf35bf80bf358000,0x3f353f803f35250d,0xbe483ec43f553f80,0xbf0ebf6dbf7bbf35,0x3f6d3f353ec4250d,0x3ec43f353f6d3f80,0xbf55bf6dbf7bbf80,0xbe48bec4bf0ebf35
.quad 0x250d8000250d8000,0x250d8000250d8000,0x3f0ebec43e48250d,0x3f7bbf6d3f55bf35,0xbf6d3f35bec48000,0xbec43f35bf6d3f80,0x3f7bbf6d3f0e250d,0xbf553ec43e48bf35
.quad 0xbf353f80bf358000,0x3f35bf803f35250d,0x3e48bf6d3f55250d,0x3f0e3ec4bf7b3f35,0x3ec43f35bf6d8000,0xbf6d3f353ec4bf80,0xbf55bec43f7b250d,0xbe48bf6d3f0e3f35
.quad 0x3f80250dbf808000,0x3f80250dbf808000,0xbf553ec43f7b250d,0xbe483f6d3f0ebf35,0x3ec4bf35bf6d8000,0xbf6dbf353ec43f80,0x3e483f6d3f55250d,0x3f0ebec4bf7bbf35
.quad 0xbf35bf80bf358000,0x3f353f803f35250d,0x3f7b3f6d3f0e250d,0xbf55bec43e483f35,0xbf6dbf35bec48000,0xbec4bf35bf6dbf80,0x3f0e3ec43e48250d,0x3f7b3f6d3f553f35
.quad 0x250d8000250d8000,0x250d8000250d8000,0x3f55bf6d3f7bbf80,0x3e48bec43f0ebf35,0x3f6dbf353ec4250d,0x3ec4bf353f6dbf80,0x3e483ec4bf553f80,0x3f0ebf6d3f7bbf35
.quad 0xbf353f80bf358000,0x3f35bf803f35250d,0xbf7b3ec43f0ebf80,0x3f55bf6d3e483f35,0xbec4bf353f6d250d,0x3f6dbf35bec43f80,0x3f0ebf6dbe483f80,0x3f7bbec4bf553f35
.quad 0x3f80250dbf808000,0x3f80250dbf808000,0x3f0e3f6dbe48bf80,0x3f7b3ec4bf55bf35,0xbec43f353f6d250d,0x3f6d3f35bec4bf80,0xbf7bbec43f0e3f80,0x3f553f6d3e48bf35
.quad 0xbf35bf80bf358000,0x3f353f803f35250d,0x3e48bec4bf55bf80,0x3f0e3f6d3f7b3f35,0x3f6d3f353ec4250d,0x3ec43f353f6d3f80,0x3f553f6d3f7b3f80,0x3e483ec43f0e3f35
.quad 0x3f8000003f800000,0x3f8000003f800000,0x3f7cd6d63f800000,0x3f7667653f79a3ee,0x3f79a3ee3f800000,0x3f6c794d3f73215c,0x3f7667653f800000,0x3f62392a3f6c794d
.quad 0x3f73215c3f800000,0x3f57aa8b3f65acc6,0x3f6fd1f43f800000,0x3f4cd1193f5ebcd5,0x3f6c794d3f800000,0x3f41b0993f57aa8b,0x3f6917883f800000,0x3f364ce53f5076ff
.quad 0x3f65acc63f800000,0x3f2aa9f23f49234e,0x3f62392a3f800000,0x3f1ecbc93f41b099,0x3f5ebcd53f800000,0x3f12b6893f3a2005,0x3f5b37ea3f800000,0x3f066e623f3272be
.quad 0x3f57aa8b3f800000,0x3ef3ef2f3f2aa9f2,0x3f5414dc3f800000,0x3edaacf83f22c6d5,0x3f5076ff3f800000,0x3ec11ee43f1aca9e,0x3f4cd1193f800000,0x3ea74dcf3f12b689
.quad 0x3f8000003f800000,0x3f8000003f800000,0x3f6fd1f43f73215c,0x3f6917883f6c794d,0x3f5ebcd53f65acc6,0x3f5076ff3f57aa8b,0x3f4cd1193f57aa8b,0x3f364ce53f41b099
.quad 0x3f3a20053f49234e,0x3f1aca9e3f2aa9f2,0x3f26bb9a3f3a2005,0x3efc48363f12b689,0x3f12b6893f2aa9f2,0x3ec11ee43ef3ef2f,0x3efc48363f1aca9e,0x3e8488f83ec11ee4
.quad 0x3ed230453f0a8bd4,0x3e0df1a93e8d42af,0x3ea74dcf3ef3ef2f,0x3c8e2b2f3e314504,0x3e77944a3ed23045,0xbdd510d43d8e1d7b,0x3e1f9e6a3eafefbb,0xbe660d19bd0e2871
.quad 0x3d8e1d7b3e8d42af,0xbeafefbbbe0df1a9,0xbc8e2b2f3e547d09,0xbeeb8cc0be77944a,0xbdd510d43e0df1a9,0xbf12b689beafefbb,0xbe42e4c83d8e1d7b,0xbf2e91b5bee3213d
.quad 0x3f8000003f800000,0x3f8000003f800000,0x3f62392a3f65acc6,0x3f5b37ea3f5ebcd5,0x3f41b0993f49234e,0x3f3272be3f3a2005,0x3f1ecbc93f2aa9f2,0x3f066e623f12b689
.quad 0x3ef3ef2f3f0a8bd4,0x3eafefbb3ed23045,0x3ea74dcf3ed23045,0x3e1f9e6a3e77944a,0x3e3145043e8d42af,0xbd0e28713d8e1d7b,0x3c8e2b2f3e0df1a9,0xbe660d19bdd510d4
.quad 0xbe0df1a925000000,0xbed23045be8d42af,0xbe95f6f4be0df1a9,0xbf16c37cbee3213d,0xbee3213dbe8d42af,0xbf41b099bf1aca9e,0xbf16c37cbed23045,0xbf691788bf41b099
.quad 0xbf3a2005bf0a8bd4,0xbf862061bf65acc6,0xbf5b37eabf2aa9f2,0xbf954440bf831a4c,0xbf79a3eebf49234e,0xbfa1b0ddbf916566,0xbf8a8294bf65acc6,0xbfab2c57bf9d80a8
.quad 0x3f8000003f800000,0x3f8000003f800000,0x3f5414dc3f57aa8b,0x3f4cd1193f5076ff,0x3f22c6d53f2aa9f2,0x3f12b6893f1aca9e,0x3edaacf83ef3ef2f,0x3ea74dcf3ec11ee4
.quad 0x3e547d093e8d42af,0x3d8e1d7b3e0df1a9,0xbc8e2b2f3d8e1d7b,0xbe42e4c8bdd510d4,0xbe77944abe0df1a9,0xbee3213dbeafefbb,0xbeeb8cc0beafefbb,0xbf2e91b5bf12b689
.quad 0xbf2aa9f2bf0a8bd4,0xbf65acc6bf49234e,0xbf5b37eabf3a2005,0xbf8a8294bf79a3ee,0xbf831a4cbf65acc6,0xbf9d80a8bf916566,0xbf954440bf862061,0xbfab2c57bfa1b0dd
.quad 0xbfa3a3b9bf968317,0xbfb30f61bfad3986,0xbfaddb43bfa3a3b9,0xbfb4e58cbfb3a872,0xbfb3a872bfad3986,0xbfb09ef7bfb4cd21,0xbfb4e58cbfb30f61,0xbfa6609cbfb09ef7
.quad 0xbf800000bf800000,0xbf800000bf800000,0xbf818fa5bf800000,0xbf849fe5bf831a4c,0xbf831a4cbf800000,0xbf8911c7bf862061,0xbf849fe5bf800000,0xbf8d541bbf8911c7
.quad 0xbf862061bf800000,0xbf916566bf8bee0a,0xbf879bb1bf800000,0xbf954440bf8eb4b9,0xbf8911c7bf800000,0xbf98ef51bf916566,0xbf8a8294bf800000,0xbf9c6553bf93ffa8
.quad 0xbf8bee0abf800000,0xbf9fa512bf968317,0xbf8d541bbf800000,0xbfa2ad6ebf98ef51,0xbf8eb4b9bf800000,0xbfa57d59bf9b43f5,0xbf900fd7bf800000,0xbfa813dbbf9d80a8
.quad 0xbf916566bf800000,0xbfaa700cbf9fa512,0xbf92b55bbf800000,0xbfac911cbfa1b0dd,0xbf93ffa8bf800000,0xbfae764cbfa3a3b9,0xbf954440bf800000,0xbfb01ef6bfa57d59
.quad 0xbf800000bf800000,0xbf800000bf800000,0xbf879bb1bf862061,0xbf8a8294bf8911c7,0xbf8eb4b9bf8bee0a,0xbf93ffa8bf916566,0xbf954440bf916566,0xbf9c6553bf98ef51
.quad 0xbf9b43f5bf968317,0xbfa3a3b9bf9fa512,0xbfa0ae10bf9b43f5,0xbfa9ad2ebfa57d59,0xbfa57d59bf9fa512,0xbfae764cbfaa700c,0xbfa9ad2ebfa3a3b9,0xbfb1f60bbfae764c
.quad 0xbfad3986bfa73d75,0xbfb425cebfb18a86,0xbfb01ef6bfaa700c,0xbfb50176bfb3a872,0xbfb25ab4bfad3986,0xbfb48763bfb4cd21,0xbfb3ea98bfaf982b,0xbfb2b87cbfb4f6fe
.quad 0xbfb4cd21bfb18a86,0xbfaf982bbfb425ce,0xbfb50176bfb30f61,0xbfab2c57bfb25ab4,0xbfb48763bfb425ce,0xbfa57d59bfaf982b,0xbfb35f5fbfb4cd21,0xbf9e95ecbfabe20a
.quad 0xbf800000bf800000,0xbf800000bf800000,0xbf8d541bbf8bee0a,0xbf900fd7bf8eb4b9,0xbf98ef51bf968317,0xbf9d80a8bf9b43f5,0xbfa2ad6ebf9fa512,0xbfa813dbbfa57d59
.quad 0xbfaa700cbfa73d75,0xbfaf982bbfad3986,0xbfb01ef6bfad3986,0xbfb3ea98bfb25ab4,0xbfb3a872bfb18a86,0xbfb4f6febfb4cd21,0xbfb50176bfb425ce,0xbfb2b87cbfb48763
.quad 0xbfb425cebfb504f3,0xbfad3986bfb18a86,0xbfb11828bfb425ce,0xbfa493b5bfabe20a,0xbfabe20abfb18a86,0xbf98ef51bfa3a3b9,0xbfa493b5bfad3986,0xbf8a8294bf98ef51
.quad 0xbf9b43f5bfa73d75,0xbf73215cbf8bee0a,0xbf900fd7bf9fa512,0xbf4cd119bf79a3ee,0xbf831a4cbf968317,0xbf22c6d5bf57aa8b,0xbf691788bf8bee0a,0xbeeb8cc0bf3272be
.quad 0xbf800000bf800000,0xbf800000bf800000,0xbf92b55bbf916566,0xbf954440bf93ffa8,0xbfa1b0ddbf9fa512,0xbfa57d59bfa3a3b9,0xbfac911cbfaa700c,0xbfb01ef6bfae764c
.quad 0xbfb30f61bfb18a86,0xbfb4cd21bfb425ce,0xbfb50176bfb4cd21,0xbfb35f5fbfb48763,0xbfb25ab4bfb425ce,0xbfabe20abfaf982b,0xbfab2c57bfaf982b,0xbf9e95ecbfa57d59
.quad 0xbf9fa512bfa73d75,0xbf8bee0abf968317,0xbf900fd7bf9b43f5,0xbf691788bf831a4c,0xbf79a3eebf8bee0a,0xbf3272bebf57aa8b,0xbf4cd119bf73215c,0xbeeb8cc0bf22c6d5
.quad 0xbf1aca9ebf49234e,0xbe547d09bed23045,0xbec9ab78bf1aca9e,0x3d5535d0be314504,0xbe314504bed23045,0x3e9ea5703d8e1d7b,0x3d5535d0be547d09,0x3f0ea3ee3e9ea570
.quad 0x3f49234e3f800000,0x3e8d42af3f0a8bd4,0x3f456dc23f800000,0x3e660d193f024bc1,0x3f41b0993f800000,0x3e3145043ef3ef2f,0x3f3debf83f800000,0x3df87edd3ee3213d
.quad 0x3f3a20053f800000,0x3d8e1d7b3ed23045,0x3f364ce53f800000,0x3c8e2b2f3ec11ee4,0x3f3272be3f800000,0xbd0e28713eafefbb,0x3f2e91b53f800000,0xbdb19a943e9ea570
.quad 0x3f2aa9f23f800000,0xbe0df1a93e8d42af,0x3f26bb9a3f800000,0xbe42e4c83e77944a,0x3f22c6d53f800000,0xbe77944a3e547d09,0x3f1ecbc93f800000,0xbe95f6f43e314504
.quad 0x3f1aca9e3f800000,0xbeafefbb3e0df1a9,0x3f16c37c3f800000,0xbec9ab783dd510d4,0x3f12b6893f800000,0xbee3213d3d8e1d7b,0x3f0ea3ee3f800000,0xbefc48363d0e2871
.quad 0xbe8d42af25000000,0xbf49234ebf0a8bd4,0xbeb88adebd8e1d7b,0xbf62392abf22c6d5,0xbee3213dbe0df1a9,0xbf79a3eebf3a2005,0xbf066e62be547d09,0xbf879bb1bf5076ff
.quad 0xbf1aca9ebe8d42af,0xbf916566bf65acc6,0xbf2e91b5beafefbb,0xbf9a1c9cbf79a3ee,0xbf41b099bed23045,0xbfa1b0ddbf862061,0xbf5414dcbef3ef2f,0xbfa813dbbf8eb4b9
.quad 0xbf65acc6bf0a8bd4,0xbfad3986bf968317,0xbf766765bf1aca9e,0xbfb11828bf9d80a8,0xbf831a4cbf2aa9f2,0xbfb3a872bfa3a3b9,0xbf8a8294bf3a2005,0xbfb4e58cbfa8e3c6
.quad 0xbf916566bf49234e,0xbfb4cd21bfad3986,0xbf97bc21bf57aa8b,0xbfb35f5fbfb09ef7,0xbf9d80a8bf65acc6,0xbfb09ef7bfb30f61,0xbfa2ad6ebf73215c,0xbfac911cbfb48763
.quad 0xbf968317bf800000,0xbfb18a86bfa73d75,0xbfa0ae10bf8bee0a,0xbfb4adbebfae764c,0xbfa8e3c6bf968317,0xbfb48763bfb30f61,0xbfaf0a9cbf9fa512,0xbfb11828bfb4f6fe
.quad 0xbfb30f61bfa73d75,0xbfaa700cbfb425ce,0xbfb4e58cbfad3986,0xbfa0ae10bfb09ef7,0xbfb48763bfb18a86,0xbf93ffa8bfaa700c,0xbfb1f60bbfb425ce,0xbf849fe5bfa1b0dd
.quad 0xbfad3986bfb504f3,0xbf65acc6bf968317,0xbfa6609cbfb425ce,0xbf3debf8bf8911c7,0xbf9d80a8bfb18a86,0xbf12b689bf73215c,0xbf92b55bbfad3986,0xbec9ab78bf5076ff
.quad 0xbf862061bfa73d75,0xbe547d09bf2aa9f2,0xbf6fd1f4bf9fa512,0xbc8e2b2fbf024bc1,0xbf5076ffbf968317,0x3e314504beafefbb,0xbf2e91b5bf8bee0a,0x3eb88adebe314504
.quad 0xbfb18a86bfb504f3,0xbf968317bfa73d75,0xbfa9ad2ebfb30f61,0xbf818fa5bf98ef51,0xbf9d80a8bfad3986,0xbf5076ffbf862061,0xbf8d541bbfa3a3b9,0xbf16c37cbf5ebcd5
.quad 0xbf73215cbf968317,0xbeafefbbbf2aa9f2,0xbf456dc2bf862061,0xbdb19a94bee3213d,0xbf12b689bf65acc6,0x3e314504be547d09,0xbeb88adebf3a2005,0x3edaacf83d0e2871
.quad 0xbe0df1a9bf0a8bd4,0x3f2aa9f23e8d42af,0x3db19a94beafefbb,0x3f62392a3f024bc1,0x3e9ea570be0df1a9,0x3f8911c73f3a2005,0x3f066e623d8e1d7b,0x3f9c65533f6c794d
.quad 0x3f3a20053e8d42af,0x3faa700c3f8bee0a,0x3f6917883ef3ef2f,0x3fb2b87c3f9d80a8,0x3f8911c73f2aa9f2,0x3fb4f6fe3faa700c,0x3f9a1c9c3f57aa8b,0x3fb118283fb25ab4
.quad 0xbf968317bf800000,0xbfb18a86bfa73d75,0xbf97bc21bf800000,0xbfb2b87cbfa8e3c6,0xbf98ef51bf800000,0xbfb3a872bfaa700c,0xbf9a1c9cbf800000,0xbfb45a13bfabe20a
.quad 0xbf9b43f5bf800000,0xbfb4cd21bfad3986,0xbf9c6553bf800000,0xbfb50176bfae764c,0xbf9d80a8bf800000,0xbfb4f6febfaf982b,0xbf9e95ecbf800000,0xbfb4adbebfb09ef7
.quad 0xbf9fa512bf800000,0xbfb425cebfb18a86,0xbfa0ae10bf800000,0xbfb35f5fbfb25ab4,0xbfa1b0ddbf800000,0xbfb25ab4bfb30f61,0xbfa2ad6ebf800000,0xbfb11828bfb3a872
.quad 0xbfa3a3b9bf800000,0xbfaf982bbfb425ce,0xbfa493b5bf800000,0xbfaddb43bfb48763,0xbfa57d59bf800000,0xbfabe20abfb4cd21,0xbfa6609cbf800000,0xbfa9ad2ebfb4f6fe
.quad 0xbfb18a86bfb504f3,0xbf968317bfa73d75,0xbfaf0a9cbfb4cd21,0xbf8d541bbfa1b0dd,0xbfabe20abfb425ce,0xbf831a4cbf9b43f5,0xbfa813dbbfb30f61,0xbf6fd1f4bf93ffa8
.quad 0xbfa3a3b9bfb18a86,0xbf57aa8bbf8bee0a,0xbf9e95ecbfaf982b,0xbf3debf8bf831a4c,0xbf98ef51bfad3986,0xbf22c6d5bf73215c,0xbf92b55bbfaa700c,0xbf066e62bf5ebcd5
.quad 0xbf8bee0abfa73d75,0xbed23045bf49234e,0xbf849fe5bfa3a3b9,0xbe95f6f4bf3272be,0xbf79a3eebf9fa512,0xbe314504bf1aca9e,0xbf691788bf9b43f5,0xbd5535d0bf024bc1
.quad 0xbf57aa8bbf968317,0x3d8e1d7bbed23045,0xbf456dc2bf916566,0x3e42e4c8be9ea570,0xbf3272bebf8bee0a,0x3e9ea570be547d09,0xbf1ecbc9bf862061,0x3edaacf8bdd510d4
.quad 0xbf49234ebf800000,0xbe8d42afbf0a8bd4,0xbf26bb9abf65acc6,0xbdb19a94bec11ee4,0xbf024bc1bf49234e,0x3dd510d4be547d09,0xbeb88adebf2aa9f2,0x3e95f6f4bd0e2871
.quad 0xbe547d09bf0a8bd4,0x3ef3ef2f3e0df1a9,0xbd5535d0bed23045,0x3f26bb9a3e9ea570,0x3dd510d4be8d42af,0x3f5076ff3ef3ef2f,0x3e8488f8be0df1a9,0x3f7667653f22c6d5
.quad 0x3ed23045a5000000,0x3f8bee0a3f49234e,0x3f0ea3ee3e0df1a9,0x3f9a1c9c3f6c794d,0x3f3272be3e8d42af,0x3fa57d593f862061,0x3f5414dc3ed23045,0x3faddb433f93ffa8
.quad 0x3f73215c3f0a8bd4,0x3fb30f613f9fa512,0x3f879bb13f2aa9f2,0x3fb501763fa8e3c6,0x3f93ffa83f49234e,0x3fb3a8723faf982b,0x3f9e95ec3f65acc6,0x3faf0a9c3fb3a872
.quad 0x3e8d42afa5000000,0x3f49234e3f0a8bd4,0x3efc48363e547d09,0x3f7cd6d63f41b099,0x3f3272be3ed23045,0x3f93ffa83f73215c,0x3f62392a3f1aca9e,0x3fa493b53f8eb4b9
.quad 0x3f8620613f49234e,0x3faf982b3f9fa512,0x3f97bc213f73215c,0x3fb4adbe3fabe20a,0x3fa57d593f8bee0a,0x3fb3a8723fb30f61,0x3faf0a9c3f9b43f5,0x3fac911c3fb4f6fe
.quad 0x3fb425ce3fa73d75,0x3f9fa5123fb18a86,0x3fb4adbe3faf982b,0x3f8d541b3fa8e3c6,0x3fb09ef73fb425ce,0x3f6c794d3f9b43f5,0x3fa813db3fb4cd21,0x3f364ce53f8911c7
.quad 0x3f9b43f53fb18a86,0x3ef3ef2f3f65acc6,0x3f8a82943faa700c,0x3e660d193f3272be,0x3f6c794d3f9fa512,0xbd0e28713ef3ef2f,0x3f3debf83f916566,0xbe95f6f43e77944a
.quad 0x3f803f803f803f80,0x8000800080008000,0x3ec43f353f6d3f80,0x3f6d3f353ec48000,0xbf35248d3f353f80,0x3f353f803f358000,0xbf6dbf353ec43f80,0xbec43f353f6d8000
.quad 0xa554bf80248d3f80,0xbf80250d3f808000,0x3f6dbf35bec43f80,0xbec4bf353f6d8000,0x3f35a554bf353f80,0x3f35bf803f358000,0xbec43f35bf6d3f80,0x3f6dbf353ec48000
.quad 0xbf803f80bf803f80,0x250d8000250d8000,0xbec43f35bf6d3f80,0xbf6d3f35bec48000,0x3f35248dbf353f80,0xbf353f80bf358000,0x3f6dbf35bec43f80,0x3ec43f35bf6d8000
.quad 0x248dbf80a5543f80,0x3f80250dbf808000,0xbf6dbf353ec43f80,0x3ec4bf35bf6d8000,0xbf35a5543f353f80,0xbf35bf80bf358000,0x3ec43f353f6d3f80,0xbf6dbf35bec48000
.quad 0x3f803f803f803f80,0x8000800080008000,0xbf6dbf35bec4248d,0x3ec43f353f6d3f80,0x3f35a554bf35bf80,0xbf35bf80bf35250d,0xbec43f353f6da554,0x3f6d3f35bec4bf80
.quad 0xa554bf80248d3f80,0xbf80250d3f808000,0x3ec43f35bf6d248d,0x3f6dbf35bec43f80,0xbf35248d3f35bf80,0xbf353f80bf35250d,0x3f6dbf353ec4a554,0x3ec4bf353f6dbf80
.quad 0xbf803f80bf803f80,0x250d8000250d8000,0x3f6dbf353ec4248d,0xbec43f35bf6d3f80,0xbf35a5543f35bf80,0x3f35bf803f35250d,0x3ec43f35bf6da554,0xbf6d3f353ec4bf80
.quad 0x248dbf80a5543f80,0x3f80250dbf808000,0xbec43f353f6d248d,0xbf6dbf353ec43f80,0x3f35248dbf35bf80,0x3f353f803f35250d,0xbf6dbf35bec4a554,0xbec4bf35bf6dbf80
.quad 0x3f803f803f803f80,0x8000800080008000,0xbec4bf35bf6dbf80,0xbf6dbf35bec4250d,0xbf35248d3f353f80,0x3f353f803f358000,0x3f6d3f35bec4bf80,0x3ec4bf35bf6d250d
.quad 0xa554bf80248d3f80,0xbf80250d3f808000,0xbf6d3f353ec4bf80,0x3ec43f35bf6d250d,0x3f35a554bf353f80,0x3f35bf803f358000,0x3ec4bf353f6dbf80,0xbf6d3f35bec4250d
.quad 0xbf803f80bf803f80,0x250d8000250d8000,0x3ec4bf353f6dbf80,0x3f6dbf353ec4250d,0x3f35248dbf353f80,0xbf353f80bf358000,0xbf6d3f353ec4bf80,0xbec4bf353f6d250d
.quad 0x248dbf80a5543f80,0x3f80250dbf808000,0x3f6d3f35bec4bf80,0xbec43f353f6d250d,0xbf35a5543f353f80,0xbf35bf80bf358000,0xbec4bf35bf6dbf80,0x3f6d3f353ec4250d
.quad 0x3f803f803f803f80,0x8000800080008000,0x3f6d3f353ec4a554,0xbec4bf35bf6dbf80,0x3f35a554bf35bf80,0xbf35bf80bf35250d,0x3ec4bf35bf6d248d,0xbf6dbf353ec43f80
.quad 0xa554bf80248d3f80,0xbf80250d3f808000,0xbec4bf353f6da554,0xbf6d3f353ec4bf80,0xbf35248d3f35bf80,0xbf353f80bf35250d,0xbf6d3f35bec4248d,0xbec43f35bf6d3f80
.quad 0xbf803f80bf803f80,0x250d8000250d8000,0xbf6d3f35bec4a554,0x3ec4bf353f6dbf80,0xbf35a5543f35bf80,0x3f35bf803f35250d,0xbec4bf353f6d248d,0x3f6dbf35bec43f80
.quad 0x248dbf80a5543f80,0x3f80250dbf808000,0x3ec4bf35bf6da554,0x3f6d3f35bec4bf80,0x3f35248dbf35bf80,0x3f353f803f35250d,0x3f6d3f353ec4248d,0x3ec43f353f6d3f80
.quad 0x0,0x3f803f803f803f80,0xbf6dbf35bec40000,0x3ec43f353f6d3f80,0xbf35bf80bf350000,0xbf35248d3f353f80,0x3ec4bf35bf6d0000,0xbf6dbf353ec43f80
.quad 0x3f80a50dbf800000,0xa554bf80248d3f80,0x3ec43f35bf6d0000,0x3f6dbf35bec43f80,0xbf353f80bf350000,0x3f35a554bf353f80,0xbf6d3f35bec40000,0xbec43f35bf6d3f80
.quad 0xa50d0000a50d0000,0xbf803f80bf803f80,0x3f6dbf353ec40000,0xbec43f35bf6d3f80,0x3f35bf803f350000,0x3f35248dbf353f80,0xbec4bf353f6d0000,0x3f6dbf35bec43f80
.quad 0xbf80a50d3f800000,0x248dbf80a5543f80,0xbec43f353f6d0000,0xbf6dbf353ec43f80,0x3f353f803f350000,0xbf35a5543f353f80,0x3f6d3f353ec40000,0x3ec43f353f6d3f80
.quad 0x0,0x3f803f803f803f80,0xbec4bf35bf6dbf80,0xbf6dbf35bec4248d,0x3f353f803f35a50d,0x3f35a554bf35bf80,0xbf6dbf353ec43f80,0xbec43f353f6da554
.quad 0x3f80a50dbf800000,0xa554bf80248d3f80,0xbf6d3f353ec4bf80,0x3ec43f35bf6d248d,0x3f35bf803f35a50d,0xbf35248d3f35bf80,0xbec43f35bf6d3f80,0x3f6dbf353ec4a554
.quad 0xa50d0000a50d0000,0xbf803f80bf803f80,0x3ec4bf353f6dbf80,0x3f6dbf353ec4248d,0xbf353f80bf35a50d,0xbf35a5543f35bf80,0x3f6dbf35bec43f80,0x3ec43f35bf6da554
.quad 0xbf80a50d3f800000,0x248dbf80a5543f80,0x3f6d3f35bec4bf80,0xbec43f353f6d248d,0xbf35bf80bf35a50d,0x3f35248dbf35bf80,0x3ec43f353f6d3f80,0xbf6dbf35bec4a554
.quad 0x0,0x3f803f803f803f80,0x3f6d3f353ec4a50d,0xbec4bf35bf6dbf80,0xbf35bf80bf350000,0xbf35248d3f353f80,0xbec43f353f6da50d,0x3f6d3f35bec4bf80
.quad 0x3f80a50dbf800000,0xa554bf80248d3f80,0xbec4bf353f6da50d,0xbf6d3f353ec4bf80,0xbf353f80bf350000,0x3f35a554bf353f80,0x3f6dbf353ec4a50d,0x3ec4bf353f6dbf80
.quad 0xa50d0000a50d0000,0xbf803f80bf803f80,0xbf6d3f35bec4a50d,0x3ec4bf353f6dbf80,0x3f35bf803f350000,0x3f35248dbf353f80,0x3ec43f35bf6da50d,0xbf6d3f353ec4bf80
.quad 0xbf80a50d3f800000,0x248dbf80a5543f80,0x3ec4bf35bf6da50d,0x3f6d3f35bec4bf80,0x3f353f803f350000,0xbf35a5543f353f80,0xbf6dbf35bec4a50d,0xbec4bf35bf6dbf80
.quad 0x0,0x3f803f803f803f80,0x3ec43f353f6d3f80,0x3f6d3f353ec4a554,0x3f353f803f35a50d,0x3f35a554bf35bf80,0x3f6d3f35bec4bf80,0x3ec4bf35bf6d248d
.quad 0x3f80a50dbf800000,0xa554bf80248d3f80,0x3f6dbf35bec43f80,0xbec4bf353f6da554,0x3f35bf803f35a50d,0xbf35248d3f35bf80,0x3ec4bf353f6dbf80,0xbf6d3f35bec4248d
.quad 0xa50d0000a50d0000,0xbf803f80bf803f80,0xbec43f35bf6d3f80,0xbf6d3f35bec4a554,0xbf353f80bf35a50d,0xbf35a5543f35bf80,0xbf6d3f353ec4bf80,0xbec4bf353f6d248d
.quad 0xbf80a50d3f800000,0x248dbf80a5543f80,0xbf6dbf353ec43f80,0x3ec4bf35bf6da554,0xbf35bf80bf35a50d,0x3f35248dbf35bf80,0xbec4bf35bf6dbf80,0x3f6d3f353ec4248d
.size tab1, 12288
.p2align 8
.type tabm,@object
tabm:
.quad 0x3f803f803f803f80,0x3f803f803f803f80,0x3f553f6d3f7b3f80,0xbf55bf6dbf7bbf80,0x3ec43f353f6d3f80,0x3ec43f353f6d3f80,0xbe483ec43f553f80,0x3e48bec4bf55bf80
.quad 0xbf35248d3f353f80,0xbf35248d3f353f80,0xbf7bbec43f0e3f80,0x3f7b3ec4bf0ebf80,0xbf6dbf353ec43f80,0xbf6dbf353ec43f80,0xbf0ebf6d3e483f80,0x3f0e3f6dbe48bf80
.quad 0xa554bf80248d3f80,0xa554bf80248d3f80,0x3f0ebf6dbe483f80,0xbf0e3f6d3e48bf80,0x3f6dbf35bec43f80,0x3f6dbf35bec43f80,0x3f7bbec4bf0e3f80,0xbf7b3ec43f0ebf80
.quad 0x3f35a554bf353f80,0x3f35a554bf353f80,0x3e483ec4bf553f80,0xbe48bec43f55bf80,0xbec43f35bf6d3f80,0xbec43f35bf6d3f80,0xbf553f6dbf7b3f80,0x3f55bf6d3f7bbf80
.quad 0x3f803f803f803f80,0x3f803f803f803f80,0x3e483ec43f0e3f35,0xbe48bec4bf0ebf35,0xbf6dbf35bec4248d,0xbf6dbf35bec4248d,0xbf0ebf6dbf7bbf35,0x3f0e3f6d3f7b3f35
.quad 0x3f35a554bf35bf80,0x3f35a554bf35bf80,0x3f553f6d3e48bf35,0xbf55bf6dbe483f35,0xbec43f353f6da554,0xbec43f353f6da554,0xbf7bbec43f553f35,0x3f7b3ec4bf55bf35
.quad 0xa554bf80248d3f80,0xa554bf80248d3f80,0x3f7bbec4bf553f35,0xbf7b3ec43f55bf35,0x3ec43f35bf6d248d,0x3ec43f35bf6d248d,0xbf553f6dbe48bf35,0x3f55bf6d3e483f35
.quad 0xbf35248d3f35bf80,0xbf35248d3f35bf80,0x3f0ebf6d3f7bbf35,0xbf0e3f6dbf7b3f35,0x3f6dbf353ec4a554,0x3f6dbf353ec4a554,0xbe483ec4bf0e3f35,0x3e48bec43f0ebf35
.quad 0x3f803f803f803f80,0x3f803f803f803f80,0xbf0ebec4be48248d,0x3f0e3ec43e48a554,0xbec4bf35bf6dbf80,0xbec4bf35bf6dbf80,0x3f7b3f6d3f0ea554,0xbf7bbf6dbf0e248d
.quad 0xbf35248d3f353f80,0xbf35248d3f353f80,0xbe48bf6dbf55248d,0x3e483f6d3f55a554,0x3f6d3f35bec4bf80,0x3f6d3f35bec4bf80,0xbf553ec43f7ba554,0x3f55bec4bf7b248d
.quad 0xa554bf80248d3f80,0xa554bf80248d3f80,0x3f553ec4bf7b248d,0xbf55bec43f7ba554,0xbf6d3f353ec4bf80,0xbf6d3f353ec4bf80,0x3e48bf6d3f55a554,0xbe483f6dbf55248d
.quad 0x3f35a554bf353f80,0x3f35a554bf353f80,0xbf7b3f6dbf0e248d,0x3f7bbf6d3f0ea554,0x3ec4bf353f6dbf80,0x3ec4bf353f6dbf80,0x3f0ebec43e48a554,0xbf0e3ec4be48248d
.quad 0x3f803f803f803f80,0x3f803f803f803f80,0xbf7bbf6dbf55bf35,0x3f7b3f6d3f553f35,0x3f6d3f353ec4a554,0x3f6d3f353ec4a554,0xbf55bec43e483f35,0x3f553ec4be48bf35
.quad 0x3f35a554bf35bf80,0x3f35a554bf35bf80,0xbf0e3ec43f7b3f35,0x3f0ebec4bf7bbf35,0x3ec4bf35bf6d248d,0x3ec4bf35bf6d248d,0xbe483f6d3f0ebf35,0x3e48bf6dbf0e3f35
.quad 0xa554bf80248d3f80,0xa554bf80248d3f80,0x3e483f6dbf0ebf35,0xbe48bf6d3f0e3f35,0xbec4bf353f6da554,0xbec4bf353f6da554,0x3f0e3ec4bf7b3f35,0xbf0ebec43f7bbf35
.quad 0xbf35248d3f35bf80,0xbf35248d3f35bf80,0x3f55bec4be483f35,0xbf553ec43e48bf35,0xbf6d3f35bec4248d,0xbf6d3f35bec4248d,0x3f7bbf6d3f55bf35,0xbf7b3f6dbf553f35
.quad 0x0,0x0,0xbf0ebec4be480000,0x3f0e3ec43e48a50d,0xbf6dbf35bec40000,0xbf6dbf35bec40000,0xbf7bbf6dbf0e0000,0x3f7b3f6d3f0ea50d
.quad 0xbf35bf80bf350000,0xbf35bf80bf350000,0xbe48bf6dbf550000,0x3e483f6d3f55a50d,0x3ec4bf35bf6d0000,0x3ec4bf35bf6d0000,0x3f55bec4bf7b0000,0xbf553ec43f7ba50d
.quad 0x3f80a50dbf800000,0x3f80a50dbf800000,0x3f553ec4bf7b0000,0xbf55bec43f7ba50d,0x3ec43f35bf6d0000,0x3ec43f35bf6d0000,0xbe483f6dbf550000,0x3e48bf6d3f55a50d
.quad 0xbf353f80bf350000,0xbf353f80bf350000,0xbf7b3f6dbf0e0000,0x3f7bbf6d3f0ea50d,0xbf6d3f35bec40000,0xbf6d3f35bec40000,0xbf0e3ec4be480000,0x3f0ebec43e48a50d
.quad 0x0,0x0,0xbf7bbf6dbf55bf35,0x3f7b3f6d3f553f35,0xbec4bf35bf6dbf80,0xbec4bf35bf6dbf80,0x3f553ec4be48bf35,0xbf55bec43e483f35
.quad 0x3f353f803f35a50d,0x3f353f803f35a50d,0xbf0e3ec43f7b3f35,0x3f0ebec4bf7bbf35,0xbf6dbf353ec43f80,0xbf6dbf353ec43f80,0x3e48bf6dbf0e3f35,0xbe483f6d3f0ebf35
.quad 0x3f80a50dbf800000,0x3f80a50dbf800000,0x3e483f6dbf0ebf35,0xbe48bf6d3f0e3f35,0xbf6d3f353ec4bf80,0xbf6d3f353ec4bf80,0xbf0ebec43f7bbf35,0x3f0e3ec4bf7b3f35
.quad 0x3f35bf803f35a50d,0x3f35bf803f35a50d,0x3f55bec4be483f35,0xbf553ec43e48bf35,0xbec43f35bf6d3f80,0xbec43f35bf6d3f80,0xbf7b3f6dbf553f35,0x3f7bbf6d3f55bf35
.quad 0x0,0x0,0xbf55bf6dbf7bbf80,0x3f553f6d3f7b3f80,0x3f6d3f353ec4a50d,0x3f6d3f353ec4a50d,0xbe483ec43f553f80,0x3e48bec4bf55bf80
.quad 0xbf35bf80bf350000,0xbf35bf80bf350000,0x3f7b3ec4bf0ebf80,0xbf7bbec43f0e3f80,0xbec43f353f6da50d,0xbec43f353f6da50d,0xbf0ebf6d3e483f80,0x3f0e3f6dbe48bf80
.quad 0x3f80a50dbf800000,0x3f80a50dbf800000,0xbf0e3f6d3e48bf80,0x3f0ebf6dbe483f80,0xbec4bf353f6da50d,0xbec4bf353f6da50d,0x3f7bbec4bf0e3f80,0xbf7b3ec43f0ebf80
.quad 0xbf353f80bf350000,0xbf353f80bf350000,0xbe48bec43f55bf80,0x3e483ec4bf553f80,0x3f6dbf353ec4a50d,0x3f6dbf353ec4a50d,0xbf553f6dbf7b3f80,0x3f55bf6d3f7bbf80
.quad 0x0,0x0,0xbe48bec4bf0ebf35,0x3e483ec43f0e3f35,0x3ec43f353f6d3f80,0x3ec43f353f6d3f80,0xbf0ebf6dbf7bbf35,0x3f0e3f6d3f7b3f35
.quad 0x3f353f803f35a50d,0x3f353f803f35a50d,0xbf55bf6dbe483f35,0x3f553f6d3e48bf35,0x3f6d3f35bec4bf80,0x3f6d3f35bec4bf80,0xbf7bbec43f553f35,0x3f7b3ec4bf55bf35
.quad 0x3f80a50dbf800000,0x3f80a50dbf800000,0xbf7b3ec43f55bf35,0x3f7bbec4bf553f35,0x3f6dbf35bec43f80,0x3f6dbf35bec43f80,0xbf553f6dbe48bf35,0x3f55bf6d3e483f35
.quad 0x3f35bf803f35a50d,0x3f35bf803f35a50d,0xbf0e3f6dbf7b3f35,0x3f0ebf6d3f7bbf35,0x3ec4bf353f6dbf80,0x3ec4bf353f6dbf80,0xbe483ec4bf0e3f35,0x3e48bec43f0ebf35
.quad 0x8000800080008000,0x8000800080008000,0x3f0e3ec43e488000,0xbf0ebec4be48250d,0x3f6d3f353ec48000,0x3f6d3f353ec48000,0x3f7b3f6d3f0e8000,0xbf7bbf6dbf0e250d
.quad 0x3f353f803f358000,0x3f353f803f358000,0x3e483f6d3f558000,0xbe48bf6dbf55250d,0xbec43f353f6d8000,0xbec43f353f6d8000,0xbf553ec43f7b8000,0x3f55bec4bf7b250d
.quad 0xbf80250d3f808000,0xbf80250d3f808000,0xbf55bec43f7b8000,0x3f553ec4bf7b250d,0xbec4bf353f6d8000,0xbec4bf353f6d8000,0x3e48bf6d3f558000,0xbe483f6dbf55250d
.quad 0x3f35bf803f358000,0x3f35bf803f358000,0x3f7bbf6d3f0e8000,0xbf7b3f6dbf0e250d,0x3f6dbf353ec48000,0x3f6dbf353ec48000,0x3f0ebec43e488000,0xbf0e3ec4be48250d
.quad 0x8000800080008000,0x8000800080008000,0x3f7b3f6d3f553f35,0xbf7bbf6dbf55bf35,0x3ec43f353f6d3f80,0x3ec43f353f6d3f80,0xbf55bec43e483f35,0x3f553ec4be48bf35
.quad 0xbf35bf80bf35250d,0xbf35bf80bf35250d,0x3f0ebec4bf7bbf35,0xbf0e3ec43f7b3f35,0x3f6d3f35bec4bf80,0x3f6d3f35bec4bf80,0xbe483f6d3f0ebf35,0x3e48bf6dbf0e3f35
.quad 0xbf80250d3f808000,0xbf80250d3f808000,0xbe48bf6d3f0e3f35,0x3e483f6dbf0ebf35,0x3f6dbf35bec43f80,0x3f6dbf35bec43f80,0x3f0e3ec4bf7b3f35,0xbf0ebec43f7bbf35
.quad 0xbf353f80bf35250d,0xbf353f80bf35250d,0xbf553ec43e48bf35,0x3f55bec4be483f35,0x3ec4bf353f6dbf80,0x3ec4bf353f6dbf80,0x3f7bbf6d3f55bf35,0xbf7b3f6dbf553f35
.quad 0x8000800080008000,0x8000800080008000,0x3f553f6d3f7b3f80,0xbf55bf6dbf7bbf80,0xbf6dbf35bec4250d,0xbf6dbf35bec4250d,0x3e48bec4bf55bf80,0xbe483ec43f553f80
.quad 0x3f353f803f358000,0x3f353f803f358000,0xbf7bbec43f0e3f80,0x3f7b3ec4bf0ebf80,0x3ec4bf35bf6d250d,0x3ec4bf35bf6d250d,0x3f0e3f6dbe48bf80,0xbf0ebf6d3e483f80
.quad 0xbf80250d3f808000,0xbf80250d3f808000,0x3f0ebf6dbe483f80,0xbf0e3f6d3e48bf80,0x3ec43f35bf6d250d,0x3ec43f35bf6d250d,0xbf7b3ec43f0ebf80,0x3f7bbec4bf0e3f80
.quad 0x3f35bf803f358000,0x3f35bf803f358000,0x3e483ec4bf553f80,0xbe48bec43f55bf80,0xbf6d3f35bec4250d,0xbf6d3f35bec4250d,0x3f55bf6d3f7bbf80,0xbf553f6dbf7b3f80
.quad 0x8000800080008000,0x8000800080008000,0x3e483ec43f0e3f35,0xbe48bec4bf0ebf35,0xbec4bf35bf6dbf80,0xbec4bf35bf6dbf80,0x3f0e3f6d3f7b3f35,0xbf0ebf6dbf7bbf35
.quad 0xbf35bf80bf35250d,0xbf35bf80bf35250d,0x3f553f6d3e48bf35,0xbf55bf6dbe483f35,0xbf6dbf353ec43f80,0xbf6dbf353ec43f80,0x3f7b3ec4bf55bf35,0xbf7bbec43f553f35
.quad 0xbf80250d3f808000,0xbf80250d3f808000,0x3f7bbec4bf553f35,0xbf7b3ec43f55bf35,0xbf6d3f353ec4bf80,0xbf6d3f353ec4bf80,0x3f55bf6d3e483f35,0xbf553f6dbe48bf35
.quad 0xbf353f80bf35250d,0xbf353f80bf35250d,0x3f0ebf6d3f7bbf35,0xbf0e3f6dbf7b3f35,0xbec43f35bf6d3f80,0xbec43f35bf6d3f80,0x3e48bec43f0ebf35,0xbe483ec4bf0e3f35
.quad 0xbf803f80bf803f80,0xbf803f80bf803f80,0xbf553f6dbf7b3f80,0x3f55bf6d3f7bbf80,0xbec43f35bf6d3f80,0xbec43f35bf6d3f80,0x3e483ec4bf553f80,0xbe48bec43f55bf80
.quad 0x3f35248dbf353f80,0x3f35248dbf353f80,0x3f7bbec4bf0e3f80,0xbf7b3ec43f0ebf80,0x3f6dbf35bec43f80,0x3f6dbf35bec43f80,0x3f0ebf6dbe483f80,0xbf0e3f6d3e48bf80
.quad 0x248dbf80a5543f80,0x248dbf80a5543f80,0xbf0ebf6d3e483f80,0x3f0e3f6dbe48bf80,0xbf6dbf353ec43f80,0xbf6dbf353ec43f80,0xbf7bbec43f0e3f80,0x3f7b3ec4bf0ebf80
.quad 0xbf35a5543f353f80,0xbf35a5543f353f80,0xbe483ec43f553f80,0x3e48bec4bf55bf80,0x3ec43f353f6d3f80,0x3ec43f353f6d3f80,0x3f553f6d3f7b3f80,0xbf55bf6dbf7bbf80
.quad 0xbf803f80bf803f80,0xbf803f80bf803f80,0xbe483ec4bf0e3f35,0x3e48bec43f0ebf35,0x3f6dbf353ec4248d,0x3f6dbf353ec4248d,0x3f0ebf6d3f7bbf35,0xbf0e3f6dbf7b3f35
.quad 0xbf35a5543f35bf80,0xbf35a5543f35bf80,0xbf553f6dbe48bf35,0x3f55bf6d3e483f35,0x3ec43f35bf6da554,0x3ec43f35bf6da554,0x3f7bbec4bf553f35,0xbf7b3ec43f55bf35
.quad 0x248dbf80a5543f80,0x248dbf80a5543f80,0xbf7bbec43f553f35,0x3f7b3ec4bf55bf35,0xbec43f353f6d248d,0xbec43f353f6d248d,0x3f553f6d3e48bf35,0xbf55bf6dbe483f35
.quad 0x3f35248dbf35bf80,0x3f35248dbf35bf80,0xbf0ebf6dbf7bbf35,0x3f0e3f6d3f7b3f35,0xbf6dbf35bec4a554,0xbf6dbf35bec4a554,0x3e483ec43f0e3f35,0xbe48bec4bf0ebf35
.quad 0xbf803f80bf803f80,0xbf803f80bf803f80,0x3f0ebec43e48248d,0xbf0e3ec4be48a554,0x3ec4bf353f6dbf80,0x3ec4bf353f6dbf80,0xbf7b3f6dbf0ea554,0x3f7bbf6d3f0e248d
.quad 0x3f35248dbf353f80,0x3f35248dbf353f80,0x3e48bf6d3f55248d,0xbe483f6dbf55a554,0xbf6d3f353ec4bf80,0xbf6d3f353ec4bf80,0x3f553ec4bf7ba554,0xbf55bec43f7b248d
.quad 0x248dbf80a5543f80,0x248dbf80a5543f80,0xbf553ec43f7b248d,0x3f55bec4bf7ba554,0x3f6d3f35bec4bf80,0x3f6d3f35bec4bf80,0xbe48bf6dbf55a554,0x3e483f6d3f55248d
.quad 0xbf35a5543f353f80,0xbf35a5543f353f80,0x3f7b3f6d3f0e248d,0xbf7bbf6dbf0ea554,0xbec4bf35bf6dbf80,0xbec4bf35bf6dbf80,0xbf0ebec4be48a554,0x3f0e3ec43e48248d
.quad 0xbf803f80bf803f80,0xbf803f80bf803f80,0x3f7bbf6d3f55bf35,0xbf7b3f6dbf553f35,0xbf6d3f35bec4a554,0xbf6d3f35bec4a554,0x3f55bec4be483f35,0xbf553ec43e48bf35
.quad 0xbf35a5543f35bf80,0xbf35a5543f35bf80,0x3f0e3ec4bf7b3f35,0xbf0ebec43f7bbf35,0xbec4bf353f6d248d,0xbec4bf353f6d248d,0x3e483f6dbf0ebf35,0xbe48bf6d3f0e3f35
.quad 0x248dbf80a5543f80,0x248dbf80a5543f80,0xbe483f6d3f0ebf35,0x3e48bf6dbf0e3f35,0x3ec4bf35bf6da554,0x3ec4bf35bf6da554,0xbf0e3ec43f7b3f35,0x3f0ebec4bf7bbf35
.quad 0x3f35248dbf35bf80,0x3f35248dbf35bf80,0xbf55bec43e483f35,0x3f553ec4be48bf35,0x3f6d3f353ec4248d,0x3f6d3f353ec4248d,0xbf7bbf6dbf55bf35,0x3f7b3f6d3f553f35
.quad 0xa50d0000a50d0000,0xa50d0000a50d0000,0x3f0ebec43e480000,0xbf0e3ec4be48a50d,0x3f6dbf353ec40000,0x3f6dbf353ec40000,0x3f7bbf6d3f0e0000,0xbf7b3f6dbf0ea50d
.quad 0x3f35bf803f350000,0x3f35bf803f350000,0x3e48bf6d3f550000,0xbe483f6dbf55a50d,0xbec4bf353f6d0000,0xbec4bf353f6d0000,0xbf55bec43f7b0000,0x3f553ec4bf7ba50d
.quad 0xbf80a50d3f800000,0xbf80a50d3f800000,0xbf553ec43f7b0000,0x3f55bec4bf7ba50d,0xbec43f353f6d0000,0xbec43f353f6d0000,0x3e483f6d3f550000,0xbe48bf6dbf55a50d
.quad 0x3f353f803f350000,0x3f353f803f350000,0x3f7b3f6d3f0e0000,0xbf7bbf6dbf0ea50d,0x3f6d3f353ec40000,0x3f6d3f353ec40000,0x3f0e3ec43e480000,0xbf0ebec4be48a50d
.quad 0xa50d0000a50d0000,0xa50d0000a50d0000,0x3f7bbf6d3f55bf35,0xbf7b3f6dbf553f35,0x3ec4bf353f6dbf80,0x3ec4bf353f6dbf80,0xbf553ec43e48bf35,0x3f55bec4be483f35
.quad 0xbf353f80bf35a50d,0xbf353f80bf35a50d,0x3f0e3ec4bf7b3f35,0xbf0ebec43f7bbf35,0x3f6dbf35bec43f80,0x3f6dbf35bec43f80,0xbe48bf6d3f0e3f35,0x3e483f6dbf0ebf35
.quad 0xbf80a50d3f800000,0xbf80a50d3f800000,0xbe483f6d3f0ebf35,0x3e48bf6dbf0e3f35,0x3f6d3f35bec4bf80,0x3f6d3f35bec4bf80,0x3f0ebec4bf7bbf35,0xbf0e3ec43f7b3f35
.quad 0xbf35bf80bf35a50d,0xbf35bf80bf35a50d,0xbf55bec43e483f35,0x3f553ec4be48bf35,0x3ec43f353f6d3f80,0x3ec43f353f6d3f80,0x3f7b3f6d3f553f35,0xbf7bbf6dbf55bf35
.quad 0xa50d0000a50d0000,0xa50d0000a50d0000,0x3f55bf6d3f7bbf80,0xbf553f6dbf7b3f80,0xbf6d3f35bec4a50d,0xbf6d3f35bec4a50d,0x3e483ec4bf553f80,0xbe48bec43f55bf80
.quad 0x3f35bf803f350000,0x3f35bf803f350000,0xbf7b3ec43f0ebf80,0x3f7bbec4bf0e3f80,0x3ec43f35bf6da50d,0x3ec43f35bf6da50d,0x3f0ebf6dbe483f80,0xbf0e3f6d3e48bf80
.quad 0xbf80a50d3f800000,0xbf80a50d3f800000,0x3f0e3f6dbe48bf80,0xbf0ebf6d3e483f80,0x3ec4bf35bf6da50d,0x3ec4bf35bf6da50d,0xbf7bbec43f0e3f80,0x3f7b3ec4bf0ebf80
.quad 0x3f353f803f350000,0x3f353f803f350000,0x3e48bec4bf55bf80,0xbe483ec43f553f80,0xbf6dbf35bec4a50d,0xbf6dbf35bec4a50d,0x3f553f6d3f7b3f80,0xbf55bf6dbf7bbf80
.quad 0xa50d0000a50d0000,0xa50d0000a50d0000,0x3e48bec43f0ebf35,0xbe483ec4bf0e3f35,0xbec43f35bf6d3f80,0xbec43f35bf6d3f80,0x3f0ebf6d3f7bbf35,0xbf0e3f6dbf7b3f35
.quad 0xbf353f80bf35a50d,0xbf353f80bf35a50d,0x3f55bf6d3e483f35,0xbf553f6dbe48bf35,0xbf6d3f353ec4bf80,0xbf6d3f353ec4bf80,0x3f7bbec4bf553f35,0xbf7b3ec43f55bf35
.quad 0xbf80a50d3f800000,0xbf80a50d3f800000,0x3f7b3ec4bf55bf35,0xbf7bbec43f553f35,0xbf6dbf353ec43f80,0xbf6dbf353ec43f80,0x3f553f6d3e48bf35,0xbf55bf6dbe483f35
.quad 0xbf35bf80bf35a50d,0xbf35bf80bf35a50d,0x3f0e3f6d3f7b3f35,0xbf0ebf6dbf7bbf35,0xbec4bf35bf6dbf80,0xbec4bf35bf6dbf80,0x3e483ec43f0e3f35,0xbe48bec4bf0ebf35
.quad 0x250d8000250d8000,0x250d8000250d8000,0xbf0e3ec4be488000,0x3f0ebec43e48250d,0xbf6d3f35bec48000,0xbf6d3f35bec48000,0xbf7b3f6dbf0e8000,0x3f7bbf6d3f0e250d
.quad 0xbf353f80bf358000,0xbf353f80bf358000,0xbe483f6dbf558000,0x3e48bf6d3f55250d,0x3ec43f35bf6d8000,0x3ec43f35bf6d8000,0x3f553ec4bf7b8000,0xbf55bec43f7b250d
.quad 0x3f80250dbf808000,0x3f80250dbf808000,0x3f55bec4bf7b8000,0xbf553ec43f7b250d,0x3ec4bf35bf6d8000,0x3ec4bf35bf6d8000,0xbe48bf6dbf558000,0x3e483f6d3f55250d
.quad 0xbf35bf80bf358000,0xbf35bf80bf358000,0xbf7bbf6dbf0e8000,0x3f7b3f6d3f0e250d,0xbf6dbf35bec48000,0xbf6dbf35bec48000,0xbf0ebec4be488000,0x3f0e3ec43e48250d
.quad 0x250d8000250d8000,0x250d8000250d8000,0xbf7b3f6dbf553f35,0x3f7bbf6d3f55bf35,0xbec43f35bf6d3f80,0xbec43f35bf6d3f80,0x3f55bec4be483f35,0xbf553ec43e48bf35
.quad 0x3f35bf803f35250d,0x3f35bf803f35250d,0xbf0ebec43f7bbf35,0x3f0e3ec4bf7b3f35,0xbf6d3f353ec4bf80,0xbf6d3f353ec4bf80,0x3e483f6dbf0ebf35,0xbe48bf6d3f0e3f35
.quad 0x3f80250dbf808000,0x3f80250dbf808000,0x3e48bf6dbf0e3f35,0xbe483f6d3f0ebf35,0xbf6dbf353ec43f80,0xbf6dbf353ec43f80,0xbf0e3ec43f7b3f35,0x3f0ebec4bf7bbf35
.quad 0x3f353f803f35250d,0x3f353f803f35250d,0x3f553ec4be48bf35,0xbf55bec43e483f35,0xbec4bf35bf6dbf80,0xbec4bf35bf6dbf80,0xbf7bbf6dbf55bf35,0x3f7b3f6d3f553f35
.quad 0x250d8000250d8000,0x250d8000250d8000,0xbf553f6dbf7b3f80,0x3f55bf6d3f7bbf80,0x3f6dbf353ec4250d,0x3f6dbf353ec4250d,0xbe48bec43f55bf80,0x3e483ec4bf553f80
.quad 0xbf353f80bf358000,0xbf353f80bf358000,0x3f7bbec4bf0e3f80,0xbf7b3ec43f0ebf80,0xbec4bf353f6d250d,0xbec4bf353f6d250d,0xbf0e3f6d3e48bf80,0x3f0ebf6dbe483f80
.quad 0x3f80250dbf808000,0x3f80250dbf808000,0xbf0ebf6d3e483f80,0x3f0e3f6dbe48bf80,0xbec43f353f6d250d,0xbec43f353f6d250d,0x3f7b3ec4bf0ebf80,0xbf7bbec43f0e3f80
.quad 0xbf35bf80bf358000,0xbf35bf80bf358000,0xbe483ec43f553f80,0x3e48bec4bf55bf80,0x3f6d3f353ec4250d,0x3f6d3f353ec4250d,0xbf55bf6dbf7bbf80,0x3f553f6d3f7b3f80
.quad 0x250d8000250d8000,0x250d8000250d8000,0xbe483ec4bf0e3f35,0x3e48bec43f0ebf35,0x3ec4bf353f6dbf80,0x3ec4bf353f6dbf80,0xbf0e3f6dbf7b3f35,0x3f0ebf6d3f7bbf35
.quad 0x3f35bf803f35250d,0x3f35bf803f35250d,0xbf553f6dbe48bf35,0x3f55bf6d3e483f35,0x3f6dbf35bec43f80,0x3f6dbf35bec43f80,0xbf7b3ec43f55bf35,0x3f7bbec4bf553f35
.quad 0x3f80250dbf808000,0x3f80250dbf808000,0xbf7bbec43f553f35,0x3f7b3ec4bf55bf35,0x3f6d3f35bec4bf80,0x3f6d3f35bec4bf80,0xbf55bf6dbe483f35,0x3f553f6d3e48bf35
.quad 0x3f353f803f35250d,0x3f353f803f35250d,0xbf0ebf6dbf7bbf35,0x3f0e3f6d3f7b3f35,0x3ec43f353f6d3f80,0x3ec43f353f6d3f80,0xbe48bec4bf0ebf35,0x3e483ec43f0e3f35
.quad 0x3f8000003f80,0x3f8000003f80,0xbe483f7b00003f80,0xbf0e3f55bec43f6d,0xbec43f6d00003f80,0xbf6d3ec4bf353f35,0xbf0e3f5500003f80,0xbf7bbe48bf6d3ec4
.quad 0xbf80248d00003f80,0x3f80a554a50dbf80,0xbf7bbe4800003f80,0x3f553f0e3ec4bf6d,0xbf6dbec400003f80,0x3ec43f6d3f35bf35,0xbf55bf0e00003f80,0xbe483f7b3f6dbec4
.quad 0xa50dbf8000003f80,0xa50dbf8000003f80,0x3e48bf7b00003f80,0x3f0ebf55bec43f6d,0x3ec4bf6d00003f80,0x3f6dbec4bf353f35,0x3f0ebf5500003f80,0x3f7b3e48bf6d3ec4
.quad 0x3f80a55400003f80,0xbf80248da50dbf80,0x3f7b3e4800003f80,0xbf55bf0e3ec4bf6d,0x3f6d3ec400003f80,0xbec4bf6d3f35bf35,0x3f553f0e00003f80,0x3e48bf7b3f6dbec4
.quad 0x3f8000003f80,0x3f8000003f80,0xbf553f0ebf353f35,0xbf7b3e48bf6d3ec4,0xbf6dbec4bf80248d,0xbec4bf6dbf35bf35,0xbe48bf7bbf35bf35,0x3f55bf0e3ec4bf6d
.quad 0xbf80248d00003f80,0x3f80a554a50dbf80,0xbf0ebf55bf353f35,0x3e483f7b3f6dbec4,0x3ec4bf6dbf80248d,0xbf6d3ec43f353f35,0x3f7bbe48bf35bf35,0xbf0ebf55bec43f6d
.quad 0xa50dbf8000003f80,0xa50dbf8000003f80,0x3f55bf0ebf353f35,0x3f7bbe48bf6d3ec4,0x3f6d3ec4bf80248d,0x3ec43f6dbf35bf35,0x3e483f7bbf35bf35,0xbf553f0e3ec4bf6d
.quad 0x3f80a55400003f80,0xbf80248da50dbf80,0x3f0e3f55bf353f35,0xbe48bf7b3f6dbec4,0xbec43f6dbf80248d,0x3f6dbec43f353f35,0xbf7b3e48bf35bf35,0x3f0e3f55bec43f6d
.quad 0x3f8000003f80,0x3f8000003f80,0xbf7bbe48bf80248d,0xbf55bf0ebf6dbec4,0x3ec4bf6da50dbf80,0x3f6dbec43f35bf35,0x3f553f0e3f80a554,0xbe483f7b3ec43f6d
.quad 0xbf80248d00003f80,0x3f80a554a50dbf80,0x3e48bf7bbf80248d,0xbf0e3f553f6d3ec4,0x3f6d3ec4a50dbf80,0xbec4bf6dbf353f35,0xbf0e3f553f80a554,0x3f7b3e48bec4bf6d
.quad 0xa50dbf8000003f80,0xa50dbf8000003f80,0x3f7b3e48bf80248d,0x3f553f0ebf6dbec4,0xbec43f6da50dbf80,0xbf6d3ec43f35bf35,0xbf55bf0e3f80a554,0x3e48bf7b3ec43f6d
.quad 0x3f80a55400003f80,0xbf80248da50dbf80,0xbe483f7bbf80248d,0x3f0ebf553f6d3ec4,0xbf6dbec4a50dbf80,0x3ec43f6dbf353f35,0x3f0ebf553f80a554,0xbf7bbe48bec4bf6d
.quad 0x3f8000003f80,0x3f8000003f80,0xbf0ebf55bf35bf35,0xbe48bf7bbec4bf6d,0x3f6d3ec43f80a554,0x3ec43f6d3f353f35,0xbf7b3e48bf353f35,0xbf0ebf55bf6dbec4
.quad 0xbf80248d00003f80,0x3f80a554a50dbf80,0x3f55bf0ebf35bf35,0xbf7b3e483ec43f6d,0xbec43f6d3f80a554,0x3f6dbec4bf35bf35,0xbe48bf7bbf353f35,0xbf553f0e3f6d3ec4
.quad 0xa50dbf8000003f80,0xa50dbf8000003f80,0x3f0e3f55bf35bf35,0x3e483f7bbec4bf6d,0xbf6dbec43f80a554,0xbec4bf6d3f353f35,0x3f7bbe48bf353f35,0x3f0e3f55bf6dbec4
.quad 0x3f80a55400003f80,0xbf80248da50dbf80,0xbf553f0ebf35bf35,0x3f7bbe483ec43f6d,0x3ec4bf6d3f80a554,0xbf6d3ec4bf35bf35,0x3e483f7bbf353f35,0x3f55bf0e3f6d3ec4
.quad 0x3f8080003f808000,0x3f8080003f808000,0x3f7b3e483f808000,0x3f553f0e3f6d3ec4,0x3f6d3ec43f808000,0x3ec43f6d3f353f35,0x3f553f0e3f808000,0xbe483f7b3ec43f6d
.quad 0x248d3f803f808000,0xa554bf80bf80250d,0xbe483f7b3f808000,0x3f0ebf55bf6dbec4,0xbec43f6d3f808000,0x3f6dbec4bf35bf35,0xbf0e3f553f808000,0x3f7b3e48bec4bf6d
.quad 0xbf80250d3f808000,0xbf80250d3f808000,0xbf7bbe483f808000,0xbf55bf0e3f6d3ec4,0xbf6dbec43f808000,0xbec4bf6d3f353f35,0xbf55bf0e3f808000,0x3e48bf7b3ec43f6d
.quad 0xa554bf803f808000,0x248d3f80bf80250d,0x3e48bf7b3f808000,0xbf0e3f55bf6dbec4,0x3ec4bf6d3f808000,0xbf6d3ec4bf35bf35,0x3f0ebf553f808000,0xbf7bbe48bec4bf6d
.quad 0x3f8080003f808000,0x3f8080003f808000,0x3f0e3f553f353f35,0x3e483f7b3ec43f6d,0xbec43f6d248d3f80,0xbf6d3ec4bf353f35,0xbf7b3e48bf353f35,0xbf0ebf55bf6dbec4
.quad 0x248d3f803f808000,0xa554bf80bf80250d,0xbf553f0e3f353f35,0x3f7bbe48bec4bf6d,0xbf6dbec4248d3f80,0x3ec43f6d3f35bf35,0xbe48bf7bbf353f35,0xbf553f0e3f6d3ec4
.quad 0xbf80250d3f808000,0xbf80250d3f808000,0xbf0ebf553f353f35,0xbe48bf7b3ec43f6d,0x3ec4bf6d248d3f80,0x3f6dbec4bf353f35,0x3f7bbe48bf353f35,0x3f0e3f55bf6dbec4
.quad 0xa554bf803f808000,0x248d3f80bf80250d,0x3f55bf0e3f353f35,0xbf7b3e48bec4bf6d,0x3f6d3ec4248d3f80,0xbec4bf6d3f35bf35,0x3e483f7bbf353f35,0x3f55bf0e3f6d3ec4
.quad 0x3f8080003f808000,0x3f8080003f808000,0xbe483f7b248d3f80,0xbf0e3f55bec43f6d,0xbf6dbec4bf80250d,0xbec4bf6dbf35bf35,0x3f0ebf55a554bf80,0x3f7b3e483f6dbec4
.quad 0x248d3f803f808000,0xa554bf80bf80250d,0xbf7bbe48248d3f80,0x3f553f0e3ec4bf6d,0x3ec4bf6dbf80250d,0xbf6d3ec43f353f35,0x3f553f0ea554bf80,0x3e48bf7bbf6d3ec4
.quad 0xbf80250d3f808000,0xbf80250d3f808000,0x3e48bf7b248d3f80,0x3f0ebf55bec43f6d,0x3f6d3ec4bf80250d,0x3ec43f6dbf35bf35,0xbf0e3f55a554bf80,0xbf7bbe483f6dbec4
.quad 0xa554bf803f808000,0x248d3f80bf80250d,0x3f7b3e48248d3f80,0xbf55bf0e3ec4bf6d,0xbec43f6dbf80250d,0x3f6dbec43f353f35,0xbf55bf0ea554bf80,0xbe483f7bbf6d3ec4
.quad 0x3f8080003f808000,0x3f8080003f808000,0xbf553f0ebf353f35,0xbf7b3e48bf6d3ec4,0x3ec4bf6da554bf80,0x3f6dbec43f35bf35,0x3e483f7b3f353f35,0xbf553f0ebec43f6d
.quad 0x248d3f803f808000,0xa554bf80bf80250d,0xbf0ebf55bf353f35,0x3e483f7b3f6dbec4,0x3f6d3ec4a554bf80,0xbec4bf6dbf353f35,0xbf7b3e483f353f35,0x3f0e3f553ec4bf6d
.quad 0xbf80250d3f808000,0xbf80250d3f808000,0x3f55bf0ebf353f35,0x3f7bbe48bf6d3ec4,0xbec43f6da554bf80,0xbf6d3ec43f35bf35,0xbe48bf7b3f353f35,0x3f55bf0ebec43f6d
.quad 0xa554bf803f808000,0x248d3f80bf80250d,0x3f0e3f55bf353f35,0xbe48bf7b3f6dbec4,0xbf6dbec4a554bf80,0x3ec43f6dbf353f35,0x3f7bbe483f353f35,0xbf0ebf553ec4bf6d
.quad 0xbf353f3500003f80,0xbf35bf35bf80248d,0xbf553f0e00003f80,0xbe48bf7bbf6dbec4,0xbf6d3ec400003f80,0x3ec4bf6dbf35bf35,0xbf7b3e4800003f80,0x3f55bf0ebec4bf6d
.quad 0xbf35bf3500003f80,0xbf353f353f80a554,0xbf0ebf5500003f80,0xbf7b3e483f6d3ec4,0xbec4bf6d00003f80,0xbf6dbec43f353f35,0xbe48bf7b00003f80,0xbf0ebf553ec43f6d
.quad 0x3f35bf3500003f80,0x3f353f35bf80248d,0x3f55bf0e00003f80,0x3e483f7bbf6dbec4,0x3f6dbec400003f80,0xbec43f6dbf35bf35,0x3f7bbe4800003f80,0xbf553f0ebec4bf6d
.quad 0x3f353f3500003f80,0x3f35bf353f80a554,0x3f0e3f5500003f80,0x3f7bbe483f6d3ec4,0x3ec43f6d00003f80,0x3f6d3ec43f353f35,0x3e483f7b00003f80,0x3f0e3f553ec43f6d
.quad 0x3f35bf35a50dbf80,0x3f353f353f80a554,0x3f7b3e483f35bf35,0xbf0e3f553ec43f6d,0x3ec43f6d3f80a554,0xbf6dbec4bf353f35,0xbf0e3f553f353f35,0x3e48bf7bbf6dbec4
.quad 0x3f353f35a50dbf80,0x3f35bf35bf80248d,0xbe483f7b3f35bf35,0x3f553f0ebec4bf6d,0xbf6d3ec43f80a554,0xbec43f6d3f35bf35,0xbf55bf0e3f353f35,0xbf7bbe483f6d3ec4
.quad 0xbf353f35a50dbf80,0xbf35bf353f80a554,0xbf7bbe483f35bf35,0x3f0ebf553ec43f6d,0xbec4bf6d3f80a554,0x3f6d3ec4bf353f35,0x3f0ebf553f353f35,0xbe483f7bbf6dbec4
.quad 0xbf35bf35a50dbf80,0xbf353f35bf80248d,0x3e48bf7b3f35bf35,0xbf55bf0ebec4bf6d,0x3f6dbec43f80a554,0x3ec4bf6d3f35bf35,0x3f553f0e3f353f35,0x3f7b3e483f6d3ec4
.quad 0xbf353f3500003f80,0xbf35bf35bf80248d,0xbf0ebf55bf80248d,0x3f7bbe483ec4bf6d,0x3f6dbec4a50dbf80,0xbec43f6d3f353f35,0x3e483f7b3f80a554,0xbf0ebf55bf6d3ec4
.quad 0xbf35bf3500003f80,0xbf353f353f80a554,0x3f55bf0ebf80248d,0xbe48bf7bbec43f6d,0x3ec43f6da50dbf80,0x3f6d3ec4bf35bf35,0xbf7b3e483f80a554,0xbf553f0e3f6dbec4
.quad 0x3f35bf3500003f80,0x3f353f35bf80248d,0x3f0e3f55bf80248d,0xbf7b3e483ec4bf6d,0xbf6d3ec4a50dbf80,0x3ec4bf6d3f353f35,0xbe48bf7b3f80a554,0x3f0e3f55bf6d3ec4
.quad 0x3f353f3500003f80,0x3f35bf353f80a554,0xbf553f0ebf80248d,0x3e483f7bbec43f6d,0xbec4bf6da50dbf80,0xbf6dbec4bf35bf35,0x3f7bbe483f80a554,0x3f55bf0e3f6dbec4
.quad 0x3f35bf35a50dbf80,0x3f353f353f80a554,0xbe483f7b3f353f35,0xbf55bf0ebf6d3ec4,0xbec4bf6dbf80248d,0x3f6d3ec43f35bf35,0x3f553f0e3f35bf35,0xbf7bbe48bec43f6d
.quad 0x3f353f35a50dbf80,0x3f35bf35bf80248d,0xbf7bbe483f353f35,0xbf0e3f553f6dbec4,0x3f6dbec4bf80248d,0x3ec4bf6dbf353f35,0xbf0e3f553f35bf35,0xbe483f7b3ec4bf6d
.quad 0xbf353f35a50dbf80,0xbf35bf353f80a554,0x3e48bf7b3f353f35,0x3f553f0ebf6d3ec4,0x3ec43f6dbf80248d,0xbf6dbec43f35bf35,0xbf55bf0e3f35bf35,0x3f7b3e48bec43f6d
.quad 0xbf35bf35a50dbf80,0xbf353f35bf80248d,0x3f7b3e483f353f35,0x3f0ebf553f6dbec4,0xbf6d3ec4bf80248d,0xbec43f6dbf353f35,0x3f0ebf553f35bf35,0x3e48bf7b3ec4bf6d
.quad 0x3f353f353f808000,0xbf353f35248d3f80,0x3f0e3f553f808000,0xbf7b3e48bec43f6d,0x3ec43f6d3f808000,0xbf6dbec4bf353f35,0x3e483f7b3f808000,0xbf0ebf55bf6d3ec4
.quad 0xbf353f353f808000,0x3f353f35a554bf80,0xbf553f0e3f808000,0x3e483f7b3ec4bf6d,0xbf6d3ec43f808000,0xbec43f6d3f35bf35,0xbf7b3e483f808000,0xbf553f0e3f6dbec4
.quad 0xbf35bf353f808000,0x3f35bf35248d3f80,0xbf0ebf553f808000,0x3f7bbe48bec43f6d,0xbec4bf6d3f808000,0x3f6d3ec4bf353f35,0xbe48bf7b3f808000,0x3f0e3f55bf6d3ec4
.quad 0x3f35bf353f808000,0xbf35bf35a554bf80,0x3f55bf0e3f808000,0xbe48bf7b3ec4bf6d,0x3f6dbec43f808000,0x3ec4bf6d3f35bf35,0x3f7bbe483f808000,0x3f55bf0e3f6dbec4
.quad 0xbf35bf35bf80250d,0x3f35bf35a554bf80,0x3e48bf7bbf35bf35,0x3f553f0e3f6dbec4,0x3f6dbec4a554bf80,0xbec43f6d3f353f35,0x3f553f0e3f35bf35,0xbf7bbe48bec43f6d
.quad 0x3f35bf35bf80250d,0xbf35bf35248d3f80,0x3f7b3e48bf35bf35,0x3f0ebf55bf6d3ec4,0x3ec43f6da554bf80,0x3f6d3ec4bf35bf35,0xbf0e3f553f35bf35,0xbe483f7b3ec4bf6d
.quad 0x3f353f35bf80250d,0xbf353f35a554bf80,0xbe483f7bbf35bf35,0xbf55bf0e3f6dbec4,0xbf6d3ec4a554bf80,0x3ec4bf6d3f353f35,0xbf55bf0e3f35bf35,0x3f7b3e48bec43f6d
.quad 0xbf353f35bf80250d,0x3f353f35248d3f80,0xbf7bbe48bf35bf35,0xbf0e3f55bf6d3ec4,0xbec4bf6da554bf80,0xbf6dbec4bf35bf35,0x3f0ebf553f35bf35,0x3e48bf7b3ec4bf6d
.quad 0x3f353f353f808000,0xbf353f35248d3f80,0xbf553f0e248d3f80,0xbe48bf7bbf6dbec4,0xbec4bf6dbf80250d,0x3f6d3ec43f35bf35,0x3f7bbe48a554bf80,0xbf553f0e3ec43f6d
.quad 0xbf353f353f808000,0x3f353f35a554bf80,0xbf0ebf55248d3f80,0xbf7b3e483f6d3ec4,0x3f6dbec4bf80250d,0x3ec4bf6dbf353f35,0x3e483f7ba554bf80,0x3f0e3f55bec4bf6d
.quad 0xbf35bf353f808000,0x3f35bf35248d3f80,0x3f55bf0e248d3f80,0x3e483f7bbf6dbec4,0x3ec43f6dbf80250d,0xbf6dbec43f35bf35,0xbf7b3e48a554bf80,0x3f55bf0e3ec43f6d
.quad 0x3f35bf353f808000,0xbf35bf35a554bf80,0x3f0e3f55248d3f80,0x3f7bbe483f6d3ec4,0xbf6d3ec4bf80250d,0xbec43f6dbf353f35,0xbe48bf7ba554bf80,0xbf0ebf55bec4bf6d
.quad 0xbf35bf35bf80250d,0x3f35bf35a554bf80,0x3f7b3e483f35bf35,0xbf0e3f553ec43f6d,0xbf6d3ec4248d3f80,0x3ec4bf6dbf35bf35,0x3f0ebf55bf35bf35,0xbe483f7b3f6d3ec4
.quad 0x3f35bf35bf80250d,0xbf35bf35248d3f80,0xbe483f7b3f35bf35,0x3f553f0ebec4bf6d,0xbec4bf6d248d3f80,0xbf6dbec43f353f35,0x3f553f0ebf35bf35,0x3f7b3e48bf6dbec4
.quad 0x3f353f35bf80250d,0xbf353f35a554bf80,0xbf7bbe483f35bf35,0x3f0ebf553ec43f6d,0x3f6dbec4248d3f80,0xbec43f6dbf35bf35,0xbf0e3f55bf35bf35,0x3e48bf7b3f6d3ec4
.quad 0xbf353f35bf80250d,0x3f353f35248d3f80,0x3e48bf7b3f35bf35,0xbf55bf0ebec4bf6d,0x3ec43f6d248d3f80,0x3f6d3ec43f353f35,0xbf55bf0ebf35bf35,0xbf7bbe48bf6dbec4
.quad 0x3f8000003f80,0x3f8000003f80,0x3e48bf7ba50dbf80,0x3f0ebf553ec4bf6d,0xbec43f6d00003f80,0xbf6d3ec4bf353f35,0x3f0ebf55a50dbf80,0x3f7b3e483f6dbec4
.quad 0xbf80248d00003f80,0x3f80a554a50dbf80,0x3f7b3e48a50dbf80,0xbf55bf0ebec43f6d,0xbf6dbec400003f80,0x3ec43f6d3f35bf35,0x3f553f0ea50dbf80,0x3e48bf7bbf6d3ec4
.quad 0xa50dbf8000003f80,0xa50dbf8000003f80,0xbe483f7ba50dbf80,0xbf0e3f553ec4bf6d,0x3ec4bf6d00003f80,0x3f6dbec4bf353f35,0xbf0e3f55a50dbf80,0xbf7bbe483f6dbec4
.quad 0x3f80a55400003f80,0xbf80248da50dbf80,0xbf7bbe48a50dbf80,0x3f553f0ebec43f6d,0x3f6d3ec400003f80,0xbec4bf6d3f35bf35,0xbf55bf0ea50dbf80,0xbe483f7bbf6d3ec4
.quad 0x3f8000003f80,0x3f8000003f80,0x3f55bf0e3f35bf35,0x3f7bbe483f6dbec4,0xbf6dbec4bf80248d,0xbec4bf6dbf35bf35,0x3e483f7b3f353f35,0xbf553f0ebec43f6d
.quad 0xbf80248d00003f80,0x3f80a554a50dbf80,0x3f0e3f553f35bf35,0xbe48bf7bbf6d3ec4,0x3ec4bf6dbf80248d,0xbf6d3ec43f353f35,0xbf7b3e483f353f35,0x3f0e3f553ec4bf6d
.quad 0xa50dbf8000003f80,0xa50dbf8000003f80,0xbf553f0e3f35bf35,0xbf7b3e483f6dbec4,0x3f6d3ec4bf80248d,0x3ec43f6dbf35bf35,0xbe48bf7b3f353f35,0x3f55bf0ebec43f6d
.quad 0x3f80a55400003f80,0xbf80248da50dbf80,0xbf0ebf553f35bf35,0x3e483f7bbf6d3ec4,0xbec43f6dbf80248d,0x3f6dbec43f353f35,0x3f7bbe483f353f35,0xbf0ebf553ec4bf6d
.quad 0x3f8000003f80,0x3f8000003f80,0x3f7b3e483f80a554,0x3f553f0e3f6d3ec4,0x3ec4bf6da50dbf80,0x3f6dbec43f35bf35,0xbf55bf0ebf80248d,0x3e48bf7bbec4bf6d
.quad 0xbf80248d00003f80,0x3f80a554a50dbf80,0xbe483f7b3f80a554,0x3f0ebf55bf6dbec4,0x3f6d3ec4a50dbf80,0xbec4bf6dbf353f35,0x3f0ebf55bf80248d,0xbf7bbe483ec43f6d
.quad 0xa50dbf8000003f80,0xa50dbf8000003f80,0xbf7bbe483f80a554,0xbf55bf0e3f6d3ec4,0xbec43f6da50dbf80,0xbf6d3ec43f35bf35,0x3f553f0ebf80248d,0xbe483f7bbec4bf6d
.quad 0x3f80a55400003f80,0xbf80248da50dbf80,0x3e48bf7b3f80a554,0xbf0e3f55bf6dbec4,0xbf6dbec4a50dbf80,0x3ec43f6dbf353f35,0xbf0e3f55bf80248d,0x3f7b3e483ec43f6d
.quad 0x3f8000003f80,0x3f8000003f80,0x3f0e3f553f353f35,0x3e483f7b3ec43f6d,0x3f6d3ec43f80a554,0x3ec43f6d3f353f35,0x3f7bbe483f35bf35,0x3f0e3f553f6d3ec4
.quad 0xbf80248d00003f80,0x3f80a554a50dbf80,0xbf553f0e3f353f35,0x3f7bbe48bec4bf6d,0xbec43f6d3f80a554,0x3f6dbec4bf35bf35,0x3e483f7b3f35bf35,0x3f55bf0ebf6dbec4
.quad 0xa50dbf8000003f80,0xa50dbf8000003f80,0xbf0ebf553f353f35,0xbe48bf7b3ec43f6d,0xbf6dbec43f80a554,0xbec4bf6d3f353f35,0xbf7b3e483f35bf35,0xbf0ebf553f6d3ec4
.quad 0x3f80a55400003f80,0xbf80248da50dbf80,0x3f55bf0e3f353f35,0xbf7b3e48bec4bf6d,0x3ec4bf6d3f80a554,0xbf6d3ec4bf35bf35,0xbe48bf7b3f35bf35,0xbf553f0ebf6dbec4
.quad 0x3f8080003f808000,0x3f8080003f808000,0xbf7bbe48bf80250d,0xbf55bf0ebf6dbec4,0x3f6d3ec43f808000,0x3ec43f6d3f353f35,0xbf55bf0ebf80250d,0x3e48bf7bbec4bf6d
.quad 0x248d3f803f808000,0xa554bf80bf80250d,0x3e48bf7bbf80250d,0xbf0e3f553f6d3ec4,0xbec43f6d3f808000,0x3f6dbec4bf35bf35,0x3f0ebf55bf80250d,0xbf7bbe483ec43f6d
.quad 0xbf80250d3f808000,0xbf80250d3f808000,0x3f7b3e48bf80250d,0x3f553f0ebf6dbec4,0xbf6dbec43f808000,0xbec4bf6d3f353f35,0x3f553f0ebf80250d,0xbe483f7bbec4bf6d
.quad 0xa554bf803f808000,0x248d3f80bf80250d,0xbe483f7bbf80250d,0x3f0ebf553f6d3ec4,0x3ec4bf6d3f808000,0xbf6d3ec4bf35bf35,0xbf0e3f55bf80250d,0x3f7b3e483ec43f6d
.quad 0x3f8080003f808000,0x3f8080003f808000,0xbf0ebf55bf35bf35,0xbe48bf7bbec4bf6d,0xbec43f6d248d3f80,0xbf6d3ec4bf353f35,0x3f7bbe483f35bf35,0x3f0e3f553f6d3ec4
.quad 0x248d3f803f808000,0xa554bf80bf80250d,0x3f55bf0ebf35bf35,0xbf7b3e483ec43f6d,0xbf6dbec4248d3f80,0x3ec43f6d3f35bf35,0x3e483f7b3f35bf35,0x3f55bf0ebf6dbec4
.quad 0xbf80250d3f808000,0xbf80250d3f808000,0x3f0e3f55bf35bf35,0x3e483f7bbec4bf6d,0x3ec4bf6d248d3f80,0x3f6dbec4bf353f35,0xbf7b3e483f35bf35,0xbf0ebf553f6d3ec4
.quad 0xa554bf803f808000,0x248d3f80bf80250d,0xbf553f0ebf35bf35,0x3f7bbe483ec43f6d,0x3f6d3ec4248d3f80,0xbec4bf6d3f35bf35,0xbe48bf7b3f35bf35,0xbf553f0ebf6dbec4
.quad 0x3f8080003f808000,0x3f8080003f808000,0x3e48bf7ba554bf80,0x3f0ebf553ec4bf6d,0xbf6dbec4bf80250d,0xbec4bf6dbf35bf35,0xbf0e3f55248d3f80,0xbf7bbe48bf6d3ec4
.quad 0x248d3f803f808000,0xa554bf80bf80250d,0x3f7b3e48a554bf80,0xbf55bf0ebec43f6d,0x3ec4bf6dbf80250d,0xbf6d3ec43f353f35,0xbf55bf0e248d3f80,0xbe483f7b3f6dbec4
.quad 0xbf80250d3f808000,0xbf80250d3f808000,0xbe483f7ba554bf80,0xbf0e3f553ec4bf6d,0x3f6d3ec4bf80250d,0x3ec43f6dbf35bf35,0x3f0ebf55248d3f80,0x3f7b3e48bf6d3ec4
.quad 0xa554bf803f808000,0x248d3f80bf80250d,0xbf7bbe48a554bf80,0x3f553f0ebec43f6d,0xbec43f6dbf80250d,0x3f6dbec43f353f35,0x3f553f0e248d3f80,0x3e48bf7b3f6dbec4
.quad 0x3f8080003f808000,0x3f8080003f808000,0x3f55bf0e3f35bf35,0x3f7bbe483f6dbec4,0x3ec4bf6da554bf80,0x3f6dbec43f35bf35,0xbe48bf7bbf35bf35,0x3f55bf0e3ec4bf6d
.quad 0x248d3f803f808000,0xa554bf80bf80250d,0x3f0e3f553f35bf35,0xbe48bf7bbf6d3ec4,0x3f6d3ec4a554bf80,0xbec4bf6dbf353f35,0x3f7bbe48bf35bf35,0xbf0ebf55bec43f6d
.quad 0xbf80250d3f808000,0xbf80250d3f808000,0xbf553f0e3f35bf35,0xbf7b3e483f6dbec4,0xbec43f6da554bf80,0xbf6d3ec43f35bf35,0x3e483f7bbf35bf35,0xbf553f0e3ec4bf6d
.quad 0xa554bf803f808000,0x248d3f80bf80250d,0xbf0ebf553f35bf35,0x3e483f7bbf6d3ec4,0xbf6dbec4a554bf80,0x3ec43f6dbf353f35,0xbf7b3e48bf35bf35,0x3f0e3f55bec43f6d
.quad 0xbf353f3500003f80,0xbf35bf35bf80248d,0x3f55bf0ea50dbf80,0x3e483f7b3f6d3ec4,0xbf6d3ec400003f80,0x3ec4bf6dbf35bf35,0x3f7bbe48a50dbf80,0xbf553f0e3ec43f6d
.quad 0xbf35bf3500003f80,0xbf353f353f80a554,0x3f0e3f55a50dbf80,0x3f7bbe48bf6dbec4,0xbec4bf6d00003f80,0xbf6dbec43f353f35,0x3e483f7ba50dbf80,0x3f0e3f55bec4bf6d
.quad 0x3f35bf3500003f80,0x3f353f35bf80248d,0xbf553f0ea50dbf80,0xbe48bf7b3f6d3ec4,0x3f6dbec400003f80,0xbec43f6dbf35bf35,0xbf7b3e48a50dbf80,0x3f55bf0e3ec43f6d
.quad 0x3f353f3500003f80,0x3f35bf353f80a554,0xbf0ebf55a50dbf80,0xbf7b3e48bf6dbec4,0x3ec43f6d00003f80,0x3f6d3ec43f353f35,0xbe48bf7ba50dbf80,0xbf0ebf55bec4bf6d
.quad 0x3f35bf35a50dbf80,0x3f353f353f80a554,0xbf7bbe48bf353f35,0x3f0ebf55bec4bf6d,0x3ec43f6d3f80a554,0xbf6dbec4bf353f35,0x3f0ebf55bf35bf35,0xbe483f7b3f6d3ec4
.quad 0x3f353f35a50dbf80,0x3f35bf35bf80248d,0x3e48bf7bbf353f35,0xbf55bf0e3ec43f6d,0xbf6d3ec43f80a554,0xbec43f6d3f35bf35,0x3f553f0ebf35bf35,0x3f7b3e48bf6dbec4
.quad 0xbf353f35a50dbf80,0xbf35bf353f80a554,0x3f7b3e48bf353f35,0xbf0e3f55bec4bf6d,0xbec4bf6d3f80a554,0x3f6d3ec4bf353f35,0xbf0e3f55bf35bf35,0x3e48bf7b3f6d3ec4
.quad 0xbf35bf35a50dbf80,0xbf353f35bf80248d,0xbe483f7bbf353f35,0x3f553f0e3ec43f6d,0x3f6dbec43f80a554,0x3ec4bf6d3f35bf35,0xbf55bf0ebf35bf35,0xbf7bbe48bf6dbec4
.quad 0xbf353f3500003f80,0xbf35bf35bf80248d,0x3f0e3f553f80a554,0xbf7b3e48bec43f6d,0x3f6dbec4a50dbf80,0xbec43f6d3f353f35,0xbe48bf7bbf80248d,0x3f0e3f553f6dbec4
.quad 0xbf35bf3500003f80,0xbf353f353f80a554,0xbf553f0e3f80a554,0x3e483f7b3ec4bf6d,0x3ec43f6da50dbf80,0x3f6d3ec4bf35bf35,0x3f7bbe48bf80248d,0x3f55bf0ebf6d3ec4
.quad 0x3f35bf3500003f80,0x3f353f35bf80248d,0xbf0ebf553f80a554,0x3f7bbe48bec43f6d,0xbf6d3ec4a50dbf80,0x3ec4bf6d3f353f35,0x3e483f7bbf80248d,0xbf0ebf553f6dbec4
.quad 0x3f353f3500003f80,0x3f35bf353f80a554,0x3f55bf0e3f80a554,0xbe48bf7b3ec4bf6d,0xbec4bf6da50dbf80,0xbf6dbec4bf35bf35,0xbf7b3e48bf80248d,0xbf553f0ebf6d3ec4
.quad 0x3f35bf35a50dbf80,0x3f353f353f80a554,0x3e48bf7bbf35bf35,0x3f553f0e3f6dbec4,0xbec4bf6dbf80248d,0x3f6d3ec43f35bf35,0xbf55bf0ebf353f35,0x3f7b3e483ec4bf6d
.quad 0x3f353f35a50dbf80,0x3f35bf35bf80248d,0x3f7b3e48bf35bf35,0x3f0ebf55bf6d3ec4,0x3f6dbec4bf80248d,0x3ec4bf6dbf353f35,0x3f0ebf55bf353f35,0x3e48bf7bbec43f6d
.quad 0xbf353f35a50dbf80,0xbf35bf353f80a554,0xbe483f7bbf35bf35,0xbf55bf0e3f6dbec4,0x3ec43f6dbf80248d,0xbf6dbec43f35bf35,0x3f553f0ebf353f35,0xbf7bbe483ec4bf6d
.quad 0xbf35bf35a50dbf80,0xbf353f35bf80248d,0xbf7bbe48bf35bf35,0xbf0e3f55bf6d3ec4,0xbf6d3ec4bf80248d,0xbec43f6dbf353f35,0xbf0e3f55bf353f35,0xbe483f7bbec43f6d
.quad 0x3f353f353f808000,0xbf353f35248d3f80,0xbf0ebf55bf80250d,0x3f7bbe483ec4bf6d,0x3ec43f6d3f808000,0xbf6dbec4bf353f35,0xbe48bf7bbf80250d,0x3f0e3f553f6dbec4
.quad 0xbf353f353f808000,0x3f353f35a554bf80,0x3f55bf0ebf80250d,0xbe48bf7bbec43f6d,0xbf6d3ec43f808000,0xbec43f6d3f35bf35,0x3f7bbe48bf80250d,0x3f55bf0ebf6d3ec4
.quad 0xbf35bf353f808000,0x3f35bf35248d3f80,0x3f0e3f55bf80250d,0xbf7b3e483ec4bf6d,0xbec4bf6d3f808000,0x3f6d3ec4bf353f35,0x3e483f7bbf80250d,0xbf0ebf553f6dbec4
.quad 0x3f35bf353f808000,0xbf35bf35a554bf80,0xbf553f0ebf80250d,0x3e483f7bbec43f6d,0x3f6dbec43f808000,0x3ec4bf6d3f35bf35,0xbf7b3e48bf80250d,0xbf553f0ebf6d3ec4
.quad 0xbf35bf35bf80250d,0x3f35bf35a554bf80,0xbe483f7b3f353f35,0xbf55bf0ebf6d3ec4,0x3f6dbec4a554bf80,0xbec43f6d3f353f35,0xbf55bf0ebf353f35,0x3f7b3e483ec4bf6d
.quad 0x3f35bf35bf80250d,0xbf35bf35248d3f80,0xbf7bbe483f353f35,0xbf0e3f553f6dbec4,0x3ec43f6da554bf80,0x3f6d3ec4bf35bf35,0x3f0ebf55bf353f35,0x3e48bf7bbec43f6d
.quad 0x3f353f35bf80250d,0xbf353f35a554bf80,0x3e48bf7b3f353f35,0x3f553f0ebf6d3ec4,0xbf6d3ec4a554bf80,0x3ec4bf6d3f353f35,0x3f553f0ebf353f35,0xbf7bbe483ec4bf6d
.quad 0xbf353f35bf80250d,0x3f353f35248d3f80,0x3f7b3e483f353f35,0x3f0ebf553f6dbec4,0xbec4bf6da554bf80,0xbf6dbec4bf35bf35,0xbf0e3f55bf353f35,0xbe483f7bbec43f6d
.quad 0x3f353f353f808000,0xbf353f35248d3f80,0x3f55bf0ea554bf80,0x3e483f7b3f6d3ec4,0xbec4bf6dbf80250d,0x3f6d3ec43f35bf35,0xbf7b3e48248d3f80,0x3f55bf0ebec4bf6d
.quad 0xbf353f353f808000,0x3f353f35a554bf80,0x3f0e3f55a554bf80,0x3f7bbe48bf6dbec4,0x3f6dbec4bf80250d,0x3ec4bf6dbf353f35,0xbe48bf7b248d3f80,0xbf0ebf553ec43f6d
.quad 0xbf35bf353f808000,0x3f35bf35248d3f80,0xbf553f0ea554bf80,0xbe48bf7b3f6d3ec4,0x3ec43f6dbf80250d,0xbf6dbec43f35bf35,0x3f7bbe48248d3f80,0xbf553f0ebec4bf6d
.quad 0x3f35bf353f808000,0xbf35bf35a554bf80,0xbf0ebf55a554bf80,0xbf7b3e48bf6dbec4,0xbf6d3ec4bf80250d,0xbec43f6dbf353f35,0x3e483f7b248d3f80,0x3f0e3f553ec43f6d
.quad 0xbf35bf35bf80250d,0x3f35bf35a554bf80,0xbf7bbe48bf353f35,0x3f0ebf55bec4bf6d,0xbf6d3ec4248d3f80,0x3ec4bf6dbf35bf35,0xbf0e3f553f353f35,0x3e48bf7bbf6dbec4
.quad 0x3f35bf35bf80250d,0xbf35bf35248d3f80,0x3e48bf7bbf353f35,0xbf55bf0e3ec43f6d,0xbec4bf6d248d3f80,0xbf6dbec43f353f35,0xbf55bf0e3f353f35,0xbf7bbe483f6d3ec4
.quad 0x3f353f35bf80250d,0xbf353f35a554bf80,0x3f7b3e48bf353f35,0xbf0e3f55bec4bf6d,0x3f6dbec4248d3f80,0xbec43f6dbf35bf35,0x3f0ebf553f353f35,0xbe483f7bbf6dbec4
.quad 0xbf353f35bf80250d,0x3f353f35248d3f80,0xbe483f7bbf353f35,0x3f553f0e3ec43f6d,0x3ec43f6d248d3f80,0x3f6d3ec43f353f35,0x3f553f0e3f353f35,0x3f7b3e483f6d3ec4
.quad 0x3500000035000000,0x3500000035000000,0x34fffb1135000000,0x34ffd39734ffec43,0x34ffec4335000000,0x34ff4e6d34ffb10f,0x34ffd39735000000,0x34fe70b034ff4e6d
.quad 0x34fec46d35000000,0x34f4fa0b34fb14be,0x34fe70b035000000,0x34f2135234f9c79d,0x34fe132435000000,0x34eed89e34f853f8,0x34fdabcc35000000,0x34eb4b0c34f6ba07
.quad 0x34fb14be35000000,0x34d4db3134ec835e,0x34fa730235000000,0x34cf7a1f34ea09a7,0x34f9c79d35000000,0x34c9d11234e76bd8,0x34f9129835000000,0x34c3e20034e4aa59
.quad 0x34f4fa0b35000000,0x34a2679934d4db31,0x34f40bdd35000000,0x349b02c634d14d3d,0x34f3144735000000,0x3493682a34cd9f02,0x34f2135235000000,0x348b9a6b34c9d112
.quad 0x3500000035000000,0x3500000035000000,0x34ff84ab34ffb10f,0x34ff0e5834ff4e6d,0x34fe132434fec46d,0x34fc3b2834fd3aac,0x34fbaccd34fd3aac,0x34f78bc534f9c79d
.quad 0x34e1c59834ec835e,0x34c5e40334d4db31,0x34d9f26a34e76bd8,0x34b73a2334c9d112,0x34d14d3d34e1c598,0x34a7365634bdaef9,0x34c7de6534db941a,0x3495f6d934b085bb
.quad 0x348e39da34b504f3,0x33c7c5c23443ef15,0x3480e7e434abeb4a,0x3361bc2e34209ae5,0x3466337534a26799,0x32490ab033f8cfcc,0x3449b95334987fc0,0xb2fb2b7433af10a2
.quad 0x3348bd363443ef15,0xb4715aeab3c7c5c2,0x3296c32c342c7cd4,0xb48b9a6bb4088e93,0xb2490ab03414a031,0xb49d7fd1b42c7cd4,0xb32fb68033f8cfcc,0xb4ae3bdeb44f7bca
.quad 0x3500000035000000,0x3500000035000000,0x34fe70b034fec46d,0x34fdabcc34fe1324,0x34f9c79d34fb14be,0x34f6ba0734f853f8,0x34f2135234f4fa0b,0x34eb4b0c34eed89e
.quad 0x34a2679934b504f3,0x34715aea348e39da,0x348b9a6b34a26799,0x343263ef34663375,0x34663375348e39da,0x33e05c13342c7cd4,0x343263ef34715aea,0x332fb68033e05c13
.quad 0xb3c7c5c21a0d3132,0xb48e39dab443ef15,0xb41aa086b348bd36,0xb4a99415b47c5d27,0xb44f7bcab3c7c5c2,0xb4c1d870b4987fc0,0xb480e7e4b414a031,0xb4d695e5b4b085bb
.quad 0xb4e1c598b4b504f3,0xb4fec46db4fb14be,0xb4edb293b4c5e403,0xb4f91298b4ff4e6d,0xb4f6ba07b4d4db31,0xb4eed89eb4ffb10f,0xb4fcbfc9b4e1c598,0xb4e04621b4fc3b28
.quad 0x3500000035000000,0x3500000035000000,0x34fcbfc934fd3aac,0x34fbaccd34fc3b28,0x34f3144734f4fa0b,0x34eed89e34f10908,0x34e33c5a34e76bd8,0x34d9f26a34debe05
.quad 0x3414a0313443ef15,0x3348bd3633c7c5c2,0x3389cf8633f8cfcc,0xb32fb68032490ab0,0xb2490ab03348bd36,0xb4088e93b3964083,0xb3bb6ecfb2c8fb30,0xb460924fb4209ae5
.quad 0xb4d4db31b4b504f3,0xb4fb14beb4ec835e,0xb4e8bf3cb4cd9f02,0xb4fffb11b4f9c79d,0xb4f6ba07b4e1c598,0xb4fc3b28b4ffb10f,0xb4fe70b0b4f10908,0xb4eff573b4fe1324
.quad 0xb4c5e403b4ec835e,0xb414a031b48e39da,0xb4a99415b4db941a,0xb361bc2eb44f7bca,0xb488f59bb4c5e403,0x3316a905b3f8cfcc,0xb449b953b4abeb4a,0x34027dc0b316a905
.quad 0x0,0x0,0x31c90e9000000000,0x3296c32c32490ab0,0x32490ab000000000,0x3316a90532c8fb30,0x3296c32c00000000,0x3361bc2e3316a905
.quad 0x3348bd3600000000,0x3414a03133c7c5c2,0x3361bc2e00000000,0x34268f1233e05c13,0x337ab27300000000,0x3438442a33f8cfcc,0x3389cf8600000000,0x3449b95334088e93
.quad 0x33c7c5c200000000,0x348e39da3443ef15,0x33d4150100000000,0x3495f6d9344f7bca,0x33e05c1300000000,0x349d7fd1345ae880,0x33ec9a7f00000000,0x34a4d22534663375
.quad 0x3414a03100000000,0x34c5e403348e39da,0x341aa08600000000,0x34cbbbf83493682a,0x34209ae500000000,0x34d14d3d34987fc0,0x34268f1200000000,0x34d695e5349d7fd1
.quad 0x0,0x0,0x32fb2b7432c8fb30,0x332fb6803316a905,0x337ab2733348bd36,0x33af10a233964083,0x33bb6ecf33964083,0x34027dc033e05c13
.quad 0x34715aea3443ef15,0x34a26799348e39da,0x34864b82345ae880,0x34b2c8c9349d7fd1,0x3493682a34715aea,0x34c1d87034abeb4a,0x349ff6cb34839c3d,0x34cf7a1f34b96842
.quad 0x34d4db3134b504f3,0x34fb14be34ec835e,0x34dd2d5334bdaef9,0x34fe70b034f31447,0x34e4aa5934c5e403,0x34ffec4334f853f8,0x34eb4b0c34cd9f02,0x34ff84ab34fc3b28
.quad 0x34fec46d34ec835e,0x34e1c59834fb14be,0x34ffd39734f10908,0x34d695e534f6ba07,0x34ffec4334f4fa0b,0x34c9d11234f10908,0x34ff0e5834f853f8,0x34bb8f3b34ea09a7
.quad 0x0,0x0,0x3361bc2e3348bd36,0x3389cf86337ab273,0x33e05c1333c7c5c2,0x34088e9333f8cfcc,0x34268f123414a031,0x3449b9533438442a
.quad 0x34c5e40334b504f3,0x34e1c59834d4db31,0x34d695e534c5e403,0x34eff57334e4aa59,0x34e4aa5934d4db31,0x34f9c79d34f10908,0x34eff57334e1c598,0x34ff0e5834f9c79d
.quad 0x34fb14be35000000,0x34d4db3134ec835e,0x34f40bdd34fec46d,0x34bfc76734debe05,0x34ea09a734fb14be,0x34a7365634cd9f02,0x34dd2d5334f4fa0b,0x348b9a6b34b96842
.quad 0x34715aea34b504f3,0xb348bd3633c7c5c2,0x343e1d4a34a26799,0xb3ec9a7f3316a905,0x34088e93348e39da,0xb438442ab2c8fb30,0x33a2abb634715aea,0xb476e0cbb3af10a2
.quad 0x0,0x0,0x33a2abb633964083,0x33bb6ecf33af10a2,0x34209ae53414a031,0x3438442a342c7cd4,0x346bcbbb345ae880,0x34864b82347c5d27
.quad 0x34f4fa0b34ec835e,0x34fec46d34fb14be,0x34fdabcc34f853f8,0x34ff0e5834ffec43,0x34ffec4334fec46d,0x34f6ba0734fd3aac,0x34fbaccd34ffb10f,0x34e60f8834f31447
.quad 0x348e39da34b504f3,0x33c7c5c23443ef15,0x3455364134987fc0,0x31c90e9033e05c13,0x34088e9334715aea,0xb3af10a232c8fb30,0x3361bc2e342c7cd4,0xb43263efb37ab273
.quad 0xb4a26799b443ef15,0xb4f4fa0bb4d4db31,0xb4bfc767b4839c3d,0xb4fe70b0b4ea09a7,0xb4d84853b4a26799,0xb4ff4e6db4f853f8,0xb4eb4b0cb4bdaef9,0xb4f78bc5b4ff4e6d
.quad 0x34ffb10f35000000,0x34fd3aac34fec46d,0x34ff84ab35000000,0x34fbaccd34fe1324,0x34ff4e6d35000000,0x34f9c79d34fd3aac,0x34ff0e5835000000,0x34f78bc534fc3b28
.quad 0x34fd3aac35000000,0x34e76bd834f4fa0b,0x34fcbfc935000000,0x34e33c5a34f31447,0x34fc3b2835000000,0x34debe0534f10908,0x34fbaccd35000000,0x34d9f26a34eed89e
.quad 0x34f853f835000000,0x34bdaef934e1c598,0x34f78bc535000000,0x34b73a2334debe05,0x34f6ba0735000000,0x34b085bb34db941a,0x34f5dec635000000,0x34a9941534d84853
.quad 0x34f1090835000000,0x34839c3d34c5e403,0x34eff57335000000,0x3476e0cb34c1d870,0x34eed89e35000000,0x3466337534bdaef9,0x34edb29335000000,0x3455364134b96842
.quad 0x34f853f834fb14be,0x34f1090834f4fa0b,0x34f40bdd34f853f8,0x34e8bf3c34eed89e,0x34eed89e34f4fa0b,0x34debe0534e76bd8,0x34e8bf3c34f10908,0x34d3184934debe05
.quad 0x34bdaef934d4db31,0x34839c3d34a26799,0x34b2c8c934cd9f02,0x3460924f3493682a,0x34a7365634c5e403,0x3438442a34839c3d,0x349b02c634bdaef9,0x340e9a2234663375
.quad 0x342c7cd4348e39da,0xb39640833348bd36,0x340e9a2234839c3d,0xb3ec9a7f32490ab0,0x33e05c1334715aea,0xb4209ae5b2c8fb30,0x33a2abb6345ae880,0xb449b953b37ab273
.quad 0xb396408333c7c5c2,0xb4bdaef9b4715aea,0xb3d4150133964083,0xb4cbbbf8b488f59b,0xb4088e933348bd36,0xb4d84853b4987fc0,0xb4268f1232c8fb30,0xb4e33c5ab4a73656
.quad 0x34e76bd834ec835e,0x34db941a34e1c598,0x34d9f26a34e1c598,0x34c7de6534d14d3d,0x34c9d11234d4db31,0x34b085bb34bdaef9,0x34b73a2334c5e403,0x3495f6d934a73656
.quad 0x33f8cfcc3443ef15,0xb2c8fb303348bd36,0x3389cf863414a031,0xb3bb6ecfb2490ab0,0x32490ab033c7c5c2,0xb4209ae5b3964083,0xb32fb6803348bd36,0xb460924fb4088e93
.quad 0xb4987fc0b443ef15,0xb4e76bd8b4c5e403,0xb4ae3bdeb4715aea,0xb4f40bddb4d84853,0xb4c1d870b48e39da,0xb4fc3b28b4e76bd8,0xb4d31849b4a26799,0xb4ffd397b4f31447
.quad 0xb4ffb10fb4ec835e,0xb4cd9f02b4f4fa0b,0xb4ff84abb4f4fa0b,0xb4b73a23b4ea09a7,0xb4fc3b28b4fb14be,0xb49d7fd1b4db941a,0xb4f5dec6b4fec46d,0xb480e7e4b4c9d112
.quad 0x34cd9f0234d4db31,0x34bdaef934c5e403,0x34b2c8c934bdaef9,0x349b02c634a73656,0x3493682a34a26799,0x3466337534839c3d,0x3460924f34839c3d,0x340e9a223438442a
.quad 0xb42c7cd4b3c7c5c2,0xb4987fc0b4715aea,0xb476e0cbb42c7cd4,0xb4bb8f3bb49d7fd1,0xb49d7fd1b4715aea,0xb4d84853b4bdaef9,0xb4bb8f3bb4987fc0,0xb4edb293b4d84853
.quad 0xb4ffb10fb4fb14be,0xb4db941ab4f4fa0b,0xb4fa7302b4ffb10f,0xb4bfc767b4e4aa59,0xb4eed89eb4fec46d,0xb49d7fd1b4cd9f02,0xb4dd2d53b4f853f8,0xb46bcbbbb4b085bb
.quad 0xb3f8cfccb48e39da,0x345ae8803348bd36,0xb32fb680b45ae880,0x3495f6d934088e93,0x3316a905b414a031,0x34b96842345ae880,0x33ec9a7fb3964083,0x34d695e53493682a
.quad 0x32c8fb3000000000,0x339640833348bd36,0x32fb2b7400000000,0x33bb6ecf337ab273,0x3316a90500000000,0x33e05c1333964083,0x332fb68000000000,0x34027dc033af10a2
.quad 0x3396408300000000,0x345ae8803414a031,0x33a2abb600000000,0x346bcbbb34209ae5,0x33af10a200000000,0x347c5d27342c7cd4,0x33bb6ecf00000000,0x34864b823438442a
.quad 0x33f8cfcc00000000,0x34abeb4a34715aea,0x34027dc000000000,0x34b2c8c9347c5d27,0x34088e9300000000,0x34b9684234839c3d,0x340e9a2200000000,0x34bfc7673488f59b
.quad 0x342c7cd400000000,0x34db941a34a26799,0x343263ef00000000,0x34e0462134a73656,0x3438442a00000000,0x34e4aa5934abeb4a,0x343e1d4a00000000,0x34e8bf3c34b085bb
.quad 0x33f8cfcc33c7c5c2,0x342c7cd43414a031,0x341aa08633f8cfcc,0x345536413438442a,0x3438442a3414a031,0x347c5d27345ae880,0x34553641342c7cd4,0x3490d3cd347c5d27
.quad 0x34abeb4a348e39da,0x34db941a34c5e403,0x34b73a2334987fc0,0x34e60f8834d14d3d,0x34c1d87034a26799,0x34eed89e34db941a,0x34cbbbf834abeb4a,0x34f5dec634e4aa59
.quad 0x34f1090834d4db31,0x34fd3aac34fec46d,0x34f5dec634db941a,0x34f9129834ffec43,0x34f9c79d34e1c598,0x34f3144734ffb10f,0x34fcbfc934e76bd8,0x34eb4b0c34fe1324
.quad 0x34fd3aac34fb14be,0x34abeb4a34e1c598,0x34fa730234fd3aac,0x349b02c634d84853,0x34f6ba0734fec46d,0x3488f59b34cd9f02,0x34f2135234ffb10f,0x346bcbbb34c1d870
.quad 0x345ae8803443ef15,0x34839c3d34715aea,0x34864b8234715aea,0x349ff6cb3493682a,0x349d7fd1348e39da,0x34b9684234abeb4a,0x34b2c8c934a26799,0x34cf7a1f34c1d870
.quad 0x34f853f834ec835e,0x34ffb10f34fec46d,0x34fdabcc34f4fa0b,0x34fbaccd34ffec43,0x34ffec4334fb14be,0x34f3144734fd3aac,0x34ff0e5834fec46d,0x34e60f8834f6ba07
.quad 0x34cd9f0234ec835e,0x345ae88034a26799,0x34bb8f3b34e1c598,0x341aa0863488f59b,0x34a7365634d4db31,0x33af10a2345ae880,0x3490d3cd34c5e403,0x3296c32c34209ae5
.quad 0x32c8fb303443ef15,0xb4987fc0b414a031,0xb2fb2b743414a031,0xb4b2c8c9b44f7bca,0xb3af10a233c7c5c2,0xb4c9d112b4839c3d,0xb40e9a223348bd36,0xb4dd2d53b49d7fd1
.quad 0x34987fc0348e39da,0x34abeb4a34a26799,0x34b73a2334abeb4a,0x34cbbbf834c1d870,0x34d14d3d34c5e403,0x34e4aa5934db941a,0x34e60f8834db941a,0x34f5dec634eed89e
.quad 0x34f1090834fb14be,0x34cd9f0234e1c598,0x34e0462134f10908,0x34ae3bde34c9d112,0x34c9d11234e1c598,0x3488f59b34abeb4a,0x34ae3bde34cd9f02,0x343e1d4a3488f59b
.quad 0xb2c8fb3033c7c5c2,0xb4839c3db414a031,0xb3d4150132c8fb30,0xb4a99415b4663375,0xb438442ab348bd36,0xb4c9d112b4987fc0,0xb480e7e4b3f8cfcc,0xb4e33c5ab4b96842
.quad 0xb4f853f8b4d4db31,0xb4e76bd8b4fec46d,0xb4ff0e58b4e76bd8,0xb4cf7a1fb4f6ba07,0xb4ff4e6db4f4fa0b,0xb4b085bbb4e76bd8,0xb4f91298b4fd3aac,0xb48b9a6bb4d14d3d
.quad 0x3f803f803f803f80,0x0,0x3ec43f353f6d3f80,0xbf6dbf35bec40000,0xbf35248d3f353f80,0xbf35bf80bf350000,0xbf6dbf353ec43f80,0x3ec4bf35bf6d0000
.quad 0xa554bf80248d3f80,0x3f80a50dbf800000,0x3f6dbf35bec43f80,0x3ec43f35bf6d0000,0x3f35a554bf353f80,0xbf353f80bf350000,0xbec43f35bf6d3f80,0xbf6d3f35bec40000
.quad 0xbf803f80bf803f80,0xa50d0000a50d0000,0xbec43f35bf6d3f80,0x3f6dbf353ec40000,0x3f35248dbf353f80,0x3f35bf803f350000,0x3f6dbf35bec43f80,0xbec4bf353f6d0000
.quad 0x248dbf80a5543f80,0xbf80a50d3f800000,0xbf6dbf353ec43f80,0xbec43f353f6d0000,0xbf35a5543f353f80,0x3f353f803f350000,0x3ec43f353f6d3f80,0x3f6d3f353ec40000
.quad 0x3f803f803f803f80,0x0,0xbf6dbf35bec4248d,0xbec4bf35bf6dbf80,0x3f35a554bf35bf80,0x3f353f803f35a50d,0xbec43f353f6da554,0xbf6dbf353ec43f80
.quad 0xa554bf80248d3f80,0x3f80a50dbf800000,0x3ec43f35bf6d248d,0xbf6d3f353ec4bf80,0xbf35248d3f35bf80,0x3f35bf803f35a50d,0x3f6dbf353ec4a554,0xbec43f35bf6d3f80
.quad 0xbf803f80bf803f80,0xa50d0000a50d0000,0x3f6dbf353ec4248d,0x3ec4bf353f6dbf80,0xbf35a5543f35bf80,0xbf353f80bf35a50d,0x3ec43f35bf6da554,0x3f6dbf35bec43f80
.quad 0x248dbf80a5543f80,0xbf80a50d3f800000,0xbec43f353f6d248d,0x3f6d3f35bec4bf80,0x3f35248dbf35bf80,0xbf35bf80bf35a50d,0xbf6dbf35bec4a554,0x3ec43f353f6d3f80
.quad 0x3f803f803f803f80,0x0,0xbec4bf35bf6dbf80,0x3f6d3f353ec4a50d,0xbf35248d3f353f80,0xbf35bf80bf350000,0x3f6d3f35bec4bf80,0xbec43f353f6da50d
.quad 0xa554bf80248d3f80,0x3f80a50dbf800000,0xbf6d3f353ec4bf80,0xbec4bf353f6da50d,0x3f35a554bf353f80,0xbf353f80bf350000,0x3ec4bf353f6dbf80,0x3f6dbf353ec4a50d
.quad 0xbf803f80bf803f80,0xa50d0000a50d0000,0x3ec4bf353f6dbf80,0xbf6d3f35bec4a50d,0x3f35248dbf353f80,0x3f35bf803f350000,0xbf6d3f353ec4bf80,0x3ec43f35bf6da50d
.quad 0x248dbf80a5543f80,0xbf80a50d3f800000,0x3f6d3f35bec4bf80,0x3ec4bf35bf6da50d,0xbf35a5543f353f80,0x3f353f803f350000,0xbec4bf35bf6dbf80,0xbf6dbf35bec4a50d
.quad 0x3f803f803f803f80,0x0,0x3f6d3f353ec4a554,0x3ec43f353f6d3f80,0x3f35a554bf35bf80,0x3f353f803f35a50d,0x3ec4bf35bf6d248d,0x3f6d3f35bec4bf80
.quad 0xa554bf80248d3f80,0x3f80a50dbf800000,0xbec4bf353f6da554,0x3f6dbf35bec43f80,0xbf35248d3f35bf80,0x3f35bf803f35a50d,0xbf6d3f35bec4248d,0x3ec4bf353f6dbf80
.quad 0xbf803f80bf803f80,0xa50d0000a50d0000,0xbf6d3f35bec4a554,0xbec43f35bf6d3f80,0xbf35a5543f35bf80,0xbf353f80bf35a50d,0xbec4bf353f6d248d,0xbf6d3f353ec4bf80
.quad 0x248dbf80a5543f80,0xbf80a50d3f800000,0x3ec4bf35bf6da554,0xbf6dbf353ec43f80,0x3f35248dbf35bf80,0xbf35bf80bf35a50d,0x3f6d3f353ec4248d,0xbec4bf35bf6dbf80
.quad 0x8000800080008000,0x3f803f803f803f80,0x3f6d3f353ec48000,0x3ec43f353f6d3f80,0x3f353f803f358000,0xbf35248d3f353f80,0xbec43f353f6d8000,0xbf6dbf353ec43f80
.quad 0xbf80250d3f808000,0xa554bf80248d3f80,0xbec4bf353f6d8000,0x3f6dbf35bec43f80,0x3f35bf803f358000,0x3f35a554bf353f80,0x3f6dbf353ec48000,0xbec43f35bf6d3f80
.quad 0x250d8000250d8000,0xbf803f80bf803f80,0xbf6d3f35bec48000,0xbec43f35bf6d3f80,0xbf353f80bf358000,0x3f35248dbf353f80,0x3ec43f35bf6d8000,0x3f6dbf35bec43f80
.quad 0x3f80250dbf808000,0x248dbf80a5543f80,0x3ec4bf35bf6d8000,0xbf6dbf353ec43f80,0xbf35bf80bf358000,0xbf35a5543f353f80,0xbf6dbf35bec48000,0x3ec43f353f6d3f80
.quad 0x8000800080008000,0x3f803f803f803f80,0x3ec43f353f6d3f80,0xbf6dbf35bec4248d,0xbf35bf80bf35250d,0x3f35a554bf35bf80,0x3f6d3f35bec4bf80,0xbec43f353f6da554
.quad 0xbf80250d3f808000,0xa554bf80248d3f80,0x3f6dbf35bec43f80,0x3ec43f35bf6d248d,0xbf353f80bf35250d,0xbf35248d3f35bf80,0x3ec4bf353f6dbf80,0x3f6dbf353ec4a554
.quad 0x250d8000250d8000,0xbf803f80bf803f80,0xbec43f35bf6d3f80,0x3f6dbf353ec4248d,0x3f35bf803f35250d,0xbf35a5543f35bf80,0xbf6d3f353ec4bf80,0x3ec43f35bf6da554
.quad 0x3f80250dbf808000,0x248dbf80a5543f80,0xbf6dbf353ec43f80,0xbec43f353f6d248d,0x3f353f803f35250d,0x3f35248dbf35bf80,0xbec4bf35bf6dbf80,0xbf6dbf35bec4a554
.quad 0x8000800080008000,0x3f803f803f803f80,0xbf6dbf35bec4250d,0xbec4bf35bf6dbf80,0x3f353f803f358000,0xbf35248d3f353f80,0x3ec4bf35bf6d250d,0x3f6d3f35bec4bf80
.quad 0xbf80250d3f808000,0xa554bf80248d3f80,0x3ec43f35bf6d250d,0xbf6d3f353ec4bf80,0x3f35bf803f358000,0x3f35a554bf353f80,0xbf6d3f35bec4250d,0x3ec4bf353f6dbf80
.quad 0x250d8000250d8000,0xbf803f80bf803f80,0x3f6dbf353ec4250d,0x3ec4bf353f6dbf80,0xbf353f80bf358000,0x3f35248dbf353f80,0xbec4bf353f6d250d,0xbf6d3f353ec4bf80
.quad 0x3f80250dbf808000,0x248dbf80a5543f80,0xbec43f353f6d250d,0x3f6d3f35bec4bf80,0xbf35bf80bf358000,0xbf35a5543f353f80,0x3f6d3f353ec4250d,0xbec4bf35bf6dbf80
.quad 0x8000800080008000,0x3f803f803f803f80,0xbec4bf35bf6dbf80,0x3f6d3f353ec4a554,0xbf35bf80bf35250d,0x3f35a554bf35bf80,0xbf6dbf353ec43f80,0x3ec4bf35bf6d248d
.quad 0xbf80250d3f808000,0xa554bf80248d3f80,0xbf6d3f353ec4bf80,0xbec4bf353f6da554,0xbf353f80bf35250d,0xbf35248d3f35bf80,0xbec43f35bf6d3f80,0xbf6d3f35bec4248d
.quad 0x250d8000250d8000,0xbf803f80bf803f80,0x3ec4bf353f6dbf80,0xbf6d3f35bec4a554,0x3f35bf803f35250d,0xbf35a5543f35bf80,0x3f6dbf35bec43f80,0xbec4bf353f6d248d
.quad 0x3f80250dbf808000,0x248dbf80a5543f80,0x3f6d3f35bec4bf80,0x3ec4bf35bf6da554,0x3f353f803f35250d,0x3f35248dbf35bf80,0x3ec43f353f6d3f80,0x3f6d3f353ec4248d
.quad 0x80003f8080003f80,0x80003f8080003f80,0x3e483f7b80003f80,0x3f0e3f553ec43f6d,0x3ec43f6d80003f80,0x3f6d3ec43f353f35,0x3f0e3f5580003f80,0x3f7bbe483f6d3ec4
.quad 0x3f353f3580003f80,0x3f35bf353f80248d,0x3f553f0e80003f80,0x3e48bf7b3f6dbec4,0x3f6d3ec480003f80,0xbec4bf6d3f35bf35,0x3f7b3e4880003f80,0xbf55bf0e3ec4bf6d
.quad 0x3f80248d80003f80,0xbf80a554250dbf80,0x3f7bbe4880003f80,0xbf553f0ebec4bf6d,0x3f6dbec480003f80,0xbec43f6dbf35bf35,0x3f55bf0e80003f80,0x3e483f7bbf6dbec4
.quad 0x3f35bf3580003f80,0x3f353f35bf80a554,0x3f0ebf5580003f80,0x3f7b3e48bf6d3ec4,0x3ec4bf6d80003f80,0x3f6dbec4bf353f35,0x3e48bf7b80003f80,0x3f0ebf55bec43f6d
.quad 0x80003f8080003f80,0x80003f8080003f80,0x3f553f0e3f353f35,0x3f7b3e483f6d3ec4,0x3f6dbec43f80248d,0x3ec4bf6d3f35bf35,0x3e48bf7b3f35bf35,0xbf55bf0ebec4bf6d
.quad 0xbf35bf35250dbf80,0xbf353f35bf80a554,0xbf7b3e48bf35bf35,0x3f0e3f55bec43f6d,0xbec43f6dbf80a554,0x3f6dbec43f353f35,0x3f0e3f55bf353f35,0xbe48bf7b3f6dbec4
.quad 0x3f80248d80003f80,0xbf80a554250dbf80,0x3f0ebf553f353f35,0xbe483f7bbf6dbec4,0xbec4bf6d3f80248d,0x3f6d3ec4bf353f35,0xbf7bbe483f35bf35,0x3f0ebf553ec43f6d
.quad 0xbf353f35250dbf80,0xbf35bf353f80248d,0x3e483f7bbf35bf35,0xbf553f0e3ec4bf6d,0x3f6d3ec4bf80a554,0x3ec43f6dbf35bf35,0x3f55bf0ebf353f35,0x3f7bbe48bf6d3ec4
.quad 0x80003f8080003f80,0x80003f8080003f80,0x3f7bbe483f80248d,0x3f55bf0e3f6dbec4,0xbec4bf6d250dbf80,0xbf6dbec4bf35bf35,0xbf553f0ebf80a554,0x3e483f7bbec43f6d
.quad 0x3f353f3580003f80,0x3f35bf353f80248d,0x3f0ebf553f80248d,0xbf7bbe48bec4bf6d,0xbf6dbec4250dbf80,0x3ec43f6dbf353f35,0xbe483f7bbf80a554,0x3f0ebf553f6d3ec4
.quad 0x3f80248d80003f80,0xbf80a554250dbf80,0xbe48bf7b3f80248d,0x3f0e3f55bf6d3ec4,0xbf6d3ec4250dbf80,0x3ec4bf6d3f353f35,0x3f0e3f55bf80a554,0xbf7b3e483ec4bf6d
.quad 0x3f35bf3580003f80,0x3f353f35bf80a554,0xbf55bf0e3f80248d,0x3e48bf7b3ec43f6d,0xbec43f6d250dbf80,0xbf6d3ec43f35bf35,0x3f7b3e48bf80a554,0x3f553f0ebf6dbec4
.quad 0x80003f8080003f80,0x80003f8080003f80,0x3f0ebf553f35bf35,0x3e48bf7b3ec4bf6d,0xbf6d3ec4bf80a554,0xbec43f6dbf353f35,0x3f7b3e483f353f35,0x3f0ebf553f6dbec4
.quad 0xbf35bf35250dbf80,0xbf353f35bf80a554,0x3e483f7bbf353f35,0x3f55bf0e3f6d3ec4,0x3ec4bf6d3f80248d,0xbf6d3ec4bf35bf35,0xbf553f0ebf35bf35,0x3f7bbe483ec43f6d
.quad 0x3f80248d80003f80,0xbf80a554250dbf80,0xbf55bf0e3f35bf35,0x3f7b3e48bec43f6d,0x3ec43f6dbf80a554,0xbf6dbec43f35bf35,0x3e48bf7b3f353f35,0x3f553f0ebf6d3ec4
.quad 0xbf353f35250dbf80,0xbf35bf353f80248d,0x3f7bbe48bf353f35,0x3f0e3f55bf6dbec4,0xbf6dbec43f80248d,0xbec4bf6d3f353f35,0x3f0e3f55bf35bf35,0x3e483f7bbec4bf6d
.quad 0x80003f8080003f80,0x80003f8080003f80,0xbe48bf7b250dbf80,0xbf0ebf55bec4bf6d,0x3ec43f6d80003f80,0x3f6d3ec43f353f35,0xbf0ebf55250dbf80,0xbf7b3e48bf6dbec4
.quad 0x3f353f3580003f80,0x3f35bf353f80248d,0xbf55bf0e250dbf80,0xbe483f7bbf6d3ec4,0x3f6d3ec480003f80,0xbec4bf6d3f35bf35,0xbf7bbe48250dbf80,0x3f553f0ebec43f6d
.quad 0x3f80248d80003f80,0xbf80a554250dbf80,0xbf7b3e48250dbf80,0x3f55bf0e3ec43f6d,0x3f6dbec480003f80,0xbec43f6dbf35bf35,0xbf553f0e250dbf80,0xbe48bf7b3f6d3ec4
.quad 0x3f35bf3580003f80,0x3f353f35bf80a554,0xbf0e3f55250dbf80,0xbf7bbe483f6dbec4,0x3ec4bf6d80003f80,0x3f6dbec4bf353f35,0xbe483f7b250dbf80,0xbf0e3f553ec4bf6d
.quad 0x80003f8080003f80,0x80003f8080003f80,0xbf55bf0ebf35bf35,0xbf7bbe48bf6dbec4,0x3f6dbec43f80248d,0x3ec4bf6d3f35bf35,0xbe483f7bbf353f35,0x3f553f0e3ec43f6d
.quad 0xbf35bf35250dbf80,0xbf353f35bf80a554,0x3f7bbe483f353f35,0xbf0ebf553ec4bf6d,0xbec43f6dbf80a554,0x3f6dbec43f353f35,0xbf0ebf553f35bf35,0x3e483f7bbf6d3ec4
.quad 0x3f80248d80003f80,0xbf80a554250dbf80,0xbf0e3f55bf35bf35,0x3e48bf7b3f6d3ec4,0xbec4bf6d3f80248d,0x3f6d3ec4bf353f35,0x3f7b3e48bf353f35,0xbf0e3f55bec4bf6d
.quad 0xbf353f35250dbf80,0xbf35bf353f80248d,0xbe48bf7b3f353f35,0x3f55bf0ebec43f6d,0x3f6d3ec4bf80a554,0x3ec43f6dbf35bf35,0xbf553f0e3f35bf35,0xbf7b3e483f6dbec4
.quad 0x80003f8080003f80,0x80003f8080003f80,0xbf7b3e48bf80a554,0xbf553f0ebf6d3ec4,0xbec4bf6d250dbf80,0xbf6dbec4bf35bf35,0x3f55bf0e3f80248d,0xbe48bf7b3ec4bf6d
.quad 0x3f353f3580003f80,0x3f35bf353f80248d,0xbf0e3f55bf80a554,0x3f7b3e483ec43f6d,0xbf6dbec4250dbf80,0x3ec43f6dbf353f35,0x3e48bf7b3f80248d,0xbf0e3f55bf6dbec4
.quad 0x3f80248d80003f80,0xbf80a554250dbf80,0x3e483f7bbf80a554,0xbf0ebf553f6dbec4,0xbf6d3ec4250dbf80,0x3ec4bf6d3f353f35,0xbf0ebf553f80248d,0x3f7bbe48bec43f6d
.quad 0x3f35bf3580003f80,0x3f353f35bf80a554,0x3f553f0ebf80a554,0xbe483f7bbec4bf6d,0xbec43f6d250dbf80,0xbf6d3ec43f35bf35,0xbf7bbe483f80248d,0xbf55bf0e3f6d3ec4
.quad 0x80003f8080003f80,0x80003f8080003f80,0xbf0e3f55bf353f35,0xbe483f7bbec43f6d,0xbf6d3ec4bf80a554,0xbec43f6dbf353f35,0xbf7bbe48bf35bf35,0xbf0e3f55bf6d3ec4
.quad 0xbf35bf35250dbf80,0xbf353f35bf80a554,0xbe48bf7b3f35bf35,0xbf553f0ebf6dbec4,0x3ec4bf6d3f80248d,0xbf6d3ec4bf35bf35,0x3f55bf0e3f353f35,0xbf7b3e48bec4bf6d
.quad 0x3f80248d80003f80,0xbf80a554250dbf80,0x3f553f0ebf353f35,0xbf7bbe483ec4bf6d,0x3ec43f6dbf80a554,0xbf6dbec43f35bf35,0xbe483f7bbf35bf35,0xbf55bf0e3f6dbec4
.quad 0xbf353f35250dbf80,0xbf35bf353f80248d,0xbf7b3e483f35bf35,0xbf0ebf553f6d3ec4,0xbf6dbec43f80248d,0xbec4bf6d3f353f35,0xbf0ebf553f353f35,0xbe48bf7b3ec43f6d
.quad 0xbf803f80bf803f80,0xbf803f80bf803f80,0x3f803f803f803f80,0x3f803f803f803f80,0xbf973f49bf803f80,0xbfb23e8dbfa73f0b,0x3f493f973f803f80,0x3e8d3fb23f0b3fa7
.quad 0xbfa73f0bbf803f80,0xbfa7bf0bbfb52500,0x3f0b3fa73f803f80,0xbf0b3fa725003fb5,0xbfb23e8dbf803f80,0xbf49bf97bfa7bf0b,0x3e8d3fb23f803f80,0xbf973f49bf0b3fa7
.quad 0xbfb52500bf803f80,0xa500bfb5bf80bf80,0x25003fb53f803f80,0xbfb52500bf803f80,0xbfb2be8dbf803f80,0x3f49bf97bf0bbfa7,0xbe8d3fb23f803f80,0xbf97bf49bfa73f0b
.quad 0xbfa7bf0bbf803f80,0x3fa7bf0ba500bfb5,0xbf0b3fa73f803f80,0xbf0bbfa7bfb52500,0xbf97bf49bf803f80,0x3fb23e8d3f0bbfa7,0xbf493f973f803f80,0x3e8dbfb2bfa7bf0b
.quad 0xbf803f80bf803f80,0xbf803f80bf803f80,0x3f803f803f803f80,0x3f803f803f803f80,0xbfb2be8dbfb52500,0xbf97bf49bfa7bf0b,0xbe8d3fb225003fb5,0xbf493f97bf0b3fa7
.quad 0xbf0bbfa7bf80bf80,0x3f0bbfa7a500bfb5,0xbfa73f0bbf803f80,0xbfa7bf0bbfb52500,0x3f49bf97a500bfb5,0x3fb23e8d3fa7bf0b,0xbf97bf49bfb52500,0x3e8dbfb2bf0bbfa7
.quad 0x3fb5a5803f80bf80,0x25c03fb53f803f80,0xa580bfb5bf80bf80,0x3fb5a5c03f80bf80,0x3f493f973fb5a580,0xbfb23e8dbf0b3fa7,0x3f97bf49a580bfb5,0x3e8d3fb23fa73f0b
.quad 0xbf0b3fa73f803f80,0xbf0bbfa7bfb52500,0x3fa73f0b3f80bf80,0xbfa73f0b25003fb5,0xbfb23e8d25c03fb5,0x3f97bf49bf0bbfa7,0x3e8d3fb23fb5a5c0,0xbf49bf97bfa73f0b
.quad 0xbf803f80bf803f80,0xbf803f80bf803f80,0x3f803f803f803f80,0x3f803f803f803f80,0xbf49bf97bf80bf80,0xbe8dbfb2bf0bbfa7,0xbf973f49bf803f80,0xbfb23e8dbfa73f0b
.quad 0x3fa7bf0b3f80bf80,0x3fa73f0b3fb5a580,0xbf0bbfa7bf80bf80,0x3f0bbfa7a580bfb5,0x3e8d3fb23f803f80,0xbf973f49bf0b3fa7,0x3fb2be8d3f80bf80,0x3f493f973fa73f0b
.quad 0xbfb52500bf803f80,0xa500bfb5bf80bf80,0x25003fb53f803f80,0xbfb52500bf803f80,0x3e8dbfb2bf80bf80,0x3f973f493fa7bf0b,0xbfb2be8dbf803f80,0x3f49bf97bf0bbfa7
.quad 0x3fa73f0b3f80bf80,0xbfa73f0b25c03fb5,0x3f0bbfa7bf80bf80,0x3f0b3fa73fb5a5c0,0xbf493f973f803f80,0x3e8dbfb2bfa7bf0b,0x3f973f493f80bf80,0xbfb2be8dbf0b3fa7
.quad 0xbf803f80bf803f80,0xbf803f80bf803f80,0x3f803f803f803f80,0x3f803f803f803f80,0x3e8dbfb2a500bfb5,0x3f49bf973f0bbfa7,0xbfb2be8dbfb52500,0xbf97bf49bfa7bf0b
.quad 0x3f0b3fa73f803f80,0xbf0b3fa725c03fb5,0x3fa7bf0b3f80bf80,0x3fa73f0b3fb5a5c0,0xbf97bf49bfb52500,0x3e8dbfb2bf0bbfa7,0xbf493f9725003fb5,0xbfb2be8dbfa73f0b
.quad 0x3fb5a5803f80bf80,0x25c03fb53f803f80,0xa580bfb5bf80bf80,0x3fb5a5c03f80bf80,0xbf973f4925c03fb5,0xbe8dbfb2bfa7bf0b,0x3f493f973fb5a5c0,0xbfb23e8dbf0b3fa7
.quad 0x3f0bbfa7bf80bf80,0x3f0b3fa73fb5a580,0xbfa7bf0bbf803f80,0x3fa7bf0ba580bfb5,0x3e8d3fb23fb5a580,0xbf49bf97bfa73f0b,0x3fb2be8da580bfb5,0xbf973f493f0b3fa7
.quad 0xbf803f80bf803f80,0xbf803f80bf803f80,0x3f803f803f803f80,0x3f803f803f803f80,0x3f97bf493f80bf80,0x3fb2be8d3fa7bf0b,0xbf49bf97bf80bf80,0xbe8dbfb2bf0bbfa7
.quad 0xbfa73f0bbf803f80,0xbfa7bf0bbfb52500,0x3f0b3fa73f803f80,0xbf0b3fa725003fb5,0x3fb2be8d3f80bf80,0x3f493f973fa73f0b,0xbe8dbfb2bf80bf80,0x3f97bf493f0bbfa7
.quad 0xbfb52500bf803f80,0xa500bfb5bf80bf80,0x25003fb53f803f80,0xbfb52500bf803f80,0x3fb23e8d3f80bf80,0xbf493f973f0b3fa7,0x3e8dbfb2bf80bf80,0x3f973f493fa7bf0b
.quad 0xbfa7bf0bbf803f80,0x3fa7bf0ba500bfb5,0xbf0b3fa73f803f80,0xbf0bbfa7bfb52500,0x3f973f493f80bf80,0xbfb2be8dbf0b3fa7,0x3f49bf97bf80bf80,0xbe8d3fb23fa73f0b
.quad 0xbf803f80bf803f80,0xbf803f80bf803f80,0x3f803f803f803f80,0x3f803f803f803f80,0x3fb23e8d3fb5a580,0x3f973f493fa73f0b,0x3e8dbfb2a580bfb5,0x3f49bf973f0bbfa7
.quad 0xbf0bbfa7bf80bf80,0x3f0bbfa7a500bfb5,0xbfa73f0bbf803f80,0xbfa7bf0bbfb52500,0xbf493f9725c03fb5,0xbfb2be8dbfa73f0b,0x3f973f493fb5a5c0,0xbe8d3fb23f0b3fa7
.quad 0x3fb5a5803f80bf80,0x25c03fb53f803f80,0xa580bfb5bf80bf80,0x3fb5a5c03f80bf80,0xbf49bf97bfb52500,0x3fb2be8d3f0bbfa7,0xbf973f4925003fb5,0xbe8dbfb2bfa7bf0b
.quad 0xbf0b3fa73f803f80,0xbf0bbfa7bfb52500,0x3fa73f0b3f80bf80,0xbfa73f0b25003fb5,0x3fb2be8da500bfb5,0xbf973f493f0b3fa7,0xbe8dbfb2bfb52500,0x3f493f973fa7bf0b
.quad 0xbf803f80bf803f80,0xbf803f80bf803f80,0x3f803f803f803f80,0x3f803f803f803f80,0x3f493f973f803f80,0x3e8d3fb23f0b3fa7,0x3f97bf493f80bf80,0x3fb2be8d3fa7bf0b
.quad 0x3fa7bf0b3f80bf80,0x3fa73f0b3fb5a580,0xbf0bbfa7bf80bf80,0x3f0bbfa7a580bfb5,0xbe8dbfb2bf80bf80,0x3f97bf493f0bbfa7,0xbfb23e8dbf803f80,0xbf49bf97bfa7bf0b
.quad 0xbfb52500bf803f80,0xa500bfb5bf80bf80,0x25003fb53f803f80,0xbfb52500bf803f80,0xbe8d3fb23f803f80,0xbf97bf49bfa73f0b,0x3fb23e8d3f80bf80,0xbf493f973f0b3fa7
.quad 0x3fa73f0b3f80bf80,0xbfa73f0b25c03fb5,0x3f0bbfa7bf80bf80,0x3f0b3fa73fb5a5c0,0x3f49bf97bf80bf80,0xbe8d3fb23fa73f0b,0xbf97bf49bf803f80,0x3fb23e8d3f0bbfa7
.quad 0xbf803f80bf803f80,0xbf803f80bf803f80,0x3f803f803f803f80,0x3f803f803f803f80,0xbe8d3fb225c03fb5,0xbf493f97bf0b3fa7,0x3fb23e8d3fb5a5c0,0x3f973f493fa73f0b
.quad 0x3f0b3fa73f803f80,0xbf0b3fa725c03fb5,0x3fa7bf0b3f80bf80,0x3fa73f0b3fb5a5c0,0x3f973f493fb5a580,0xbe8d3fb23f0b3fa7,0x3f49bf97a580bfb5,0x3fb23e8d3fa7bf0b
.quad 0x3fb5a5803f80bf80,0x25c03fb53f803f80,0xa580bfb5bf80bf80,0x3fb5a5c03f80bf80,0x3f97bf49a500bfb5,0x3e8d3fb23fa73f0b,0xbf49bf97bfb52500,0x3fb2be8d3f0bbfa7
.quad 0x3f0bbfa7bf80bf80,0x3f0b3fa73fb5a580,0xbfa7bf0bbf803f80,0x3fa7bf0ba580bfb5,0xbe8dbfb2bfb52500,0x3f493f973fa7bf0b,0xbfb23e8d25003fb5,0x3f97bf49bf0bbfa7
.quad 0x3f803f803f803f80,0x3f803f803f803f80,0x3f80bf803f80bf80,0x3f80bf803f80bf80,0x3f2b3fa03f663f8c,0x3e0e3fb43ed23fad,0x3fa0bf2b3f8cbf66,0x3fb4be0e3fadbed2
.quad 0x3e8d3fb23f493f97,0xbf493f97be8d3fb2,0x3fb2be8d3f97bf49,0x3f973f493fb23e8d,0xbe0e3fb43f2b3fa0,0xbfad3ed2bf663f8c,0x3fb43e0e3fa0bf2b,0x3ed23fad3f8c3f66
.quad 0xbf0b3fa73f0b3fa7,0xbfa7bf0bbfa73f0b,0x3fa73f0b3fa7bf0b,0xbf0b3fa73f0b3fa7,0xbf663f8c3ed23fad,0xbf2bbfa0bfb4be0e,0x3f8c3f663fadbed2,0xbfa03f2bbe0e3fb4
.quad 0xbf973f493e8d3fb2,0x3e8dbfb2bf97bf49,0x3f493f973fb2be8d,0xbfb2be8dbf493f97,0xbfad3ed23e0e3fb4,0x3f8cbf66bf2bbfa0,0x3ed23fad3fb4be0e,0xbf66bf8cbfa03f2b
.quad 0x3f803f803f803f80,0x3f803f803f803f80,0x3f80bf803f80bf80,0x3f80bf803f80bf80,0xbed23fadbe0e3fb4,0xbf663f8cbf2b3fa0,0x3fad3ed23fb43e0e,0x3f8c3f663fa03f2b
.quad 0xbfb23e8dbf973f49,0xbf97bf49bfb2be8d,0x3e8d3fb23f493f97,0xbf493f97be8d3fb2,0xbf66bf8cbfadbed2,0x3f2bbfa0be0ebfb4,0xbf8c3f66bed23fad,0xbfa0bf2bbfb43e0e
.quad 0x3f0bbfa7bf0bbfa7,0x3fa73f0b3fa7bf0b,0xbfa7bf0bbfa73f0b,0x3f0bbfa7bf0bbfa7,0x3fb4be0e3f2bbfa0,0xbed23fad3f663f8c,0xbe0ebfb4bfa0bf2b,0x3fad3ed23f8cbf66
.quad 0x3f493f973fb2be8d,0xbfb2be8dbf493f97,0x3f97bf49be8dbfb2,0xbe8d3fb23f973f49,0xbf2b3fa03f8c3f66,0x3e0ebfb4bfadbed2,0x3fa03f2b3f66bf8c,0xbfb4be0ebed23fad
.quad 0x3f803f803f803f80,0x3f803f803f803f80,0x3f80bf803f80bf80,0x3f80bf803f80bf80,0xbfa03f2bbf8c3f66,0xbfb43e0ebfad3ed2,0x3f2b3fa03f663f8c,0x3e0e3fb43ed23fad
.quad 0xbe8dbfb2bf49bf97,0x3f49bf973e8dbfb2,0xbfb23e8dbf973f49,0xbf97bf49bfb2be8d,0x3fb43e0e3fa0bf2b,0x3ed23fad3f8c3f66,0x3e0ebfb4bf2bbfa0,0x3fadbed23f66bf8c
.quad 0xbf0b3fa73f0b3fa7,0xbfa7bf0bbfa73f0b,0x3fa73f0b3fa7bf0b,0xbf0b3fa73f0b3fa7,0xbf8cbf66bfad3ed2,0x3fa0bf2b3e0ebfb4,0xbf663f8c3ed23fad,0xbf2bbfa0bfb4be0e
.quad 0x3f97bf49be8dbfb2,0xbe8d3fb23f973f49,0xbf49bf97bfb23e8d,0x3fb23e8d3f49bf97,0x3ed23fad3fb4be0e,0xbf66bf8cbfa03f2b,0x3fadbed2be0ebfb4,0xbf8c3f663f2b3fa0
.quad 0x3f803f803f803f80,0x3f803f803f803f80,0x3f80bf803f80bf80,0x3f80bf803f80bf80,0xbfadbed2bfb4be0e,0xbf8cbf66bfa0bf2b,0xbed23fadbe0e3fb4,0xbf663f8cbf2b3fa0
.quad 0x3fb2be8d3f97bf49,0x3f973f493fb23e8d,0xbe8dbfb2bf49bf97,0x3f49bf973e8dbfb2,0xbf8c3f66bed23fad,0xbfa0bf2bbfb43e0e,0x3f663f8c3fad3ed2,0xbf2b3fa03e0e3fb4
.quad 0x3f0bbfa7bf0bbfa7,0x3fa73f0b3fa7bf0b,0xbfa7bf0bbfa73f0b,0x3f0bbfa7bf0bbfa7,0x3e0e3fb43fa03f2b,0xbfadbed2bf8c3f66,0x3fb4be0e3f2bbfa0,0xbed23fad3f663f8c
.quad 0xbf49bf97bfb23e8d,0x3fb23e8d3f49bf97,0xbf973f493e8d3fb2,0x3e8dbfb2bf97bf49,0x3fa03f2b3f66bf8c,0xbfb4be0ebed23fad,0x3f2bbfa0bf8cbf66,0xbe0e3fb43fad3ed2
.quad 0x3f803f803f803f80,0x3f803f803f803f80,0x3f80bf803f80bf80,0x3f80bf803f80bf80,0xbf2bbfa0bf66bf8c,0xbe0ebfb4bed2bfad,0xbfa03f2bbf8c3f66,0xbfb43e0ebfad3ed2
.quad 0x3e8d3fb23f493f97,0xbf493f97be8d3fb2,0x3fb2be8d3f97bf49,0x3f973f493fb23e8d,0x3e0ebfb4bf2bbfa0,0x3fadbed23f66bf8c,0xbfb4be0ebfa03f2b,0xbed2bfadbf8cbf66
.quad 0xbf0b3fa73f0b3fa7,0xbfa7bf0bbfa73f0b,0x3fa73f0b3fa7bf0b,0xbf0b3fa73f0b3fa7,0x3f66bf8cbed2bfad,0x3f2b3fa03fb43e0e,0xbf8cbf66bfad3ed2,0x3fa0bf2b3e0ebfb4
.quad 0xbf973f493e8d3fb2,0x3e8dbfb2bf97bf49,0x3f493f973fb2be8d,0xbfb2be8dbf493f97,0x3fadbed2be0ebfb4,0xbf8c3f663f2b3fa0,0xbed2bfadbfb43e0e,0x3f663f8c3fa0bf2b
.quad 0x3f803f803f803f80,0x3f803f803f803f80,0x3f80bf803f80bf80,0x3f80bf803f80bf80,0x3ed2bfad3e0ebfb4,0x3f66bf8c3f2bbfa0,0xbfadbed2bfb4be0e,0xbf8cbf66bfa0bf2b
.quad 0xbfb23e8dbf973f49,0xbf97bf49bfb2be8d,0x3e8d3fb23f493f97,0xbf493f97be8d3fb2,0x3f663f8c3fad3ed2,0xbf2b3fa03e0e3fb4,0x3f8cbf663ed2bfad,0x3fa03f2b3fb4be0e
.quad 0x3f0bbfa7bf0bbfa7,0x3fa73f0b3fa7bf0b,0xbfa7bf0bbfa73f0b,0x3f0bbfa7bf0bbfa7,0xbfb43e0ebf2b3fa0,0x3ed2bfadbf66bf8c,0x3e0e3fb43fa03f2b,0xbfadbed2bf8c3f66
.quad 0x3f493f973fb2be8d,0xbfb2be8dbf493f97,0x3f97bf49be8dbfb2,0xbe8d3fb23f973f49,0x3f2bbfa0bf8cbf66,0xbe0e3fb43fad3ed2,0xbfa0bf2bbf663f8c,0x3fb43e0e3ed2bfad
.quad 0x3f803f803f803f80,0x3f803f803f803f80,0x3f80bf803f80bf80,0x3f80bf803f80bf80,0x3fa0bf2b3f8cbf66,0x3fb4be0e3fadbed2,0xbf2bbfa0bf66bf8c,0xbe0ebfb4bed2bfad
.quad 0xbe8dbfb2bf49bf97,0x3f49bf973e8dbfb2,0xbfb23e8dbf973f49,0xbf97bf49bfb2be8d,0xbfb4be0ebfa03f2b,0xbed2bfadbf8cbf66,0xbe0e3fb43f2b3fa0,0xbfad3ed2bf663f8c
.quad 0xbf0b3fa73f0b3fa7,0xbfa7bf0bbfa73f0b,0x3fa73f0b3fa7bf0b,0xbf0b3fa73f0b3fa7,0x3f8c3f663fadbed2,0xbfa03f2bbe0e3fb4,0x3f66bf8cbed2bfad,0x3f2b3fa03fb43e0e
.quad 0x3f97bf49be8dbfb2,0xbe8d3fb23f973f49,0xbf49bf97bfb23e8d,0x3fb23e8d3f49bf97,0xbed2bfadbfb43e0e,0x3f663f8c3fa0bf2b,0xbfad3ed23e0e3fb4,0x3f8cbf66bf2bbfa0
.quad 0x3f803f803f803f80,0x3f803f803f803f80,0x3f80bf803f80bf80,0x3f80bf803f80bf80,0x3fad3ed23fb43e0e,0x3f8c3f663fa03f2b,0x3ed2bfad3e0ebfb4,0x3f66bf8c3f2bbfa0
.quad 0x3fb2be8d3f97bf49,0x3f973f493fb23e8d,0xbe8dbfb2bf49bf97,0x3f49bf973e8dbfb2,0x3f8cbf663ed2bfad,0x3fa03f2b3fb4be0e,0xbf66bf8cbfadbed2,0x3f2bbfa0be0ebfb4
.quad 0x3f0bbfa7bf0bbfa7,0x3fa73f0b3fa7bf0b,0xbfa7bf0bbfa73f0b,0x3f0bbfa7bf0bbfa7,0xbe0ebfb4bfa0bf2b,0x3fad3ed23f8cbf66,0xbfb43e0ebf2b3fa0,0x3ed2bfadbf66bf8c
.quad 0xbf49bf97bfb23e8d,0x3fb23e8d3f49bf97,0xbf973f493e8d3fb2,0x3e8dbfb2bf97bf49,0xbfa0bf2bbf663f8c,0x3fb43e0e3ed2bfad,0xbf2b3fa03f8c3f66,0x3e0ebfb4bfadbed2
.quad 0x250dbf8080003f80,0x250dbf8080003f80,0xbe48bf7b80003f80,0xbf0ebf553ec43f6d,0xbec4bf6d80003f80,0xbf6dbec43f353f35,0xbf0ebf5580003f80,0xbf7b3e483f6d3ec4
.quad 0xbf35bf3580003f80,0xbf353f353f80248d,0xbf55bf0e80003f80,0xbe483f7b3f6dbec4,0xbf6dbec480003f80,0x3ec43f6d3f35bf35,0xbf7bbe4880003f80,0x3f553f0e3ec4bf6d
.quad 0xbf80a55480003f80,0x3f80248d250dbf80,0xbf7b3e4880003f80,0x3f55bf0ebec4bf6d,0xbf6d3ec480003f80,0x3ec4bf6dbf35bf35,0xbf553f0e80003f80,0xbe48bf7bbf6dbec4
.quad 0xbf353f3580003f80,0xbf35bf35bf80a554,0xbf0e3f5580003f80,0xbf7bbe48bf6d3ec4,0xbec43f6d80003f80,0xbf6d3ec4bf353f35,0xbe483f7b80003f80,0xbf0e3f55bec43f6d
.quad 0x250dbf8080003f80,0x250dbf8080003f80,0xbf55bf0e3f353f35,0xbf7bbe483f6d3ec4,0xbf6d3ec43f80248d,0xbec43f6d3f35bf35,0xbe483f7b3f35bf35,0x3f553f0ebec4bf6d
.quad 0x3f353f35250dbf80,0x3f35bf35bf80a554,0x3f7bbe48bf35bf35,0xbf0ebf55bec43f6d,0x3ec4bf6dbf80a554,0xbf6d3ec43f353f35,0xbf0ebf55bf353f35,0x3e483f7b3f6dbec4
.quad 0xbf80a55480003f80,0x3f80248d250dbf80,0xbf0e3f553f353f35,0x3e48bf7bbf6dbec4,0x3ec43f6d3f80248d,0xbf6dbec4bf353f35,0x3f7b3e483f35bf35,0xbf0e3f553ec43f6d
.quad 0x3f35bf35250dbf80,0x3f353f353f80248d,0xbe48bf7bbf35bf35,0x3f55bf0e3ec4bf6d,0xbf6dbec4bf80a554,0xbec4bf6dbf35bf35,0xbf553f0ebf353f35,0xbf7b3e48bf6d3ec4
.quad 0x250dbf8080003f80,0x250dbf8080003f80,0xbf7b3e483f80248d,0xbf553f0e3f6dbec4,0x3ec43f6d250dbf80,0x3f6d3ec4bf35bf35,0x3f55bf0ebf80a554,0xbe48bf7bbec43f6d
.quad 0xbf35bf3580003f80,0xbf353f353f80248d,0xbf0e3f553f80248d,0x3f7b3e48bec4bf6d,0x3f6d3ec4250dbf80,0xbec4bf6dbf353f35,0x3e48bf7bbf80a554,0xbf0e3f553f6d3ec4
.quad 0xbf80a55480003f80,0x3f80248d250dbf80,0x3e483f7b3f80248d,0xbf0ebf55bf6d3ec4,0x3f6dbec4250dbf80,0xbec43f6d3f353f35,0xbf0ebf55bf80a554,0x3f7bbe483ec4bf6d
.quad 0xbf353f3580003f80,0xbf35bf35bf80a554,0x3f553f0e3f80248d,0xbe483f7b3ec43f6d,0x3ec4bf6d250dbf80,0x3f6dbec43f35bf35,0xbf7bbe48bf80a554,0xbf55bf0ebf6dbec4
.quad 0x250dbf8080003f80,0x250dbf8080003f80,0xbf0e3f553f35bf35,0xbe483f7b3ec4bf6d,0x3f6dbec4bf80a554,0x3ec4bf6dbf353f35,0xbf7bbe483f353f35,0xbf0e3f553f6dbec4
.quad 0x3f353f35250dbf80,0x3f35bf35bf80a554,0xbe48bf7bbf353f35,0xbf553f0e3f6d3ec4,0xbec43f6d3f80248d,0x3f6dbec4bf35bf35,0x3f55bf0ebf35bf35,0xbf7b3e483ec43f6d
.quad 0xbf80a55480003f80,0x3f80248d250dbf80,0x3f553f0e3f35bf35,0xbf7bbe48bec43f6d,0xbec4bf6dbf80a554,0x3f6d3ec43f35bf35,0xbe483f7b3f353f35,0xbf55bf0ebf6d3ec4
.quad 0x3f35bf35250dbf80,0x3f353f353f80248d,0xbf7b3e48bf353f35,0xbf0ebf55bf6dbec4,0x3f6d3ec43f80248d,0x3ec43f6d3f353f35,0xbf0ebf55bf35bf35,0xbe48bf7bbec4bf6d
.quad 0x250dbf8080003f80,0x250dbf8080003f80,0x3e483f7b250dbf80,0x3f0e3f55bec4bf6d,0xbec4bf6d80003f80,0xbf6dbec43f353f35,0x3f0e3f55250dbf80,0x3f7bbe48bf6dbec4
.quad 0xbf35bf3580003f80,0xbf353f353f80248d,0x3f553f0e250dbf80,0x3e48bf7bbf6d3ec4,0xbf6dbec480003f80,0x3ec43f6d3f35bf35,0x3f7b3e48250dbf80,0xbf55bf0ebec43f6d
.quad 0xbf80a55480003f80,0x3f80248d250dbf80,0x3f7bbe48250dbf80,0xbf553f0e3ec43f6d,0xbf6d3ec480003f80,0x3ec4bf6dbf35bf35,0x3f55bf0e250dbf80,0x3e483f7b3f6d3ec4
.quad 0xbf353f3580003f80,0xbf35bf35bf80a554,0x3f0ebf55250dbf80,0x3f7b3e483f6dbec4,0xbec43f6d80003f80,0xbf6d3ec4bf353f35,0x3e48bf7b250dbf80,0x3f0ebf553ec4bf6d
.quad 0x250dbf8080003f80,0x250dbf8080003f80,0x3f553f0ebf35bf35,0x3f7b3e48bf6dbec4,0xbf6d3ec43f80248d,0xbec43f6d3f35bf35,0x3e48bf7bbf353f35,0xbf55bf0e3ec43f6d
.quad 0x3f353f35250dbf80,0x3f35bf35bf80a554,0xbf7b3e483f353f35,0x3f0e3f553ec4bf6d,0x3ec4bf6dbf80a554,0xbf6d3ec43f353f35,0x3f0e3f553f35bf35,0xbe48bf7bbf6d3ec4
.quad 0xbf80a55480003f80,0x3f80248d250dbf80,0x3f0ebf55bf35bf35,0xbe483f7b3f6d3ec4,0x3ec43f6d3f80248d,0xbf6dbec4bf353f35,0xbf7bbe48bf353f35,0x3f0ebf55bec4bf6d
.quad 0x3f35bf35250dbf80,0x3f353f353f80248d,0x3e483f7b3f353f35,0xbf553f0ebec43f6d,0xbf6dbec4bf80a554,0xbec4bf6dbf35bf35,0x3f55bf0e3f35bf35,0x3f7bbe483f6dbec4
.quad 0x250dbf8080003f80,0x250dbf8080003f80,0x3f7bbe48bf80a554,0x3f55bf0ebf6d3ec4,0x3ec43f6d250dbf80,0x3f6d3ec4bf35bf35,0xbf553f0e3f80248d,0x3e483f7b3ec4bf6d
.quad 0xbf35bf3580003f80,0xbf353f353f80248d,0x3f0ebf55bf80a554,0xbf7bbe483ec43f6d,0x3f6d3ec4250dbf80,0xbec4bf6dbf353f35,0xbe483f7b3f80248d,0x3f0ebf55bf6dbec4
.quad 0xbf80a55480003f80,0x3f80248d250dbf80,0xbe48bf7bbf80a554,0x3f0e3f553f6dbec4,0x3f6dbec4250dbf80,0xbec43f6d3f353f35,0x3f0e3f553f80248d,0xbf7b3e48bec43f6d
.quad 0xbf353f3580003f80,0xbf35bf35bf80a554,0xbf55bf0ebf80a554,0x3e48bf7bbec4bf6d,0x3ec4bf6d250dbf80,0x3f6dbec43f35bf35,0x3f7b3e483f80248d,0x3f553f0e3f6d3ec4
.quad 0x250dbf8080003f80,0x250dbf8080003f80,0x3f0ebf55bf353f35,0x3e48bf7bbec43f6d,0x3f6dbec4bf80a554,0x3ec4bf6dbf353f35,0x3f7b3e48bf35bf35,0x3f0ebf55bf6d3ec4
.quad 0x3f353f35250dbf80,0x3f35bf35bf80a554,0x3e483f7b3f35bf35,0x3f55bf0ebf6dbec4,0xbec43f6d3f80248d,0x3f6dbec4bf35bf35,0xbf553f0e3f353f35,0x3f7bbe48bec4bf6d
.quad 0xbf80a55480003f80,0x3f80248d250dbf80,0xbf55bf0ebf353f35,0x3f7b3e483ec4bf6d,0xbec4bf6dbf80a554,0x3f6d3ec43f35bf35,0x3e48bf7bbf35bf35,0x3f553f0e3f6dbec4
.quad 0x3f35bf35250dbf80,0x3f353f353f80248d,0x3f7bbe483f35bf35,0x3f0e3f553f6d3ec4,0x3f6d3ec43f80248d,0x3ec43f6d3f353f35,0x3f0e3f553f353f35,0x3e483f7b3ec43f6d
.quad 0xbf80bf80bf803f80,0x3f803f803f80bf80,0xbf803f803f803f80,0x3f80bf80bf80bf80,0xbf49bf97bf803f80,0x3e8d3fb23fa7bf0b,0xbf973f493f803f80,0x3fb2be8dbf0bbfa7
.quad 0xbf0bbfa7bf803f80,0xbf0b3fa73fb5a580,0xbfa73f0b3f803f80,0x3fa73f0ba580bfb5,0xbe8dbfb2bf803f80,0xbf973f493fa73f0b,0xbfb23e8d3f803f80,0x3f493f973f0bbfa7
.quad 0xa500bfb5bf803f80,0xbfb525003f803f80,0xbfb525003f803f80,0x25003fb53f80bf80,0x3e8dbfb2bf803f80,0xbf97bf493f0b3fa7,0xbfb2be8d3f803f80,0xbf493f973fa7bf0b
.quad 0x3f0bbfa7bf803f80,0xbf0bbfa725c03fb5,0xbfa7bf0b3f803f80,0xbfa73f0b3fb5a5c0,0x3f49bf97bf803f80,0x3e8dbfb2bf0b3fa7,0xbf97bf493f803f80,0xbfb2be8d3fa73f0b
.quad 0xbf80bf80bf803f80,0x3f803f803f80bf80,0xbf803f803f803f80,0x3f80bf80bf80bf80,0x3e8dbfb2bfb52500,0xbf493f973fa73f0b,0xbfb2be8d25003fb5,0x3f973f493f0bbfa7
.quad 0x3fa7bf0bbf80bf80,0xbfa7bf0b25c03fb5,0xbf0bbfa7bf803f80,0xbf0b3fa73fb5a5c0,0x3f973f49a500bfb5,0x3e8dbfb2bfa73f0b,0x3f49bf97bfb52500,0xbfb2be8d3f0b3fa7
.quad 0x25c03fb53f80bf80,0x3fb5a580bf80bf80,0x3fb5a5c0bf80bf80,0xa580bfb5bf803f80,0xbf973f493fb5a580,0x3e8d3fb23f0bbfa7,0x3f493f97a580bfb5,0x3fb2be8dbfa7bf0b
.quad 0xbfa7bf0b3f803f80,0xbfa73f0b3fb5a580,0xbf0b3fa73f80bf80,0x3f0b3fa7a580bfb5,0xbe8dbfb225c03fb5,0xbf49bf973f0b3fa7,0xbfb23e8d3fb5a5c0,0xbf973f493fa7bf0b
.quad 0xbf80bf80bf803f80,0x3f803f803f80bf80,0xbf803f803f803f80,0x3f80bf80bf80bf80,0x3f97bf49bf80bf80,0xbfb23e8d3f0b3fa7,0xbf49bf97bf803f80,0x3e8d3fb23fa7bf0b
.quad 0x3f0b3fa73f80bf80,0x3f0bbfa7bfb52500,0x3fa7bf0bbf80bf80,0xbfa7bf0b25003fb5,0xbfb23e8d3f803f80,0x3f493f973f0bbfa7,0x3e8d3fb23f80bf80,0x3f97bf49bfa7bf0b
.quad 0xa500bfb5bf803f80,0xbfb525003f803f80,0xbfb525003f803f80,0x25003fb53f80bf80,0x3fb23e8dbf80bf80,0x3f49bf97bfa73f0b,0x3e8dbfb2bf803f80,0xbf97bf493f0b3fa7
.quad 0xbf0b3fa73f80bf80,0x3f0b3fa7a500bfb5,0x3fa73f0bbf80bf80,0x3fa7bf0bbfb52500,0xbf97bf493f803f80,0xbfb2be8d3fa73f0b,0xbf493f973f80bf80,0xbe8d3fb23f0bbfa7
.quad 0xbf80bf80bf803f80,0x3f803f803f80bf80,0xbf803f803f803f80,0x3f80bf80bf80bf80,0x3fb23e8da500bfb5,0xbf97bf49bf0b3fa7,0x3e8dbfb2bfb52500,0xbf493f973fa73f0b
.quad 0xbfa73f0b3f803f80,0x3fa73f0ba500bfb5,0x3f0b3fa73f80bf80,0x3f0bbfa7bfb52500,0x3f49bf97bfb52500,0xbfb2be8d3f0b3fa7,0xbf97bf4925003fb5,0xbe8d3fb23fa7bf0b
.quad 0x25c03fb53f80bf80,0x3fb5a580bf80bf80,0x3fb5a5c0bf80bf80,0xa580bfb5bf803f80,0xbf49bf9725c03fb5,0xbfb23e8d3fa73f0b,0xbf973f493fb5a5c0,0x3e8d3fb23f0bbfa7
.quad 0x3fa73f0bbf80bf80,0x3fa7bf0bbfb52500,0x3f0bbfa7bf803f80,0xbf0bbfa725003fb5,0xbfb23e8d3fb5a580,0xbf973f493fa7bf0b,0x3e8d3fb2a580bfb5,0x3f493f97bf0bbfa7
.quad 0xbf80bf80bf803f80,0x3f803f803f80bf80,0xbf803f803f803f80,0x3f80bf80bf80bf80,0x3f493f973f80bf80,0xbe8dbfb2bfa73f0b,0x3f97bf49bf80bf80,0xbfb23e8d3f0b3fa7
.quad 0xbf0bbfa7bf803f80,0xbf0b3fa73fb5a580,0xbfa73f0b3f803f80,0x3fa73f0ba580bfb5,0x3e8d3fb23f80bf80,0x3f97bf49bfa7bf0b,0x3fb2be8dbf80bf80,0xbf49bf97bf0b3fa7
.quad 0xa500bfb5bf803f80,0xbfb525003f803f80,0xbfb525003f803f80,0x25003fb53f80bf80,0xbe8d3fb23f80bf80,0x3f973f49bf0bbfa7,0x3fb23e8dbf80bf80,0x3f49bf97bfa73f0b
.quad 0x3f0bbfa7bf803f80,0xbf0bbfa725c03fb5,0xbfa7bf0b3f803f80,0xbfa73f0b3fb5a5c0,0xbf493f973f80bf80,0xbe8d3fb23f0bbfa7,0x3f973f49bf80bf80,0x3fb23e8dbfa7bf0b
.quad 0xbf80bf80bf803f80,0x3f803f803f80bf80,0xbf803f803f803f80,0x3f80bf80bf80bf80,0xbe8d3fb23fb5a580,0x3f49bf97bfa7bf0b,0x3fb23e8da580bfb5,0xbf97bf49bf0b3fa7
.quad 0x3fa7bf0bbf80bf80,0xbfa7bf0b25c03fb5,0xbf0bbfa7bf803f80,0xbf0b3fa73fb5a5c0,0xbf97bf4925c03fb5,0xbe8d3fb23fa7bf0b,0xbf493f973fb5a5c0,0x3fb23e8dbf0bbfa7
.quad 0x25c03fb53f80bf80,0x3fb5a580bf80bf80,0x3fb5a5c0bf80bf80,0xa580bfb5bf803f80,0x3f97bf49bfb52500,0xbe8dbfb2bf0b3fa7,0xbf49bf9725003fb5,0xbfb23e8d3fa73f0b
.quad 0xbfa7bf0b3f803f80,0xbfa73f0b3fb5a580,0xbf0b3fa73f80bf80,0x3f0b3fa7a580bfb5,0x3e8d3fb2a500bfb5,0x3f493f97bf0bbfa7,0x3fb2be8dbfb52500,0x3f97bf49bfa73f0b
.quad 0xbf80bf80bf803f80,0x3f803f803f80bf80,0xbf803f803f803f80,0x3f80bf80bf80bf80,0xbf973f493f803f80,0x3fb2be8dbf0bbfa7,0x3f493f973f80bf80,0xbe8dbfb2bfa73f0b
.quad 0x3f0b3fa73f80bf80,0x3f0bbfa7bfb52500,0x3fa7bf0bbf80bf80,0xbfa7bf0b25003fb5,0x3fb2be8dbf80bf80,0xbf49bf97bf0b3fa7,0xbe8dbfb2bf803f80,0xbf973f493fa73f0b
.quad 0xa500bfb5bf803f80,0xbfb525003f803f80,0xbfb525003f803f80,0x25003fb53f80bf80,0xbfb2be8d3f803f80,0xbf493f973fa7bf0b,0xbe8d3fb23f80bf80,0x3f973f49bf0bbfa7
.quad 0xbf0b3fa73f80bf80,0x3f0b3fa7a500bfb5,0x3fa73f0bbf80bf80,0x3fa7bf0bbfb52500,0x3f973f49bf80bf80,0x3fb23e8dbfa7bf0b,0x3f49bf97bf803f80,0x3e8dbfb2bf0b3fa7
.quad 0xbf80bf80bf803f80,0x3f803f803f80bf80,0xbf803f803f803f80,0x3f80bf80bf80bf80,0xbfb2be8d25c03fb5,0x3f973f493f0bbfa7,0xbe8d3fb23fb5a5c0,0x3f49bf97bfa7bf0b
.quad 0xbfa73f0b3f803f80,0x3fa73f0ba500bfb5,0x3f0b3fa73f80bf80,0x3f0bbfa7bfb52500,0xbf493f973fb5a580,0x3fb23e8dbf0bbfa7,0x3f973f49a580bfb5,0x3e8dbfb2bfa73f0b
.quad 0x25c03fb53f80bf80,0x3fb5a580bf80bf80,0x3fb5a5c0bf80bf80,0xa580bfb5bf803f80,0x3f493f97a500bfb5,0x3fb2be8dbfa7bf0b,0x3f97bf49bfb52500,0xbe8dbfb2bf0b3fa7
.quad 0x3fa73f0bbf80bf80,0x3fa7bf0bbfb52500,0x3f0bbfa7bf803f80,0xbf0bbfa725003fb5,0x3fb2be8dbfb52500,0x3f97bf49bfa73f0b,0xbe8dbfb225003fb5,0xbf49bf973f0b3fa7
.quad 0xbfb5250025003fb5,0x3fb5a5c0a580bfb5,0x25003fb53fb5a500,0xa5c0bfb5bfb52580,0xbfadbed2be0e3fb4,0x3f8c3f663f2bbfa0,0xbed23fad3fb43e0e,0x3f66bf8cbfa0bf2b
.quad 0xbf97bf49be8d3fb2,0x3e8d3fb23f97bf49,0xbf493f973fb23e8d,0x3fb2be8dbf49bf97,0xbf66bf8cbed23fad,0xbf2b3fa03fb4be0e,0xbf8c3f663fad3ed2,0x3fa03f2bbe0ebfb4
.quad 0xbf0bbfa7bf0b3fa7,0xbfa73f0b3fa73f0b,0xbfa73f0b3fa73f0b,0x3f0b3fa73f0bbfa7,0xbe0ebfb4bf2b3fa0,0xbfadbed23f663f8c,0xbfb43e0e3fa03f2b,0xbed23fad3f8cbf66
.quad 0x3e8dbfb2bf493f97,0xbf49bf973e8d3fb2,0xbfb2be8d3f973f49,0xbf973f493fb2be8d,0x3f2bbfa0bf663f8c,0x3e0ebfb4bed23fad,0xbfa0bf2b3f8c3f66,0xbfb4be0e3fad3ed2
.quad 0xbfb5250025003fb5,0x3fb5a5c0a580bfb5,0x25003fb53fb5a500,0xa5c0bfb5bfb52580,0xbf2bbfa0bf8c3f66,0x3e0e3fb43fadbed2,0xbfa03f2b3f663f8c,0x3fb4be0ebed2bfad
.quad 0x3f49bf97bfb2be8d,0xbfb23e8d3f493f97,0xbf97bf49be8d3fb2,0x3e8d3fb23f97bf49,0x3fb43e0ebf2bbfa0,0xbed2bfadbf663f8c,0x3e0ebfb4bfa03f2b,0xbfad3ed23f8c3f66
.quad 0x3f0b3fa73f0bbfa7,0x3fa7bf0bbfa7bf0b,0x3fa7bf0bbfa7bf0b,0xbf0bbfa7bf0b3fa7,0xbf663f8c3fadbed2,0x3f2b3fa03e0ebfb4,0x3f8c3f66bed2bfad,0x3fa0bf2bbfb4be0e
.quad 0xbfb2be8d3f973f49,0xbf973f493fb2be8d,0xbe8d3fb23f49bf97,0x3f493f97be8dbfb2,0xbed2bfad3e0e3fb4,0xbf66bf8c3f2b3fa0,0xbfad3ed23fb4be0e,0xbf8c3f663fa0bf2b
.quad 0xbfb5250025003fb5,0x3fb5a5c0a580bfb5,0x25003fb53fb5a500,0xa5c0bfb5bfb52580,0x3ed2bfadbfb4be0e,0xbf663f8c3fa03f2b,0xbfadbed2be0e3fb4,0x3f8c3f663f2bbfa0
.quad 0x3f973f493e8dbfb2,0xbe8dbfb2bf973f49,0x3f49bf97bfb2be8d,0xbfb23e8d3f493f97,0xbf8c3f663fad3ed2,0x3fa03f2bbe0ebfb4,0x3f663f8c3ed2bfad,0x3f2bbfa0bfb43e0e
.quad 0xbf0bbfa7bf0b3fa7,0xbfa73f0b3fa73f0b,0xbfa73f0b3fa73f0b,0x3f0b3fa73f0bbfa7,0x3fb4be0ebfa0bf2b,0x3ed2bfadbf8c3f66,0xbe0ebfb4bf2b3fa0,0xbfadbed23f663f8c
.quad 0xbe8d3fb23f49bf97,0x3f493f97be8dbfb2,0x3fb23e8dbf97bf49,0x3f97bf49bfb23e8d,0xbfa0bf2b3f8c3f66,0xbfb4be0e3fad3ed2,0xbf2b3fa03f66bf8c,0xbe0e3fb43ed2bfad
.quad 0xbfb5250025003fb5,0x3fb5a5c0a580bfb5,0x25003fb53fb5a500,0xa5c0bfb5bfb52580,0x3fa0bf2bbf66bf8c,0xbfb43e0e3ed23fad,0xbf2bbfa0bf8c3f66,0x3e0e3fb43fadbed2
.quad 0xbf493f973fb23e8d,0x3fb2be8dbf49bf97,0x3f973f493e8dbfb2,0xbe8dbfb2bf973f49,0x3e0ebfb4bfa03f2b,0xbfad3ed23f8c3f66,0xbfb4be0e3f2b3fa0,0x3ed23fad3f66bf8c
.quad 0x3f0b3fa73f0bbfa7,0x3fa7bf0bbfa7bf0b,0x3fa7bf0bbfa7bf0b,0xbf0bbfa7bf0b3fa7,0xbf8cbf663ed23fad,0xbfa03f2b3fb43e0e,0xbf663f8c3fadbed2,0x3f2b3fa03e0ebfb4
.quad 0x3fb23e8dbf97bf49,0x3f97bf49bfb23e8d,0x3e8dbfb2bf493f97,0xbf49bf973e8d3fb2,0xbfad3ed23fb4be0e,0xbf8c3f663fa0bf2b,0x3ed23fadbe0ebfb4,0x3f663f8cbf2bbfa0
.quad 0xbfb5250025003fb5,0x3fb5a5c0a580bfb5,0x25003fb53fb5a500,0xa5c0bfb5bfb52580,0x3fad3ed23e0ebfb4,0xbf8cbf66bf2b3fa0,0x3ed2bfadbfb4be0e,0xbf663f8c3fa03f2b
.quad 0xbf97bf49be8d3fb2,0x3e8d3fb23f97bf49,0xbf493f973fb23e8d,0x3fb2be8dbf49bf97,0x3f663f8c3ed2bfad,0x3f2bbfa0bfb43e0e,0x3f8cbf66bfadbed2,0xbfa0bf2b3e0e3fb4
.quad 0xbf0bbfa7bf0b3fa7,0xbfa73f0b3fa73f0b,0xbfa73f0b3fa73f0b,0x3f0b3fa73f0bbfa7,0x3e0e3fb43f2bbfa0,0x3fad3ed2bf66bf8c,0x3fb4be0ebfa0bf2b,0x3ed2bfadbf8c3f66
.quad 0x3e8dbfb2bf493f97,0xbf49bf973e8d3fb2,0xbfb2be8d3f973f49,0xbf973f493fb2be8d,0xbf2b3fa03f66bf8c,0xbe0e3fb43ed2bfad,0x3fa03f2bbf8cbf66,0x3fb43e0ebfadbed2
.quad 0xbfb5250025003fb5,0x3fb5a5c0a580bfb5,0x25003fb53fb5a500,0xa5c0bfb5bfb52580,0x3f2b3fa03f8cbf66,0xbe0ebfb4bfad3ed2,0x3fa0bf2bbf66bf8c,0xbfb43e0e3ed23fad
.quad 0x3f49bf97bfb2be8d,0xbfb23e8d3f493f97,0xbf97bf49be8d3fb2,0x3e8d3fb23f97bf49,0xbfb4be0e3f2b3fa0,0x3ed23fad3f66bf8c,0xbe0e3fb43fa0bf2b,0x3fadbed2bf8cbf66
.quad 0x3f0b3fa73f0bbfa7,0x3fa7bf0bbfa7bf0b,0x3fa7bf0bbfa7bf0b,0xbf0bbfa7bf0b3fa7,0x3f66bf8cbfad3ed2,0xbf2bbfa0be0e3fb4,0xbf8cbf663ed23fad,0xbfa03f2b3fb43e0e
.quad 0xbfb2be8d3f973f49,0xbf973f493fb2be8d,0xbe8d3fb23f49bf97,0x3f493f97be8dbfb2,0x3ed23fadbe0ebfb4,0x3f663f8cbf2bbfa0,0x3fadbed2bfb43e0e,0x3f8cbf66bfa03f2b
.quad 0xbfb5250025003fb5,0x3fb5a5c0a580bfb5,0x25003fb53fb5a500,0xa5c0bfb5bfb52580,0xbed23fad3fb43e0e,0x3f66bf8cbfa0bf2b,0x3fad3ed23e0ebfb4,0xbf8cbf66bf2b3fa0
.quad 0x3f973f493e8dbfb2,0xbe8dbfb2bf973f49,0x3f49bf97bfb2be8d,0xbfb23e8d3f493f97,0x3f8cbf66bfadbed2,0xbfa0bf2b3e0e3fb4,0xbf66bf8cbed23fad,0xbf2b3fa03fb4be0e
.quad 0xbf0bbfa7bf0b3fa7,0xbfa73f0b3fa73f0b,0xbfa73f0b3fa73f0b,0x3f0b3fa73f0bbfa7,0xbfb43e0e3fa03f2b,0xbed23fad3f8cbf66,0x3e0e3fb43f2bbfa0,0x3fad3ed2bf66bf8c
.quad 0xbe8d3fb23f49bf97,0x3f493f97be8dbfb2,0x3fb23e8dbf97bf49,0x3f97bf49bfb23e8d,0x3fa03f2bbf8cbf66,0x3fb43e0ebfadbed2,0x3f2bbfa0bf663f8c,0x3e0ebfb4bed23fad
.quad 0xbfb5250025003fb5,0x3fb5a5c0a580bfb5,0x25003fb53fb5a500,0xa5c0bfb5bfb52580,0xbfa03f2b3f663f8c,0x3fb4be0ebed2bfad,0x3f2b3fa03f8cbf66,0xbe0ebfb4bfad3ed2
.quad 0xbf493f973fb23e8d,0x3fb2be8dbf49bf97,0x3f973f493e8dbfb2,0xbe8dbfb2bf973f49,0xbe0e3fb43fa0bf2b,0x3fadbed2bf8cbf66,0x3fb43e0ebf2bbfa0,0xbed2bfadbf663f8c
.quad 0x3f0b3fa73f0bbfa7,0x3fa7bf0bbfa7bf0b,0x3fa7bf0bbfa7bf0b,0xbf0bbfa7bf0b3fa7,0x3f8c3f66bed2bfad,0x3fa0bf2bbfb4be0e,0x3f66bf8cbfad3ed2,0xbf2bbfa0be0e3fb4
.quad 0x3fb23e8dbf97bf49,0x3f97bf49bfb23e8d,0x3e8dbfb2bf493f97,0xbf49bf973e8d3fb2,0x3fadbed2bfb43e0e,0x3f8cbf66bfa03f2b,0xbed2bfad3e0e3fb4,0xbf66bf8c3f2b3fa0
.quad 0x3dc93f7f80003f80,0x3e953f753e483f7b,0x3e953f7580003f80,0x3f463f223f0e3f55,0x3ef13f6280003f80,0x3f7f3dc93f553f0e,0x3f223f4680003f80,0x3f62bef13f7b3e48
.quad 0x3f463f2280003f80,0x3ef1bf623f7bbe48,0x3f623ef180003f80,0xbdc9bf7f3f55bf0e,0x3f753e9580003f80,0xbf22bf463f0ebf55,0x3f7f3dc980003f80,0xbf75be953e48bf7b
.quad 0x3f7fbdc980003f80,0xbf753e95be48bf7b,0x3f75be9580003f80,0xbf223f46bf0ebf55,0x3f62bef180003f80,0xbdc93f7fbf55bf0e,0x3f46bf2280003f80,0x3ef13f62bf7bbe48
.quad 0x3f22bf4680003f80,0x3f623ef1bf7b3e48,0x3ef1bf6280003f80,0x3f7fbdc9bf553f0e,0x3e95bf7580003f80,0x3f46bf22bf0e3f55,0x3dc9bf7f80003f80,0x3e95bf75be483f7b
.quad 0x3ef13f623ec43f6d,0x3f223f463f0e3f55,0x3f7f3dc93f6d3ec4,0x3f62bef13f7bbe48,0x3f22bf463f6dbec4,0xbe95bf753e48bf7b,0xbe95bf753ec4bf6d,0xbf7f3dc9bf55bf0e
.quad 0xbf75be95bec4bf6d,0xbdc93f7fbf553f0e,0xbf463f22bf6dbec4,0x3f753e953e483f7b,0x3dc93f7fbf6d3ec4,0x3ef1bf623f7b3e48,0x3f623ef1bec43f6d,0xbf46bf223f0ebf55
.quad 0x3f62bef13ec43f6d,0xbf463f22bf0ebf55,0x3dc9bf7f3f6d3ec4,0x3ef13f62bf7b3e48,0xbf46bf223f6dbec4,0x3f75be95be483f7b,0xbf753e953ec4bf6d,0xbdc9bf7f3f553f0e
.quad 0xbe953f75bec4bf6d,0xbf7fbdc93f55bf0e,0x3f223f46bf6dbec4,0xbe953f75be48bf7b,0x3f7fbdc9bf6d3ec4,0x3f623ef1bf7bbe48,0x3ef1bf62bec43f6d,0x3f22bf46bf0e3f55
.quad 0x3f463f223f353f35,0x3f623ef13f553f0e,0x3ef1bf623f35bf35,0xbdc9bf7f3e48bf7b,0xbf75be95bf35bf35,0xbf463f22bf7b3e48,0xbdc93f7fbf353f35,0x3f753e953f0e3f55
.quad 0x3f7fbdc93f353f35,0xbe95bf753f0ebf55,0xbe95bf753f35bf35,0xbf223f46bf7bbe48,0xbf623ef1bf35bf35,0x3f7f3dc93e483f7b,0x3f223f46bf353f35,0xbef1bf623f55bf0e
.quad 0x3f22bf463f353f35,0xbef13f62bf55bf0e,0xbf62bef13f35bf35,0x3f7fbdc9be483f7b,0xbe953f75bf35bf35,0xbf22bf463f7bbe48,0x3f7f3dc9bf353f35,0xbe953f75bf0ebf55
.quad 0xbdc9bf7f3f353f35,0x3f75be95bf0e3f55,0xbf753e953f35bf35,0xbf46bf223f7b3e48,0x3ef13f62bf35bf35,0xbdc93f7fbe48bf7b,0x3f46bf22bf353f35,0x3f62bef1bf553f0e
.quad 0x3f753e953f6d3ec4,0x3f7f3dc93f7b3e48,0xbf22bf46bec4bf6d,0xbf75be95bf55bf0e,0x3dc93f7fbec43f6d,0x3f623ef13f0e3f55,0x3ef1bf623f6dbec4,0xbf46bf22be48bf7b
.quad 0xbf623ef1bf6dbec4,0x3f223f46be483f7b,0x3f7f3dc93ec43f6d,0xbef1bf623f0ebf55,0xbf46bf223ec4bf6d,0x3e953f75bf553f0e,0x3e953f75bf6d3ec4,0xbdc9bf7f3f7bbe48
.quad 0x3e95bf753f6d3ec4,0xbdc93f7fbf7bbe48,0xbf463f22bec4bf6d,0x3e95bf753f553f0e,0x3f7fbdc9bec43f6d,0xbef13f62bf0ebf55,0xbf62bef13f6dbec4,0x3f22bf463e483f7b
.quad 0x3ef13f62bf6dbec4,0xbf463f223e48bf7b,0x3dc9bf7f3ec43f6d,0x3f62bef1bf0e3f55,0xbf223f463ec4bf6d,0xbf753e953f55bf0e,0x3f75be95bf6d3ec4,0x3f7fbdc9bf7b3e48
.quad 0x3f7fbdc93f80248d,0x3f75be953f7bbe48,0xbf753e95bf80a554,0xbf223f46bf553f0e,0x3f62bef13f80248d,0x3dc9bf7f3f0ebf55,0xbf463f22bf80a554,0x3ef13f62be483f7b
.quad 0x3f22bf463f80248d,0xbf62bef1be48bf7b,0xbef13f62bf80a554,0x3f7fbdc93f0e3f55,0x3e95bf753f80248d,0xbf463f22bf55bf0e,0xbdc93f7fbf80a554,0x3e95bf753f7b3e48
.quad 0xbdc9bf7f3f80248d,0x3e953f75bf7b3e48,0x3e953f75bf80a554,0xbf46bf223f55bf0e,0xbef1bf623f80248d,0x3f7f3dc9bf0e3f55,0x3f223f46bf80a554,0xbf623ef13e48bf7b
.quad 0xbf46bf223f80248d,0x3ef1bf623e483f7b,0x3f623ef1bf80a554,0x3dc93f7fbf0ebf55,0xbf75be953f80248d,0xbf22bf463f553f0e,0x3f7f3dc9bf80a554,0x3f753e95bf7bbe48
.quad 0x3f62bef13f6dbec4,0x3f46bf223f55bf0e,0xbdc93f7fbec43f6d,0x3ef13f623e483f7b,0xbf46bf22bec4bf6d,0xbf753e95bf7bbe48,0x3f75be953f6d3ec4,0xbdc9bf7f3f0ebf55
.quad 0xbe953f75bf6d3ec4,0x3f7f3dc93f0e3f55,0xbf22bf463ec4bf6d,0xbe953f75bf7b3e48,0x3f7fbdc93ec43f6d,0xbf62bef13e48bf7b,0xbef13f62bf6dbec4,0x3f22bf463f553f0e
.quad 0xbef1bf623f6dbec4,0x3f223f46bf553f0e,0x3f7f3dc9bec43f6d,0xbf623ef1be48bf7b,0xbf223f46bec4bf6d,0xbe95bf753f7b3e48,0xbe95bf753f6d3ec4,0x3f7fbdc9bf0e3f55
.quad 0x3f753e95bf6d3ec4,0xbdc93f7fbf0ebf55,0xbf463f223ec4bf6d,0xbf75be953f7bbe48,0xbdc9bf7f3ec43f6d,0x3ef1bf62be483f7b,0x3f623ef1bf6dbec4,0x3f463f22bf55bf0e
.quad 0x3f22bf463f35bf35,0x3ef1bf623f0ebf55,0x3f623ef13f353f35,0x3f7fbdc93f7b3e48,0xbe953f75bf353f35,0x3f223f463e483f7b,0xbf7fbdc9bf35bf35,0xbe953f75bf553f0e
.quad 0xbdc9bf7f3f35bf35,0xbf753e95bf55bf0e,0x3f75be953f353f35,0xbf46bf223e48bf7b,0x3ef13f62bf353f35,0x3dc9bf7f3f7bbe48,0xbf463f22bf35bf35,0x3f62bef13f0e3f55
.quad 0xbf46bf223f35bf35,0x3f623ef1bf0e3f55,0x3ef1bf623f353f35,0x3dc93f7fbf7bbe48,0x3f753e95bf353f35,0xbf463f22be48bf7b,0xbdc93f7fbf35bf35,0xbf75be953f55bf0e
.quad 0xbf7f3dc93f35bf35,0xbe95bf753f553f0e,0xbe95bf753f353f35,0x3f22bf46be483f7b,0x3f62bef1bf353f35,0x3f7f3dc9bf7b3e48,0x3f223f46bf35bf35,0x3ef13f62bf0ebf55
.quad 0x3e95bf753ec4bf6d,0x3dc9bf7f3e48bf7b,0x3f46bf223f6dbec4,0x3e95bf753f0ebf55,0x3f7fbdc93f6d3ec4,0x3ef1bf623f55bf0e,0x3f623ef13ec43f6d,0x3f22bf463f7bbe48
.quad 0x3ef13f62bec43f6d,0x3f46bf223f7b3e48,0xbdc93f7fbf6d3ec4,0x3f62bef13f553f0e,0xbf223f46bf6dbec4,0x3f75be953f0e3f55,0xbf753e95bec4bf6d,0x3f7fbdc93e483f7b
.quad 0xbf75be953ec4bf6d,0x3f7f3dc9be483f7b,0xbf22bf463f6dbec4,0x3f753e95bf0e3f55,0xbdc9bf7f3f6d3ec4,0x3f623ef1bf553f0e,0x3ef1bf623ec43f6d,0x3f463f22bf7b3e48
.quad 0x3f62bef1bec43f6d,0x3f223f46bf7bbe48,0x3f7f3dc9bf6d3ec4,0x3ef13f62bf55bf0e,0x3f463f22bf6dbec4,0x3e953f75bf0ebf55,0x3e953f75bec4bf6d,0x3dc93f7fbe48bf7b
.quad 0x3f80bf80bf803f80,0x3f80bf80bf803f80,0xbf80bf803f803f80,0xbf80bf803f803f80,0x3f97bf49bf803f80,0x3fb2be8dbfa73f0b,0xbf49bf973f803f80,0xbe8dbfb23f0b3fa7
.quad 0x3fa7bf0bbf803f80,0x3fa73f0bbfb52500,0xbf0bbfa73f803f80,0x3f0bbfa725003fb5,0x3fb2be8dbf803f80,0x3f493f97bfa7bf0b,0xbe8dbfb23f803f80,0x3f97bf49bf0b3fa7
.quad 0x3fb5a580bf803f80,0x25c03fb5bf80bf80,0xa580bfb53f803f80,0x3fb5a5c0bf803f80,0x3fb23e8dbf803f80,0xbf493f97bf0bbfa7,0x3e8dbfb23f803f80,0x3f973f49bfa73f0b
.quad 0x3fa73f0bbf803f80,0xbfa73f0ba500bfb5,0x3f0bbfa73f803f80,0x3f0b3fa7bfb52500,0x3f973f49bf803f80,0xbfb2be8d3f0bbfa7,0x3f49bf973f803f80,0xbe8d3fb2bfa7bf0b
.quad 0x3f80bf80bf803f80,0x3f80bf80bf803f80,0xbf80bf803f803f80,0xbf80bf803f803f80,0x3fb23e8dbfb52500,0x3f973f49bfa7bf0b,0x3e8dbfb225003fb5,0x3f49bf97bf0b3fa7
.quad 0x3f0b3fa7bf80bf80,0xbf0b3fa7a500bfb5,0x3fa7bf0bbf803f80,0x3fa73f0bbfb52500,0xbf493f97a500bfb5,0xbfb2be8d3fa7bf0b,0x3f973f49bfb52500,0xbe8d3fb2bf0bbfa7
.quad 0xbfb525003f80bf80,0xa500bfb53f803f80,0x25003fb5bf80bf80,0xbfb525003f80bf80,0xbf49bf973fb5a580,0x3fb2be8dbf0b3fa7,0xbf973f49a580bfb5,0xbe8dbfb23fa73f0b
.quad 0x3f0bbfa73f803f80,0x3f0b3fa7bfb52500,0xbfa7bf0b3f80bf80,0x3fa7bf0b25003fb5,0x3fb2be8d25c03fb5,0xbf973f49bf0bbfa7,0xbe8dbfb23fb5a5c0,0x3f493f97bfa73f0b
.quad 0x3f80bf80bf803f80,0x3f80bf80bf803f80,0xbf80bf803f803f80,0xbf80bf803f803f80,0x3f493f97bf80bf80,0x3e8d3fb2bf0bbfa7,0x3f97bf49bf803f80,0x3fb2be8dbfa73f0b
.quad 0xbfa73f0b3f80bf80,0xbfa7bf0b3fb5a580,0x3f0b3fa7bf80bf80,0xbf0b3fa7a580bfb5,0xbe8dbfb23f803f80,0x3f97bf49bf0b3fa7,0xbfb23e8d3f80bf80,0xbf49bf973fa73f0b
.quad 0x3fb5a580bf803f80,0x25c03fb5bf80bf80,0xa580bfb53f803f80,0x3fb5a5c0bf803f80,0xbe8d3fb2bf80bf80,0xbf97bf493fa7bf0b,0x3fb23e8dbf803f80,0xbf493f97bf0bbfa7
.quad 0xbfa7bf0b3f80bf80,0x3fa7bf0b25c03fb5,0xbf0b3fa7bf80bf80,0xbf0bbfa73fb5a5c0,0x3f49bf973f803f80,0xbe8d3fb2bfa7bf0b,0xbf97bf493f80bf80,0x3fb23e8dbf0b3fa7
.quad 0x3f80bf80bf803f80,0x3f80bf80bf803f80,0xbf80bf803f803f80,0xbf80bf803f803f80,0xbe8d3fb2a500bfb5,0xbf493f973f0bbfa7,0x3fb23e8dbfb52500,0x3f973f49bfa7bf0b
.quad 0xbf0bbfa73f803f80,0x3f0bbfa725c03fb5,0xbfa73f0b3f80bf80,0xbfa7bf0b3fb5a5c0,0x3f973f49bfb52500,0xbe8d3fb2bf0bbfa7,0x3f49bf9725003fb5,0x3fb23e8dbfa73f0b
.quad 0xbfb525003f80bf80,0xa500bfb53f803f80,0x25003fb5bf80bf80,0xbfb525003f80bf80,0x3f97bf4925c03fb5,0x3e8d3fb2bfa7bf0b,0xbf49bf973fb5a5c0,0x3fb2be8dbf0b3fa7
.quad 0xbf0b3fa7bf80bf80,0xbf0bbfa73fb5a580,0x3fa73f0bbf803f80,0xbfa73f0ba580bfb5,0xbe8dbfb23fb5a580,0x3f493f97bfa73f0b,0xbfb23e8da580bfb5,0x3f97bf493f0b3fa7
.quad 0x3f80bf80bf803f80,0x3f80bf80bf803f80,0xbf80bf803f803f80,0xbf80bf803f803f80,0xbf973f493f80bf80,0xbfb23e8d3fa7bf0b,0x3f493f97bf80bf80,0x3e8d3fb2bf0bbfa7
.quad 0x3fa7bf0bbf803f80,0x3fa73f0bbfb52500,0xbf0bbfa73f803f80,0x3f0bbfa725003fb5,0xbfb23e8d3f80bf80,0xbf49bf973fa73f0b,0x3e8d3fb2bf80bf80,0xbf973f493f0bbfa7
.quad 0x3fb5a580bf803f80,0x25c03fb5bf80bf80,0xa580bfb53f803f80,0x3fb5a5c0bf803f80,0xbfb2be8d3f80bf80,0x3f49bf973f0b3fa7,0xbe8d3fb2bf80bf80,0xbf97bf493fa7bf0b
.quad 0x3fa73f0bbf803f80,0xbfa73f0ba500bfb5,0x3f0bbfa73f803f80,0x3f0b3fa7bfb52500,0xbf97bf493f80bf80,0x3fb23e8dbf0b3fa7,0xbf493f97bf80bf80,0x3e8dbfb23fa73f0b
.quad 0x3f80bf80bf803f80,0x3f80bf80bf803f80,0xbf80bf803f803f80,0xbf80bf803f803f80,0xbfb2be8d3fb5a580,0xbf97bf493fa73f0b,0xbe8d3fb2a580bfb5,0xbf493f973f0bbfa7
.quad 0x3f0b3fa7bf80bf80,0xbf0b3fa7a500bfb5,0x3fa7bf0bbf803f80,0x3fa73f0bbfb52500,0x3f49bf9725c03fb5,0x3fb23e8dbfa73f0b,0xbf97bf493fb5a5c0,0x3e8dbfb23f0b3fa7
.quad 0xbfb525003f80bf80,0xa500bfb53f803f80,0x25003fb5bf80bf80,0xbfb525003f80bf80,0x3f493f97bfb52500,0xbfb23e8d3f0bbfa7,0x3f97bf4925003fb5,0x3e8d3fb2bfa7bf0b
.quad 0x3f0bbfa73f803f80,0x3f0b3fa7bfb52500,0xbfa7bf0b3f80bf80,0x3fa7bf0b25003fb5,0xbfb23e8da500bfb5,0x3f97bf493f0b3fa7,0x3e8d3fb2bfb52500,0xbf49bf973fa7bf0b
.quad 0x3f80bf80bf803f80,0x3f80bf80bf803f80,0xbf80bf803f803f80,0xbf80bf803f803f80,0xbf49bf973f803f80,0xbe8dbfb23f0b3fa7,0xbf973f493f80bf80,0xbfb23e8d3fa7bf0b
.quad 0xbfa73f0b3f80bf80,0xbfa7bf0b3fb5a580,0x3f0b3fa7bf80bf80,0xbf0b3fa7a580bfb5,0x3e8d3fb2bf80bf80,0xbf973f493f0bbfa7,0x3fb2be8dbf803f80,0x3f493f97bfa7bf0b
.quad 0x3fb5a580bf803f80,0x25c03fb5bf80bf80,0xa580bfb53f803f80,0x3fb5a5c0bf803f80,0x3e8dbfb23f803f80,0x3f973f49bfa73f0b,0xbfb2be8d3f80bf80,0x3f49bf973f0b3fa7
.quad 0xbfa7bf0b3f80bf80,0x3fa7bf0b25c03fb5,0xbf0b3fa7bf80bf80,0xbf0bbfa73fb5a5c0,0xbf493f97bf80bf80,0x3e8dbfb23fa73f0b,0x3f973f49bf803f80,0xbfb2be8d3f0bbfa7
.quad 0x3f80bf80bf803f80,0x3f80bf80bf803f80,0xbf80bf803f803f80,0xbf80bf803f803f80,0x3e8dbfb225c03fb5,0x3f49bf97bf0b3fa7,0xbfb2be8d3fb5a5c0,0xbf97bf493fa73f0b
.quad 0xbf0bbfa73f803f80,0x3f0bbfa725c03fb5,0xbfa73f0b3f80bf80,0xbfa7bf0b3fb5a5c0,0xbf97bf493fb5a580,0x3e8dbfb23f0b3fa7,0xbf493f97a580bfb5,0xbfb2be8d3fa7bf0b
.quad 0xbfb525003f80bf80,0xa500bfb53f803f80,0x25003fb5bf80bf80,0xbfb525003f80bf80,0xbf973f49a500bfb5,0xbe8dbfb23fa73f0b,0x3f493f97bfb52500,0xbfb23e8d3f0bbfa7
.quad 0xbf0b3fa7bf80bf80,0xbf0bbfa73fb5a580,0x3fa73f0bbf803f80,0xbfa73f0ba580bfb5,0x3e8d3fb2bfb52500,0xbf49bf973fa7bf0b,0x3fb2be8d25003fb5,0xbf973f49bf0bbfa7
.quad 0x3f80bf80bf803f80,0x3f80bf80bf803f80,0xbf80bf803f803f80,0xbf80bf803f803f80,0x3fa0bf2bbf8c3f66,0x3fb4be0ebfad3ed2,0xbf2bbfa03f663f8c,0xbe0ebfb43ed23fad
.quad 0x3fb2be8dbf973f49,0x3f973f49bfb2be8d,0xbe8dbfb23f493f97,0x3f49bf97be8d3fb2,0x3fb43e0ebfa03f2b,0x3ed23fadbf8cbf66,0x3e0ebfb43f2b3fa0,0x3fadbed2bf663f8c
.quad 0x3fa73f0bbfa73f0b,0xbf0b3fa7bf0bbfa7,0x3f0bbfa73f0b3fa7,0x3fa73f0bbfa73f0b,0x3f8c3f66bfad3ed2,0xbfa03f2b3e0ebfb4,0x3f66bf8c3ed23fad,0x3f2b3fa0bfb4be0e
.quad 0x3f493f97bfb23e8d,0xbfb2be8d3f49bf97,0x3f97bf493e8d3fb2,0xbe8d3fb2bf97bf49,0x3ed23fadbfb43e0e,0xbf66bf8c3fa0bf2b,0x3fadbed23e0e3fb4,0xbf8c3f66bf2bbfa0
.quad 0x3f80bf80bf803f80,0x3f80bf80bf803f80,0xbf80bf803f803f80,0xbf80bf803f803f80,0x3fad3ed2bfb4be0e,0x3f8c3f66bfa0bf2b,0x3ed2bfadbe0e3fb4,0x3f66bf8cbf2b3fa0
.quad 0x3e8d3fb2bf49bf97,0xbf493f973e8dbfb2,0x3fb2be8dbf973f49,0x3f973f49bfb2be8d,0xbf8c3f663ed2bfad,0xbfa0bf2b3fb4be0e,0x3f663f8cbfadbed2,0xbf2b3fa0be0ebfb4
.quad 0xbfa7bf0b3fa7bf0b,0x3f0bbfa73f0b3fa7,0xbf0b3fa7bf0bbfa7,0xbfa7bf0b3fa7bf0b,0xbe0ebfb43fa03f2b,0x3fad3ed2bf8c3f66,0xbfb43e0e3f2bbfa0,0x3ed2bfad3f663f8c
.quad 0x3f97bf493e8d3fb2,0xbe8d3fb2bf97bf49,0xbf49bf973fb2be8d,0x3fb23e8dbf493f97,0x3fa03f2bbf663f8c,0xbfb4be0e3ed2bfad,0x3f2bbfa03f8c3f66,0xbe0e3fb4bfadbed2
.quad 0x3f80bf80bf803f80,0x3f80bf80bf803f80,0xbf80bf803f803f80,0xbf80bf803f803f80,0x3f2b3fa0bf66bf8c,0x3e0e3fb4bed2bfad,0x3fa0bf2bbf8c3f66,0x3fb4be0ebfad3ed2
.quad 0xbfb23e8d3f97bf49,0xbf97bf493fb23e8d,0x3e8d3fb2bf49bf97,0xbf493f973e8dbfb2,0x3e0ebfb43f2b3fa0,0x3fadbed2bf663f8c,0xbfb4be0e3fa0bf2b,0xbed2bfad3f8c3f66
.quad 0x3fa73f0bbfa73f0b,0xbf0b3fa7bf0bbfa7,0x3f0bbfa73f0b3fa7,0x3fa73f0bbfa73f0b,0xbf663f8cbed2bfad,0xbf2bbfa03fb43e0e,0x3f8c3f66bfad3ed2,0xbfa03f2b3e0ebfb4
.quad 0xbf49bf973fb2be8d,0x3fb23e8dbf493f97,0xbf973f49be8dbfb2,0x3e8dbfb23f973f49,0x3fadbed23e0e3fb4,0xbf8c3f66bf2bbfa0,0xbed2bfad3fb4be0e,0x3f663f8cbfa03f2b
.quad 0x3f80bf80bf803f80,0x3f80bf80bf803f80,0xbf80bf803f803f80,0xbf80bf803f803f80,0xbed23fad3e0ebfb4,0xbf663f8c3f2bbfa0,0x3fad3ed2bfb4be0e,0x3f8c3f66bfa0bf2b
.quad 0xbe8dbfb23f493f97,0x3f49bf97be8d3fb2,0xbfb23e8d3f97bf49,0xbf97bf493fb23e8d,0x3f663f8cbfadbed2,0xbf2b3fa0be0ebfb4,0x3f8cbf66bed23fad,0x3fa03f2bbfb43e0e
.quad 0xbfa7bf0b3fa7bf0b,0x3f0bbfa73f0b3fa7,0xbf0b3fa7bf0bbfa7,0xbfa7bf0b3fa7bf0b,0x3fb4be0ebf2b3fa0,0xbed23fadbf66bf8c,0xbe0ebfb43fa03f2b,0x3fad3ed2bf8c3f66
.quad 0xbf973f49be8dbfb2,0x3e8dbfb23f973f49,0x3f493f97bfb23e8d,0xbfb2be8d3f49bf97,0x3f2bbfa03f8c3f66,0xbe0e3fb4bfadbed2,0xbfa0bf2b3f66bf8c,0x3fb43e0ebed23fad
.quad 0x3f80bf80bf803f80,0x3f80bf80bf803f80,0xbf80bf803f803f80,0xbf80bf803f803f80,0xbfa03f2b3f8cbf66,0xbfb43e0e3fadbed2,0x3f2b3fa0bf66bf8c,0x3e0e3fb4bed2bfad
.quad 0x3fb2be8dbf973f49,0x3f973f49bfb2be8d,0xbe8dbfb23f493f97,0x3f49bf97be8d3fb2,0xbfb4be0e3fa0bf2b,0xbed2bfad3f8c3f66,0xbe0e3fb4bf2bbfa0,0xbfad3ed23f66bf8c
.quad 0x3fa73f0bbfa73f0b,0xbf0b3fa7bf0bbfa7,0x3f0bbfa73f0b3fa7,0x3fa73f0bbfa73f0b,0xbf8cbf663fadbed2,0x3fa0bf2bbe0e3fb4,0xbf663f8cbed2bfad,0xbf2bbfa03fb43e0e
.quad 0x3f493f97bfb23e8d,0xbfb2be8d3f49bf97,0x3f97bf493e8d3fb2,0xbe8d3fb2bf97bf49,0xbed2bfad3fb4be0e,0x3f663f8cbfa03f2b,0xbfad3ed2be0ebfb4,0x3f8cbf663f2b3fa0
.quad 0x3f80bf80bf803f80,0x3f80bf80bf803f80,0xbf80bf803f803f80,0xbf80bf803f803f80,0xbfadbed23fb43e0e,0xbf8cbf663fa03f2b,0xbed23fad3e0ebfb4,0xbf663f8c3f2bbfa0
.quad 0x3e8d3fb2bf49bf97,0xbf493f973e8dbfb2,0x3fb2be8dbf973f49,0x3f973f49bfb2be8d,0x3f8cbf66bed23fad,0x3fa03f2bbfb43e0e,0xbf66bf8c3fad3ed2,0x3f2bbfa03e0e3fb4
.quad 0xbfa7bf0b3fa7bf0b,0x3f0bbfa73f0b3fa7,0xbf0b3fa7bf0bbfa7,0xbfa7bf0b3fa7bf0b,0x3e0e3fb4bfa0bf2b,0xbfadbed23f8cbf66,0x3fb4be0ebf2b3fa0,0xbed23fadbf66bf8c
.quad 0x3f97bf493e8d3fb2,0xbe8d3fb2bf97bf49,0xbf49bf973fb2be8d,0x3fb23e8dbf493f97,0xbfa0bf2b3f66bf8c,0x3fb43e0ebed23fad,0xbf2b3fa0bf8cbf66,0x3e0ebfb43fad3ed2
.quad 0x3f80bf80bf803f80,0x3f80bf80bf803f80,0xbf80bf803f803f80,0xbf80bf803f803f80,0xbf2bbfa03f663f8c,0xbe0ebfb43ed23fad,0xbfa03f2b3f8cbf66,0xbfb43e0e3fadbed2
.quad 0xbfb23e8d3f97bf49,0xbf97bf493fb23e8d,0x3e8d3fb2bf49bf97,0xbf493f973e8dbfb2,0xbe0e3fb4bf2bbfa0,0xbfad3ed23f66bf8c,0x3fb43e0ebfa03f2b,0x3ed23fadbf8cbf66
.quad 0x3fa73f0bbfa73f0b,0xbf0b3fa7bf0bbfa7,0x3f0bbfa73f0b3fa7,0x3fa73f0bbfa73f0b,0x3f66bf8c3ed23fad,0x3f2b3fa0bfb4be0e,0xbf8cbf663fadbed2,0x3fa0bf2bbe0e3fb4
.quad 0xbf49bf973fb2be8d,0x3fb23e8dbf493f97,0xbf973f49be8dbfb2,0x3e8dbfb23f973f49,0xbfad3ed2be0ebfb4,0x3f8cbf663f2b3fa0,0x3ed23fadbfb43e0e,0xbf66bf8c3fa0bf2b
.quad 0x3f80bf80bf803f80,0x3f80bf80bf803f80,0xbf80bf803f803f80,0xbf80bf803f803f80,0x3ed2bfadbe0e3fb4,0x3f66bf8cbf2b3fa0,0xbfadbed23fb43e0e,0xbf8cbf663fa03f2b
.quad 0xbe8dbfb23f493f97,0x3f49bf97be8d3fb2,0xbfb23e8d3f97bf49,0xbf97bf493fb23e8d,0xbf66bf8c3fad3ed2,0x3f2bbfa03e0e3fb4,0xbf8c3f663ed2bfad,0xbfa0bf2b3fb4be0e
.quad 0xbfa7bf0b3fa7bf0b,0x3f0bbfa73f0b3fa7,0xbf0b3fa7bf0bbfa7,0xbfa7bf0b3fa7bf0b,0xbfb43e0e3f2bbfa0,0x3ed2bfad3f663f8c,0x3e0e3fb4bfa0bf2b,0xbfadbed23f8cbf66
.quad 0xbf973f49be8dbfb2,0x3e8dbfb23f973f49,0x3f493f97bfb23e8d,0xbfb2be8d3f49bf97,0xbf2b3fa0bf8cbf66,0x3e0ebfb43fad3ed2,0x3fa03f2bbf663f8c,0xbfb4be0e3ed2bfad
.quad 0xbdc9bf7f80003f80,0xbe95bf753e483f7b,0xbe95bf7580003f80,0xbf46bf223f0e3f55,0xbef1bf6280003f80,0xbf7fbdc93f553f0e,0xbf22bf4680003f80,0xbf623ef13f7b3e48
.quad 0xbf46bf2280003f80,0xbef13f623f7bbe48,0xbf62bef180003f80,0x3dc93f7f3f55bf0e,0xbf75be9580003f80,0x3f223f463f0ebf55,0xbf7fbdc980003f80,0x3f753e953e48bf7b
.quad 0xbf7f3dc980003f80,0x3f75be95be48bf7b,0xbf753e9580003f80,0x3f22bf46bf0ebf55,0xbf623ef180003f80,0x3dc9bf7fbf55bf0e,0xbf463f2280003f80,0xbef1bf62bf7bbe48
.quad 0xbf223f4680003f80,0xbf62bef1bf7b3e48,0xbef13f6280003f80,0xbf7f3dc9bf553f0e,0xbe953f7580003f80,0xbf463f22bf0e3f55,0xbdc93f7f80003f80,0xbe953f75be483f7b
.quad 0xbef1bf623ec43f6d,0xbf22bf463f0e3f55,0xbf7fbdc93f6d3ec4,0xbf623ef13f7bbe48,0xbf223f463f6dbec4,0x3e953f753e48bf7b,0x3e953f753ec4bf6d,0x3f7fbdc9bf55bf0e
.quad 0x3f753e95bec4bf6d,0x3dc9bf7fbf553f0e,0x3f46bf22bf6dbec4,0xbf75be953e483f7b,0xbdc9bf7fbf6d3ec4,0xbef13f623f7b3e48,0xbf62bef1bec43f6d,0x3f463f223f0ebf55
.quad 0xbf623ef13ec43f6d,0x3f46bf22bf0ebf55,0xbdc93f7f3f6d3ec4,0xbef1bf62bf7b3e48,0x3f463f223f6dbec4,0xbf753e95be483f7b,0x3f75be953ec4bf6d,0x3dc93f7f3f553f0e
.quad 0x3e95bf75bec4bf6d,0x3f7f3dc93f55bf0e,0xbf22bf46bf6dbec4,0x3e95bf75be48bf7b,0xbf7f3dc9bf6d3ec4,0xbf62bef1bf7bbe48,0xbef13f62bec43f6d,0xbf223f46bf0e3f55
.quad 0xbf46bf223f353f35,0xbf62bef13f553f0e,0xbef13f623f35bf35,0x3dc93f7f3e48bf7b,0x3f753e95bf35bf35,0x3f46bf22bf7b3e48,0x3dc9bf7fbf353f35,0xbf75be953f0e3f55
.quad 0xbf7f3dc93f353f35,0x3e953f753f0ebf55,0x3e953f753f35bf35,0x3f22bf46bf7bbe48,0x3f62bef1bf35bf35,0xbf7fbdc93e483f7b,0xbf22bf46bf353f35,0x3ef13f623f55bf0e
.quad 0xbf223f463f353f35,0x3ef1bf62bf55bf0e,0x3f623ef13f35bf35,0xbf7f3dc9be483f7b,0x3e95bf75bf35bf35,0x3f223f463f7bbe48,0xbf7fbdc9bf353f35,0x3e95bf75bf0ebf55
.quad 0x3dc93f7f3f353f35,0xbf753e95bf0e3f55,0x3f75be953f35bf35,0x3f463f223f7b3e48,0xbef1bf62bf35bf35,0x3dc9bf7fbe48bf7b,0xbf463f22bf353f35,0xbf623ef1bf553f0e
.quad 0xbf75be953f6d3ec4,0xbf7fbdc93f7b3e48,0x3f223f46bec4bf6d,0x3f753e95bf55bf0e,0xbdc9bf7fbec43f6d,0xbf62bef13f0e3f55,0xbef13f623f6dbec4,0x3f463f22be48bf7b
.quad 0x3f62bef1bf6dbec4,0xbf22bf46be483f7b,0xbf7fbdc93ec43f6d,0x3ef13f623f0ebf55,0x3f463f223ec4bf6d,0xbe95bf75bf553f0e,0xbe95bf75bf6d3ec4,0x3dc93f7f3f7bbe48
.quad 0xbe953f753f6d3ec4,0x3dc9bf7fbf7bbe48,0x3f46bf22bec4bf6d,0xbe953f753f553f0e,0xbf7f3dc9bec43f6d,0x3ef1bf62bf0ebf55,0x3f623ef13f6dbec4,0xbf223f463e483f7b
.quad 0xbef1bf62bf6dbec4,0x3f46bf223e48bf7b,0xbdc93f7f3ec43f6d,0xbf623ef1bf0e3f55,0x3f22bf463ec4bf6d,0x3f75be953f55bf0e,0xbf753e95bf6d3ec4,0xbf7f3dc9bf7b3e48
.quad 0xbf7f3dc93f80248d,0xbf753e953f7bbe48,0x3f75be95bf80a554,0x3f22bf46bf553f0e,0xbf623ef13f80248d,0xbdc93f7f3f0ebf55,0x3f46bf22bf80a554,0xbef1bf62be483f7b
.quad 0xbf223f463f80248d,0x3f623ef1be48bf7b,0x3ef1bf62bf80a554,0xbf7f3dc93f0e3f55,0xbe953f753f80248d,0x3f46bf22bf55bf0e,0x3dc9bf7fbf80a554,0xbe953f753f7b3e48
.quad 0x3dc93f7f3f80248d,0xbe95bf75bf7b3e48,0xbe95bf75bf80a554,0x3f463f223f55bf0e,0x3ef13f623f80248d,0xbf7fbdc9bf0e3f55,0xbf22bf46bf80a554,0x3f62bef13e48bf7b
.quad 0x3f463f223f80248d,0xbef13f623e483f7b,0xbf62bef1bf80a554,0xbdc9bf7fbf0ebf55,0x3f753e953f80248d,0x3f223f463f553f0e,0xbf7fbdc9bf80a554,0xbf75be95bf7bbe48
.quad 0xbf623ef13f6dbec4,0xbf463f223f55bf0e,0x3dc9bf7fbec43f6d,0xbef1bf623e483f7b,0x3f463f22bec4bf6d,0x3f75be95bf7bbe48,0xbf753e953f6d3ec4,0x3dc93f7f3f0ebf55
.quad 0x3e95bf75bf6d3ec4,0xbf7fbdc93f0e3f55,0x3f223f463ec4bf6d,0x3e95bf75bf7b3e48,0xbf7f3dc93ec43f6d,0x3f623ef13e48bf7b,0x3ef1bf62bf6dbec4,0xbf223f463f553f0e
.quad 0x3ef13f623f6dbec4,0xbf22bf46bf553f0e,0xbf7fbdc9bec43f6d,0x3f62bef1be48bf7b,0x3f22bf46bec4bf6d,0x3e953f753f7b3e48,0x3e953f753f6d3ec4,0xbf7f3dc9bf0e3f55
.quad 0xbf75be95bf6d3ec4,0x3dc9bf7fbf0ebf55,0x3f46bf223ec4bf6d,0x3f753e953f7bbe48,0x3dc93f7f3ec43f6d,0xbef13f62be483f7b,0xbf62bef1bf6dbec4,0xbf46bf22bf55bf0e
.quad 0xbf223f463f35bf35,0xbef13f623f0ebf55,0xbf62bef13f353f35,0xbf7f3dc93f7b3e48,0x3e95bf75bf353f35,0xbf22bf463e483f7b,0x3f7f3dc9bf35bf35,0x3e95bf75bf553f0e
.quad 0x3dc93f7f3f35bf35,0x3f75be95bf55bf0e,0xbf753e953f353f35,0x3f463f223e48bf7b,0xbef1bf62bf353f35,0xbdc93f7f3f7bbe48,0x3f46bf22bf35bf35,0xbf623ef13f0e3f55
.quad 0x3f463f223f35bf35,0xbf62bef1bf0e3f55,0xbef13f623f353f35,0xbdc9bf7fbf7bbe48,0xbf75be95bf353f35,0x3f46bf22be48bf7b,0x3dc9bf7fbf35bf35,0x3f753e953f55bf0e
.quad 0x3f7fbdc93f35bf35,0x3e953f753f553f0e,0x3e953f753f353f35,0xbf223f46be483f7b,0xbf623ef1bf353f35,0xbf7fbdc9bf7b3e48,0xbf22bf46bf35bf35,0xbef1bf62bf0ebf55
.quad 0xbe953f753ec4bf6d,0xbdc93f7f3e48bf7b,0xbf463f223f6dbec4,0xbe953f753f0ebf55,0xbf7f3dc93f6d3ec4,0xbef13f623f55bf0e,0xbf62bef13ec43f6d,0xbf223f463f7bbe48
.quad 0xbef1bf62bec43f6d,0xbf463f223f7b3e48,0x3dc9bf7fbf6d3ec4,0xbf623ef13f553f0e,0x3f22bf46bf6dbec4,0xbf753e953f0e3f55,0x3f75be95bec4bf6d,0xbf7f3dc93e483f7b
.quad 0x3f753e953ec4bf6d,0xbf7fbdc9be483f7b,0x3f223f463f6dbec4,0xbf75be95bf0e3f55,0x3dc93f7f3f6d3ec4,0xbf62bef1bf553f0e,0xbef13f623ec43f6d,0xbf46bf22bf7b3e48
.quad 0xbf623ef1bec43f6d,0xbf22bf46bf7bbe48,0xbf7fbdc9bf6d3ec4,0xbef1bf62bf55bf0e,0xbf46bf22bf6dbec4,0xbe95bf75bf0ebf55,0xbe95bf75bec4bf6d,0xbdc9bf7fbe48bf7b
.quad 0x3f803f80bf803f80,0xbf80bf803f80bf80,0x3f80bf803f803f80,0xbf803f80bf80bf80,0x3f493f97bf803f80,0xbe8dbfb23fa7bf0b,0x3f97bf493f803f80,0xbfb23e8dbf0bbfa7
.quad 0x3f0b3fa7bf803f80,0x3f0bbfa73fb5a580,0x3fa7bf0b3f803f80,0xbfa7bf0ba580bfb5,0x3e8d3fb2bf803f80,0x3f97bf493fa73f0b,0x3fb2be8d3f803f80,0xbf49bf973f0bbfa7
.quad 0x25c03fb5bf803f80,0x3fb5a5803f803f80,0x3fb5a5c03f803f80,0xa580bfb53f80bf80,0xbe8d3fb2bf803f80,0x3f973f493f0b3fa7,0x3fb23e8d3f803f80,0x3f49bf973fa7bf0b
.quad 0xbf0b3fa7bf803f80,0x3f0b3fa725c03fb5,0x3fa73f0b3f803f80,0x3fa7bf0b3fb5a5c0,0xbf493f97bf803f80,0xbe8d3fb2bf0b3fa7,0x3f973f493f803f80,0x3fb23e8d3fa73f0b
.quad 0x3f803f80bf803f80,0xbf80bf803f80bf80,0x3f80bf803f803f80,0xbf803f80bf80bf80,0xbe8d3fb2bfb52500,0x3f49bf973fa73f0b,0x3fb23e8d25003fb5,0xbf97bf493f0bbfa7
.quad 0xbfa73f0bbf80bf80,0x3fa73f0b25c03fb5,0x3f0b3fa7bf803f80,0x3f0bbfa73fb5a5c0,0xbf97bf49a500bfb5,0xbe8d3fb2bfa73f0b,0xbf493f97bfb52500,0x3fb23e8d3f0b3fa7
.quad 0xa500bfb53f80bf80,0xbfb52500bf80bf80,0xbfb52500bf80bf80,0x25003fb5bf803f80,0x3f97bf493fb5a580,0xbe8dbfb23f0bbfa7,0xbf49bf97a580bfb5,0xbfb23e8dbfa7bf0b
.quad 0x3fa73f0b3f803f80,0x3fa7bf0b3fb5a580,0x3f0bbfa73f80bf80,0xbf0bbfa7a580bfb5,0x3e8d3fb225c03fb5,0x3f493f973f0b3fa7,0x3fb2be8d3fb5a5c0,0x3f97bf493fa7bf0b
.quad 0x3f803f80bf803f80,0xbf80bf803f80bf80,0x3f80bf803f803f80,0xbf803f80bf80bf80,0xbf973f49bf80bf80,0x3fb2be8d3f0b3fa7,0x3f493f97bf803f80,0xbe8dbfb23fa7bf0b
.quad 0xbf0bbfa73f80bf80,0xbf0b3fa7bfb52500,0xbfa73f0bbf80bf80,0x3fa73f0b25003fb5,0x3fb2be8d3f803f80,0xbf49bf973f0bbfa7,0xbe8dbfb23f80bf80,0xbf973f49bfa7bf0b
.quad 0x25c03fb5bf803f80,0x3fb5a5803f803f80,0x3fb5a5c03f803f80,0xa580bfb53f80bf80,0xbfb2be8dbf80bf80,0xbf493f97bfa73f0b,0xbe8d3fb2bf803f80,0x3f973f493f0b3fa7
.quad 0x3f0bbfa73f80bf80,0xbf0bbfa7a500bfb5,0xbfa7bf0bbf80bf80,0xbfa73f0bbfb52500,0x3f973f493f803f80,0x3fb23e8d3fa73f0b,0x3f49bf973f80bf80,0x3e8dbfb23f0bbfa7
.quad 0x3f803f80bf803f80,0xbf80bf803f80bf80,0x3f80bf803f803f80,0xbf803f80bf80bf80,0xbfb2be8da500bfb5,0x3f973f49bf0b3fa7,0xbe8d3fb2bfb52500,0x3f49bf973fa73f0b
.quad 0x3fa7bf0b3f803f80,0xbfa7bf0ba500bfb5,0xbf0bbfa73f80bf80,0xbf0b3fa7bfb52500,0xbf493f97bfb52500,0x3fb23e8d3f0b3fa7,0x3f973f4925003fb5,0x3e8dbfb23fa7bf0b
.quad 0xa500bfb53f80bf80,0xbfb52500bf80bf80,0xbfb52500bf80bf80,0x25003fb5bf803f80,0x3f493f9725c03fb5,0x3fb2be8d3fa73f0b,0x3f97bf493fb5a5c0,0xbe8dbfb23f0bbfa7
.quad 0xbfa7bf0bbf80bf80,0xbfa73f0bbfb52500,0xbf0b3fa7bf803f80,0x3f0b3fa725003fb5,0x3fb2be8d3fb5a580,0x3f97bf493fa7bf0b,0xbe8dbfb2a580bfb5,0xbf49bf97bf0bbfa7
.quad 0x3f803f80bf803f80,0xbf80bf803f80bf80,0x3f80bf803f803f80,0xbf803f80bf80bf80,0xbf49bf973f80bf80,0x3e8d3fb2bfa73f0b,0xbf973f49bf80bf80,0x3fb2be8d3f0b3fa7
.quad 0x3f0b3fa7bf803f80,0x3f0bbfa73fb5a580,0x3fa7bf0b3f803f80,0xbfa7bf0ba580bfb5,0xbe8dbfb23f80bf80,0xbf973f49bfa7bf0b,0xbfb23e8dbf80bf80,0x3f493f97bf0b3fa7
.quad 0x25c03fb5bf803f80,0x3fb5a5803f803f80,0x3fb5a5c03f803f80,0xa580bfb53f80bf80,0x3e8dbfb23f80bf80,0xbf97bf49bf0bbfa7,0xbfb2be8dbf80bf80,0xbf493f97bfa73f0b
.quad 0xbf0b3fa7bf803f80,0x3f0b3fa725c03fb5,0x3fa73f0b3f803f80,0x3fa7bf0b3fb5a5c0,0x3f49bf973f80bf80,0x3e8dbfb23f0bbfa7,0xbf97bf49bf80bf80,0xbfb2be8dbfa7bf0b
.quad 0x3f803f80bf803f80,0xbf80bf803f80bf80,0x3f80bf803f803f80,0xbf803f80bf80bf80,0x3e8dbfb23fb5a580,0xbf493f97bfa7bf0b,0xbfb2be8da580bfb5,0x3f973f49bf0b3fa7
.quad 0xbfa73f0bbf80bf80,0x3fa73f0b25c03fb5,0x3f0b3fa7bf803f80,0x3f0bbfa73fb5a5c0,0x3f973f4925c03fb5,0x3e8dbfb23fa7bf0b,0x3f49bf973fb5a5c0,0xbfb2be8dbf0bbfa7
.quad 0xa500bfb53f80bf80,0xbfb52500bf80bf80,0xbfb52500bf80bf80,0x25003fb5bf803f80,0xbf973f49bfb52500,0x3e8d3fb2bf0b3fa7,0x3f493f9725003fb5,0x3fb2be8d3fa73f0b
.quad 0x3fa73f0b3f803f80,0x3fa7bf0b3fb5a580,0x3f0bbfa73f80bf80,0xbf0bbfa7a580bfb5,0xbe8dbfb2a500bfb5,0xbf49bf97bf0bbfa7,0xbfb23e8dbfb52500,0xbf973f49bfa73f0b
.quad 0x3f803f80bf803f80,0xbf80bf803f80bf80,0x3f80bf803f803f80,0xbf803f80bf80bf80,0x3f97bf493f803f80,0xbfb23e8dbf0bbfa7,0xbf49bf973f80bf80,0x3e8d3fb2bfa73f0b
.quad 0xbf0bbfa73f80bf80,0xbf0b3fa7bfb52500,0xbfa73f0bbf80bf80,0x3fa73f0b25003fb5,0xbfb23e8dbf80bf80,0x3f493f97bf0b3fa7,0x3e8d3fb2bf803f80,0x3f97bf493fa73f0b
.quad 0x25c03fb5bf803f80,0x3fb5a5803f803f80,0x3fb5a5c03f803f80,0xa580bfb53f80bf80,0x3fb23e8d3f803f80,0x3f49bf973fa7bf0b,0x3e8dbfb23f80bf80,0xbf97bf49bf0bbfa7
.quad 0x3f0bbfa73f80bf80,0xbf0bbfa7a500bfb5,0xbfa7bf0bbf80bf80,0xbfa73f0bbfb52500,0xbf97bf49bf80bf80,0xbfb2be8dbfa7bf0b,0xbf493f97bf803f80,0xbe8d3fb2bf0b3fa7
.quad 0x3f803f80bf803f80,0xbf80bf803f80bf80,0x3f80bf803f803f80,0xbf803f80bf80bf80,0x3fb23e8d25c03fb5,0xbf97bf493f0bbfa7,0x3e8dbfb23fb5a5c0,0xbf493f97bfa7bf0b
.quad 0x3fa7bf0b3f803f80,0xbfa7bf0ba500bfb5,0xbf0bbfa73f80bf80,0xbf0b3fa7bfb52500,0x3f49bf973fb5a580,0xbfb2be8dbf0bbfa7,0xbf97bf49a580bfb5,0xbe8d3fb2bfa73f0b
.quad 0xa500bfb53f80bf80,0xbfb52500bf80bf80,0xbfb52500bf80bf80,0x25003fb5bf803f80,0xbf49bf97a500bfb5,0xbfb23e8dbfa7bf0b,0xbf973f49bfb52500,0x3e8d3fb2bf0b3fa7
.quad 0xbfa7bf0bbf80bf80,0xbfa73f0bbfb52500,0xbf0b3fa7bf803f80,0x3f0b3fa725003fb5,0xbfb23e8dbfb52500,0xbf973f49bfa73f0b,0x3e8d3fb225003fb5,0x3f493f973f0b3fa7
.quad 0x25003fb5bfb52500,0xa580bfb53fb5a5c0,0x3fb5a50025003fb5,0xbfb52580a5c0bfb5,0xbed23fadbfb4be0e,0x3f66bf8c3fa03f2b,0x3fad3ed2be0e3fb4,0xbf8cbf663f2bbfa0
.quad 0xbf493f97bfb2be8d,0x3fb2be8d3f493f97,0x3f973f49be8d3fb2,0xbe8dbfb23f97bf49,0xbf8c3f66bfadbed2,0x3fa03f2b3e0e3fb4,0x3f663f8cbed23fad,0x3f2bbfa03fb4be0e
.quad 0xbfa73f0bbfa7bf0b,0x3f0b3fa7bf0b3fa7,0x3f0b3fa7bf0b3fa7,0x3fa7bf0b3fa73f0b,0xbfb43e0ebfa0bf2b,0xbed23fadbf8c3f66,0x3e0e3fb4bf2b3fa0,0x3fad3ed23f663f8c
.quad 0xbfb2be8dbf97bf49,0xbf973f49bfb23e8d,0xbe8d3fb2bf493f97,0x3f493f973e8d3fb2,0xbfa0bf2bbf8cbf66,0xbfb4be0ebfadbed2,0xbf2b3fa0bf663f8c,0xbe0e3fb4bed23fad
.quad 0x25003fb5bfb52500,0xa580bfb53fb5a5c0,0x3fb5a50025003fb5,0xbfb52580a5c0bfb5,0xbfa03f2bbf66bf8c,0x3fb4be0e3ed23fad,0x3f2b3fa0bf8c3f66,0xbe0ebfb43fadbed2
.quad 0xbf97bf493e8dbfb2,0x3e8d3fb2bf973f49,0xbf493f97bfb2be8d,0x3fb2be8d3f493f97,0x3e0ebfb43fa0bf2b,0xbfad3ed2bf8cbf66,0xbfb4be0ebf2bbfa0,0x3ed23fadbf663f8c
.quad 0x3fa7bf0b3fa73f0b,0xbf0bbfa73f0bbfa7,0xbf0bbfa73f0bbfa7,0xbfa73f0bbfa7bf0b,0x3f8c3f663ed23fad,0x3fa0bf2b3fb43e0e,0x3f66bf8c3fadbed2,0xbf2bbfa03e0ebfb4
.quad 0xbe8d3fb2bf493f97,0x3f493f973e8d3fb2,0x3fb23e8d3f973f49,0x3f97bf493fb2be8d,0xbfad3ed2bfb43e0e,0xbf8c3f66bfa03f2b,0x3ed23fad3e0e3fb4,0x3f663f8c3f2b3fa0
.quad 0x25003fb5bfb52500,0xa580bfb53fb5a5c0,0x3fb5a50025003fb5,0xbfb52580a5c0bfb5,0xbfadbed23e0ebfb4,0x3f8c3f66bf2b3fa0,0xbed23fadbfb4be0e,0x3f66bf8c3fa03f2b
.quad 0x3f49bf973fb23e8d,0xbfb23e8dbf49bf97,0xbf97bf493e8dbfb2,0x3e8d3fb2bf973f49,0x3f663f8cbed23fad,0x3f2bbfa03fb4be0e,0x3f8cbf663fad3ed2,0xbfa0bf2bbe0ebfb4
.quad 0xbfa73f0bbfa7bf0b,0x3f0b3fa7bf0b3fa7,0x3f0b3fa7bf0b3fa7,0x3fa7bf0b3fa73f0b,0xbe0ebfb43f2bbfa0,0xbfadbed2bf66bf8c,0xbfb43e0ebfa0bf2b,0xbed23fadbf8c3f66
.quad 0x3fb23e8d3f973f49,0x3f97bf493fb2be8d,0x3e8dbfb23f49bf97,0xbf49bf97be8dbfb2,0xbf2b3fa0bf663f8c,0xbe0e3fb4bed23fad,0x3fa03f2b3f8c3f66,0x3fb43e0e3fad3ed2
.quad 0x25003fb5bfb52500,0xa580bfb53fb5a5c0,0x3fb5a50025003fb5,0xbfb52580a5c0bfb5,0xbf2bbfa03f8cbf66,0x3e0e3fb4bfad3ed2,0xbfa03f2bbf66bf8c,0x3fb4be0e3ed23fad
.quad 0x3f973f49be8d3fb2,0xbe8dbfb23f97bf49,0x3f49bf973fb23e8d,0xbfb23e8dbf49bf97,0xbfb4be0ebf2bbfa0,0x3ed23fadbf663f8c,0xbe0e3fb4bfa03f2b,0x3fadbed23f8c3f66
.quad 0x3fa7bf0b3fa73f0b,0xbf0bbfa73f0bbfa7,0xbf0bbfa73f0bbfa7,0xbfa73f0bbfa7bf0b,0xbf663f8cbfad3ed2,0x3f2b3fa0be0e3fb4,0x3f8c3f663ed23fad,0x3fa0bf2b3fb43e0e
.quad 0x3e8dbfb23f49bf97,0xbf49bf97be8dbfb2,0xbfb2be8dbf97bf49,0xbf973f49bfb23e8d,0x3ed23fad3e0e3fb4,0x3f663f8c3f2b3fa0,0x3fadbed23fb4be0e,0x3f8cbf663fa0bf2b
.quad 0x25003fb5bfb52500,0xa580bfb53fb5a5c0,0x3fb5a50025003fb5,0xbfb52580a5c0bfb5,0x3ed2bfad3fb43e0e,0xbf663f8cbfa0bf2b,0xbfadbed23e0ebfb4,0x3f8c3f66bf2b3fa0
.quad 0xbf493f97bfb2be8d,0x3fb2be8d3f493f97,0x3f973f49be8d3fb2,0xbe8dbfb23f97bf49,0x3f8cbf663fad3ed2,0xbfa0bf2bbe0ebfb4,0xbf66bf8c3ed2bfad,0xbf2b3fa0bfb43e0e
.quad 0xbfa73f0bbfa7bf0b,0x3f0b3fa7bf0b3fa7,0x3f0b3fa7bf0b3fa7,0x3fa7bf0b3fa73f0b,0x3fb4be0e3fa03f2b,0x3ed2bfad3f8cbf66,0xbe0ebfb43f2bbfa0,0xbfadbed2bf66bf8c
.quad 0xbfb2be8dbf97bf49,0xbf973f49bfb23e8d,0xbe8d3fb2bf493f97,0x3f493f973e8d3fb2,0x3fa03f2b3f8c3f66,0x3fb43e0e3fad3ed2,0x3f2bbfa03f66bf8c,0x3e0ebfb43ed2bfad
.quad 0x25003fb5bfb52500,0xa580bfb53fb5a5c0,0x3fb5a50025003fb5,0xbfb52580a5c0bfb5,0x3fa0bf2b3f663f8c,0xbfb43e0ebed2bfad,0xbf2bbfa03f8cbf66,0x3e0e3fb4bfad3ed2
.quad 0xbf97bf493e8dbfb2,0x3e8d3fb2bf973f49,0xbf493f97bfb2be8d,0x3fb2be8d3f493f97,0xbe0e3fb4bfa03f2b,0x3fadbed23f8c3f66,0x3fb43e0e3f2b3fa0,0xbed2bfad3f66bf8c
.quad 0x3fa7bf0b3fa73f0b,0xbf0bbfa73f0bbfa7,0xbf0bbfa73f0bbfa7,0xbfa73f0bbfa7bf0b,0xbf8cbf66bed2bfad,0xbfa03f2bbfb4be0e,0xbf663f8cbfad3ed2,0x3f2b3fa0be0e3fb4
.quad 0xbe8d3fb2bf493f97,0x3f493f973e8d3fb2,0x3fb23e8d3f973f49,0x3f97bf493fb2be8d,0x3fadbed23fb4be0e,0x3f8cbf663fa0bf2b,0xbed2bfadbe0ebfb4,0xbf66bf8cbf2bbfa0
.quad 0x25003fb5bfb52500,0xa580bfb53fb5a5c0,0x3fb5a50025003fb5,0xbfb52580a5c0bfb5,0x3fad3ed2be0e3fb4,0xbf8cbf663f2bbfa0,0x3ed2bfad3fb43e0e,0xbf663f8cbfa0bf2b
.quad 0x3f49bf973fb23e8d,0xbfb23e8dbf49bf97,0xbf97bf493e8dbfb2,0x3e8d3fb2bf973f49,0xbf66bf8c3ed2bfad,0xbf2b3fa0bfb43e0e,0xbf8c3f66bfadbed2,0x3fa03f2b3e0e3fb4
.quad 0xbfa73f0bbfa7bf0b,0x3f0b3fa7bf0b3fa7,0x3f0b3fa7bf0b3fa7,0x3fa7bf0b3fa73f0b,0x3e0e3fb4bf2b3fa0,0x3fad3ed23f663f8c,0x3fb4be0e3fa03f2b,0x3ed2bfad3f8cbf66
.quad 0x3fb23e8d3f973f49,0x3f97bf493fb2be8d,0x3e8dbfb23f49bf97,0xbf49bf97be8dbfb2,0x3f2bbfa03f66bf8c,0x3e0ebfb43ed2bfad,0xbfa0bf2bbf8cbf66,0xbfb4be0ebfadbed2
.quad 0x25003fb5bfb52500,0xa580bfb53fb5a5c0,0x3fb5a50025003fb5,0xbfb52580a5c0bfb5,0x3f2b3fa0bf8c3f66,0xbe0ebfb43fadbed2,0x3fa0bf2b3f663f8c,0xbfb43e0ebed2bfad
.quad 0x3f973f49be8d3fb2,0xbe8dbfb23f97bf49,0x3f49bf973fb23e8d,0xbfb23e8dbf49bf97,0x3fb43e0e3f2b3fa0,0xbed2bfad3f66bf8c,0x3e0ebfb43fa0bf2b,0xbfad3ed2bf8cbf66
.quad 0x3fa7bf0b3fa73f0b,0xbf0bbfa73f0bbfa7,0xbf0bbfa73f0bbfa7,0xbfa73f0bbfa7bf0b,0x3f66bf8c3fadbed2,0xbf2bbfa03e0ebfb4,0xbf8cbf66bed2bfad,0xbfa03f2bbfb4be0e
.quad 0x3e8dbfb23f49bf97,0xbf49bf97be8dbfb2,0xbfb2be8dbf97bf49,0xbf973f49bfb23e8d,0xbed2bfadbe0ebfb4,0xbf66bf8cbf2bbfa0,0xbfad3ed2bfb43e0e,0xbf8c3f66bfa03f2b
.size tabm, 45056
```
